```python
import torch

def _softmax(x, axis=-1):
    return torch.softmax(x, dim=axis)
def _gelu(x):
    return torch.nn.functional.gelu(x, approximate="tanh")
def _silu(x):
    return torch.nn.functional.silu(x)
def _sigmoid(x):
    return torch.sigmoid(x)
def _layernorm(x, axis=-1, eps=1e-5):
    m = x.mean(dim=axis, keepdim=True)
    v = x.var(dim=axis, keepdim=True, unbiased=False)
    return (x - m) / torch.sqrt(v + eps)
def _scatter_add(tgt, idx, src, axis=0):
    return tgt.clone().index_add_(axis, idx, src)
def _segment_sum(src, seg, n):
    out = torch.zeros((n,) + src.shape[1:], dtype=src.dtype)
    return out.index_add_(0, seg, src)
def _pad(x, pw):
    flat = tuple(v for pair in reversed(pw) for v in pair)
    return torch.nn.functional.pad(x, flat)

kernel_name = 'sequential_preLN__sliding_block__glu_gated_glu__prompt'

def setup_inputs():

    _w = (lambda a: (lambda t: t.to(torch.bfloat16) if t.is_floating_point() else t)(torch.as_tensor(a)))
    def _A_setup():
        B, S, D = 1, 2048, 640
        return {
            "x": _w((lambda *s: torch.randn(*s, dtype=torch.bfloat16) * 0.05)(B, S, D)),
            "wqkv": _w((lambda *s: torch.randn(*s, dtype=torch.bfloat16) * 0.05)(D, 3 * D)),
            "wo": _w((lambda *s: torch.randn(*s, dtype=torch.bfloat16) * 0.05)(D, D)),
        }
    _A_in = _A_setup()

    def _B_setup():
        B, S, D, F = 1, 2048, 640, 1728
        return {
            "x": _w((lambda *s: torch.randn(*s, dtype=torch.bfloat16) * 0.05)(B, S, D)),
            "w_gate": _w((lambda *s: torch.randn(*s, dtype=torch.bfloat16) * 0.05)(D, F)),
            "w_up": _w((lambda *s: torch.randn(*s, dtype=torch.bfloat16) * 0.05)(D, F)),
            "w_down": _w((lambda *s: torch.randn(*s, dtype=torch.bfloat16) * 0.05)(F, D)),
        }
    _B_in = _B_setup()

    return {
        "A_x": _A_in["x"],
        "A_wqkv": _A_in["wqkv"],
        "A_wo": _A_in["wo"],
        "B_x": _B_in["x"],
        "B_w_gate": _B_in["w_gate"],
        "B_w_up": _B_in["w_up"],
        "B_w_down": _B_in["w_down"],
    }

def reference(A_x, A_wqkv, A_wo, B_x, B_w_gate, B_w_up, B_w_down):
    def _A_ref(x, wqkv, wo):
        B, S, D = x.shape
        H = 32; Dh = D // H; W = 256
        qkv = (lambda x, *d: x.permute(*d))((x @ wqkv).reshape(B, S, 3, H, Dh), 2, 0, 3, 1, 4)
        q, k, v = qkv[0], qkv[1], qkv[2]
        scores = torch.einsum("bhqd,bhkd->bhqk", q, k) * (Dh ** -0.5)
        idx = torch.arange(S)
        mask = (idx[:, None] - idx[None, :] >= 0) & (idx[:, None] - idx[None, :] < W)
        scores = torch.where(mask[None, None], scores, -1e9)
        p = _softmax(scores, axis=-1)
        o = torch.einsum("bhqk,bhkd->bhqd", p, v)
        return (lambda x, *d: x.permute(*d))(o, 0, 2, 1, 3).reshape(B, S, D) @ wo

    def _B_ref(x, w_gate, w_up, w_down):
        g = torch.einsum("bsd,df->bsf", x, w_gate)
        u = torch.einsum("bsd,df->bsf", x, w_up)
        h = _sigmoid(g) * u
        return torch.einsum("bsf,fd->bsd", h, w_down)

    x = A_x
    h = x + _A_ref(_layernorm(x, axis=-1), A_wqkv, A_wo)
    h2 = h + _B_ref(_layernorm(h, axis=-1), B_w_gate, B_w_up, B_w_down)
    return h2
```

```asm
; @launch grid=(256,1,1) block=(512,1,1) lds=163840
.amdgcn_target "amdgcn-amd-amdhsa--gfx950"
.text
.globl sequential_preLN__sliding_block__glu_gated_glu__prompt_kernel
.p2align 8
.type sequential_preLN__sliding_block__glu_gated_glu__prompt_kernel,@function
sequential_preLN__sliding_block__glu_gated_glu__prompt_kernel:
    s_cmp_ge_u32 s2, 256
    s_cbranch_scc1 L_end
    s_load_dwordx16 s[64:79], s[0:1], 0
    s_load_dwordx4 s[80:83], s[0:1], 64
    s_cmp_ge_u32 s2, 16
    s_cbranch_scc1 L_nocode
    s_cmp_eq_u32 s2, 5
    s_cbranch_scc1 L_nocode
    s_getpc_b64 s[40:41]
L_pc:
    s_sub_u32 s40, s40, L_pc-sequential_preLN__sliding_block__glu_gated_glu__prompt_kernel
    s_subb_u32 s41, s41, 0
    s_and_b32 s42, s2, 8
    s_lshl_b32 s42, s42, 5
    v_and_b32 v2, 256, v0
    v_cmp_ne_u32 vcc, s42, v2
    s_cmp_eq_u32 s2, 13
    s_cselect_b64 vcc, -1, vcc
    s_cbranch_vccz L_nocode
    v_lshlrev_b32 v2, 7, v0
    v_min_u32 v2, L_code_end-sequential_preLN__sliding_block__glu_gated_glu__prompt_kernel-4, v2
    global_load_dword v250, v2, s[40:41]
L_nocode:
    v_and_b32 v1, 63, v0
    v_lshrrev_b32 v2, 6, v0
    s_nop 0
    v_readfirstlane_b32 s3, v2
    v_mov_b32 v247, 0
    v_mov_b32 v78, 0
    s_mov_b32 s98, 0
    s_mov_b32 s96, 0x100000
    s_lshr_b32 s40, s2, 3
    s_sub_u32 s40, s40, 2
    s_and_b32 s41, s2, 1
    s_mul_i32 s41, s41, 30
    s_add_u32 s40, s40, s41
    s_lshr_b32 s41, s40, 2
    s_and_b32 s40, s40, 3
    s_add_u32 s43, s40, s41
    s_mul_i32 s42, s41, 21846
    s_lshr_b32 s42, s42, 16
    s_mul_i32 s41, s41, 5
    s_mul_i32 s44, s42, 14
    s_sub_u32 s41, s41, s44
    s_and_b32 s42, s2, 6
    s_lshl_b32 s42, s42, 1
    s_add_u32 s40, s40, s42
    s_and_b32 s97, s3, 3
    s_mov_b32 s55, s2
    v_lshrrev_b32 v10, 3, v1
    v_mul_u32_u24 v2, 1280, v10
    v_lshrrev_b32 v10, 4, v1
    v_and_b32 v11, 7, v1
    v_xor_b32 v11, v11, v10
    v_lshl_add_u32 v2, v11, 4, v2
    v_xor_b32 v3, 64, v2
    v_add_u32 v3, 9216, v3
    v_add_u32 v4, 18432, v2
    v_add_u32 v5, 18432, v3
    v_mul_u32_u24 v6, 3840, v10
    v_lshlrev_b32 v10, 1, v10
    v_and_b32 v11, 15, v1
    v_xor_b32 v11, v11, v10
    v_lshl_add_u32 v6, v11, 4, v6
    v_add_u32 v7, 14336, v6
    v_xor_b32 v8, 128, v6
    v_add_u32 v8, 28672, v8
    v_add_u32 v9, 14336, v8
    s_lshl_b32 s44, s40, 2
    s_add_u32 s44, s44, s97
    s_mul_i32 s44, s44, 40960
    s_mul_i32 s45, s97, 61440
    s_lshl_b32 s46, s41, 8
    s_add_u32 s45, s45, s46
    s_and_b32 s46, s43, 3
    s_lshl_b32 s47, s97, 12
    s_waitcnt lgkmcnt(0)
    s_mov_b32 s8, s64
    s_mov_b32 s9, s65
    s_mov_b32 s10, 2621440
    s_mov_b32 s11, 0x20000
    s_mov_b32 s12, s66
    s_mov_b32 s13, s67
    s_mov_b32 s14, 2457600
    s_mov_b32 s15, 0x20000
    s_cmp_eq_u32 s2, 5
    s_cbranch_scc1 L_init
L_init_back:
    s_cmp_ge_u32 s3, 4
    s_cbranch_scc1 L_w47
    s_lshl_b32 s44, s55, 2
    s_add_u32 s44, s44, s3
    s_lshl_b32 s44, s44, 1
    v_lshlrev_b32 v8, 4, v1
    v_lshlrev_b32 v9, 2, v1
    s_mul_i32 s45, s44, 1280
    buffer_load_dwordx4 v[12:15], v8, s[8:11], s45 offen offset:0
    buffer_load_dword v16, v9, s[8:11], s45 offen offset:1024
    buffer_load_dwordx4 v[20:23], v8, s[8:11], s45 offen offset:1280
    buffer_load_dword v24, v9, s[8:11], s45 offen offset:2304
    s_cmp_lt_u32 s2, 16
    s_cbranch_scc1 L_spare
    s_branch L_p1_c
L_w47:
    s_cmp_lt_u32 s2, 16
    s_cbranch_scc1 L_spare
    s_lshl_b32 s48, s46, 7
    s_add_u32 s48, s48, s44
    s_mul_i32 s49, s46, 245760
    s_add_u32 s49, s49, s45
    s_add_u32 m0, s47, 0
    s_nop 0
    buffer_load_dwordx4 v2, s[8:11], s48 offen offset:0  lds
    buffer_load_dwordx4 v3, s[8:11], s48 offen offset:1024  lds
    buffer_load_dwordx4 v4, s[8:11], s48 offen offset:2048  lds
    buffer_load_dwordx4 v5, s[8:11], s48 offen offset:3072  lds
    s_add_u32 m0, s47, 16384
    s_nop 0
    buffer_load_dwordx4 v6, s[12:15], s49 offen offset:0 lds
    buffer_load_dwordx4 v7, s[12:15], s49 offen offset:1024 lds
    buffer_load_dwordx4 v8, s[12:15], s49 offen offset:2048 lds
    buffer_load_dwordx4 v9, s[12:15], s49 offen offset:3072 lds
    s_add_u32 s46, s46, 1
    s_and_b32 s46, s46, 3
    s_mov_b32 s4, s82
    s_mov_b32 s5, s83
    s_mov_b32 s6, 24117248
    s_mov_b32 s7, 0x20000
    s_mov_b32 s36, s80
    s_mov_b32 s37, s81
    s_mov_b32 s38, 256
    s_mov_b32 s39, 0x20000
    s_mov_b32 s16, s68
    s_mov_b32 s17, s69
    s_mov_b32 s18, 819200
    s_mov_b32 s19, 0x20000
    s_mov_b32 s20, s72
    s_mov_b32 s21, s73
    s_mov_b32 s22, 2211840
    s_mov_b32 s23, 0x20000
    s_mov_b32 s24, s74
    s_mov_b32 s25, s75
    s_mov_b32 s26, 2211840
    s_mov_b32 s27, 0x20000
    s_mov_b32 s28, s76
    s_mov_b32 s29, s77
    s_mov_b32 s30, 2211840
    s_mov_b32 s31, 0x20000
    s_mov_b32 s32, s78
    s_mov_b32 s33, s79
    s_mov_b32 s34, 2621440
    s_mov_b32 s35, 0x20000
    s_mov_b32 s0, 0
    s_sub_u32 s1, s2, 220
    s_lshl_b32 s48, s46, 7
    s_add_u32 s48, s48, s44
    s_mul_i32 s49, s46, 245760
    s_add_u32 s49, s49, s45
    s_add_u32 m0, s47, 32768
    s_nop 0
    buffer_load_dwordx4 v2, s[8:11], s48 offen offset:0  lds
    buffer_load_dwordx4 v3, s[8:11], s48 offen offset:1024  lds
    buffer_load_dwordx4 v4, s[8:11], s48 offen offset:2048  lds
    buffer_load_dwordx4 v5, s[8:11], s48 offen offset:3072  lds
    s_add_u32 m0, s47, 49152
    s_nop 0
    buffer_load_dwordx4 v6, s[12:15], s49 offen offset:0 lds
    buffer_load_dwordx4 v7, s[12:15], s49 offen offset:1024 lds
    buffer_load_dwordx4 v8, s[12:15], s49 offen offset:2048 lds
    buffer_load_dwordx4 v9, s[12:15], s49 offen offset:3072 lds
    s_add_u32 s46, s46, 1
    s_and_b32 s46, s46, 3
    s_mul_i32 s52, s40, 15
    s_add_u32 s52, s52, s41
    s_lshl_b32 s52, s52, 7
    v_mov_b32 v12, 0
    s_waitcnt vmcnt(8)
    s_barrier
    s_lshl_b32 s48, s46, 7
    s_add_u32 s48, s48, s44
    s_mul_i32 s49, s46, 245760
    s_add_u32 s49, s49, s45
    s_add_u32 m0, s47, 65536
    s_nop 0
    buffer_load_dwordx4 v2, s[8:11], s48 offen offset:0  lds
    buffer_load_dwordx4 v3, s[8:11], s48 offen offset:1024  lds
    buffer_load_dwordx4 v4, s[8:11], s48 offen offset:2048  lds
    buffer_load_dwordx4 v5, s[8:11], s48 offen offset:3072  lds
    s_add_u32 m0, s47, 81920
    s_nop 0
    buffer_load_dwordx4 v6, s[12:15], s49 offen offset:0 lds
    buffer_load_dwordx4 v7, s[12:15], s49 offen offset:1024 lds
    buffer_load_dwordx4 v8, s[12:15], s49 offen offset:2048 lds
    buffer_load_dwordx4 v9, s[12:15], s49 offen offset:3072 lds
    s_add_u32 s46, s46, 1
    s_and_b32 s46, s46, 3
    s_waitcnt vmcnt(8)
    s_barrier
    buffer_load_dword v13, v12, s[36:39], 0 offen sc1
    s_lshl_b32 s48, s46, 7
    s_add_u32 s48, s48, s44
    s_mul_i32 s49, s46, 245760
    s_add_u32 s49, s49, s45
    s_add_u32 m0, s47, 98304
    s_nop 0
    buffer_load_dwordx4 v2, s[8:11], s48 offen offset:0  lds
    buffer_load_dwordx4 v3, s[8:11], s48 offen offset:1024  lds
    buffer_load_dwordx4 v4, s[8:11], s48 offen offset:2048  lds
    buffer_load_dwordx4 v5, s[8:11], s48 offen offset:3072  lds
    s_add_u32 m0, s47, 114688
    s_nop 0
    buffer_load_dwordx4 v6, s[12:15], s49 offen offset:0 lds
    buffer_load_dwordx4 v7, s[12:15], s49 offen offset:1024 lds
    buffer_load_dwordx4 v8, s[12:15], s49 offen offset:2048 lds
    buffer_load_dwordx4 v9, s[12:15], s49 offen offset:3072 lds
    s_mov_b32 s46, 4
    s_waitcnt vmcnt(9)
    s_barrier
    s_lshl_b32 s48, s46, 7
    s_add_u32 s48, s48, s44
    s_mul_i32 s49, s46, 245760
    s_add_u32 s49, s49, s45
    s_add_u32 m0, s47, 0
    s_nop 0
    buffer_load_dwordx4 v2, s[8:11], s48 offen offset:0  lds
    buffer_load_dwordx4 v3, s[8:11], s48 offen offset:1024  lds
    buffer_load_dwordx4 v4, s[8:11], s48 offen offset:2048  lds
    buffer_load_dwordx4 v5, s[8:11], s48 offen offset:3072  lds
    s_add_u32 m0, s47, 16384
    s_nop 0
    buffer_load_dwordx4 v6, s[12:15], s49 offen offset:0 lds
    buffer_load_dwordx4 v7, s[12:15], s49 offen offset:1024 lds
    buffer_load_dwordx4 v8, s[12:15], s49 offen offset:2048 lds
    buffer_load_dwordx4 v9, s[12:15], s49 offen offset:3072 lds
    s_mov_b32 s46, 5
    s_waitcnt vmcnt(8)
    s_barrier
    s_waitcnt vmcnt(16)
    v_cmp_ne_u32 vcc, 1, v13
    s_cbranch_vccz Ls0_1r
    v_mov_b32 v10, 0
Lpoll_2:
    buffer_load_dword v11, v10, s[36:39], 0 offen sc1
    s_waitcnt vmcnt(0)
    v_cmp_ne_u32 vcc, 1, v11
    s_cbranch_vccz Lpoll_2d
    s_sleep 1
    s_sub_u32 s96, s96, 1
    s_cbranch_scc0 Lpoll_2
    s_mov_b32 s96, 0
Lpoll_2d:
Ls0_1r:
    s_lshr_b32 s53, s55, 4
    s_mul_i32 s53, s53, 15
    s_lshl_b32 s54, s97, 2
    s_add_u32 s53, s53, s54
    v_add_u32 v10, s53, v1
    s_cmp_eq_u32 s97, 3
    s_cselect_b64 vcc, 7, 15
    v_lshlrev_b32 v10, 7, v10
    v_mov_b32 v11, 1
    s_mov_b64 exec, vcc
    buffer_atomic_add v11, v10, s[4:7], 0 offen offset:0 sc1
    s_mov_b64 exec, -1
    s_lshl_b32 s48, s46, 7
    s_add_u32 s48, s48, s44
    s_mul_i32 s49, s46, 245760
    s_add_u32 s49, s49, s45
    s_add_u32 m0, s47, 32768
    s_nop 0
    buffer_load_dwordx4 v2, s[8:11], s48 offen offset:0  lds
    buffer_load_dwordx4 v3, s[8:11], s48 offen offset:1024  lds
    buffer_load_dwordx4 v4, s[8:11], s48 offen offset:2048  lds
    buffer_load_dwordx4 v5, s[8:11], s48 offen offset:3072  lds
    s_add_u32 m0, s47, 49152
    s_nop 0
    buffer_load_dwordx4 v6, s[12:15], s49 offen offset:0 lds
    buffer_load_dwordx4 v7, s[12:15], s49 offen offset:1024 lds
    buffer_load_dwordx4 v8, s[12:15], s49 offen offset:2048 lds
    buffer_load_dwordx4 v9, s[12:15], s49 offen offset:3072 lds
    s_mov_b32 s46, 6
    s_waitcnt vmcnt(9)
    s_barrier
    s_lshl_b32 s48, s46, 7
    s_add_u32 s48, s48, s44
    s_mul_i32 s49, s46, 245760
    s_add_u32 s49, s49, s45
    s_add_u32 m0, s47, 65536
    s_nop 0
    buffer_load_dwordx4 v2, s[8:11], s48 offen offset:0  lds
    buffer_load_dwordx4 v3, s[8:11], s48 offen offset:1024  lds
    buffer_load_dwordx4 v4, s[8:11], s48 offen offset:2048  lds
    buffer_load_dwordx4 v5, s[8:11], s48 offen offset:3072  lds
    s_add_u32 m0, s47, 81920
    s_nop 0
    buffer_load_dwordx4 v6, s[12:15], s49 offen offset:0 lds
    buffer_load_dwordx4 v7, s[12:15], s49 offen offset:1024 lds
    buffer_load_dwordx4 v8, s[12:15], s49 offen offset:2048 lds
    buffer_load_dwordx4 v9, s[12:15], s49 offen offset:3072 lds
    s_mov_b32 s46, 7
    s_waitcnt vmcnt(8)
    s_barrier
    s_lshl_b32 s48, s46, 7
    s_add_u32 s48, s48, s44
    s_mul_i32 s49, s46, 245760
    s_add_u32 s49, s49, s45
    s_add_u32 m0, s47, 98304
    s_nop 0
    buffer_load_dwordx4 v2, s[8:11], s48 offen offset:0  lds
    buffer_load_dwordx4 v3, s[8:11], s48 offen offset:1024  lds
    buffer_load_dwordx4 v4, s[8:11], s48 offen offset:2048  lds
    buffer_load_dwordx4 v5, s[8:11], s48 offen offset:3072  lds
    s_add_u32 m0, s47, 114688
    s_nop 0
    buffer_load_dwordx4 v6, s[12:15], s49 offen offset:0 lds
    buffer_load_dwordx4 v7, s[12:15], s49 offen offset:1024 lds
    buffer_load_dwordx4 v8, s[12:15], s49 offen offset:2048 lds
    buffer_load_dwordx4 v9, s[12:15], s49 offen offset:3072 lds
    s_mov_b32 s46, 8
    s_waitcnt vmcnt(8)
    s_barrier
    buffer_load_dword v14, v12, s[4:7], s52 offen sc1
    s_lshl_b32 s48, s46, 7
    s_add_u32 s48, s48, s44
    s_mul_i32 s49, s46, 245760
    s_add_u32 s49, s49, s45
    s_add_u32 m0, s47, 0
    s_nop 0
    buffer_load_dwordx4 v2, s[8:11], s48 offen offset:0  lds
    buffer_load_dwordx4 v3, s[8:11], s48 offen offset:1024  lds
    buffer_load_dwordx4 v4, s[8:11], s48 offen offset:2048  lds
    buffer_load_dwordx4 v5, s[8:11], s48 offen offset:3072  lds
    s_add_u32 m0, s47, 16384
    s_nop 0
    buffer_load_dwordx4 v6, s[12:15], s49 offen offset:0 lds
    buffer_load_dwordx4 v7, s[12:15], s49 offen offset:1024 lds
    buffer_load_dwordx4 v8, s[12:15], s49 offen offset:2048 lds
    buffer_load_dwordx4 v9, s[12:15], s49 offen offset:3072 lds
    s_mov_b32 s46, 9
    s_waitcnt vmcnt(9)
    s_barrier
    s_lshl_b32 s48, s46, 7
    s_add_u32 s48, s48, s44
    s_mul_i32 s49, s46, 245760
    s_add_u32 s49, s49, s45
    s_add_u32 m0, s47, 32768
    s_nop 0
    buffer_load_dwordx4 v2, s[8:11], s48 offen offset:0  lds
    buffer_load_dwordx4 v3, s[8:11], s48 offen offset:1024  lds
    buffer_load_dwordx4 v4, s[8:11], s48 offen offset:2048  lds
    buffer_load_dwordx4 v5, s[8:11], s48 offen offset:3072  lds
    s_add_u32 m0, s47, 49152
    s_nop 0
    buffer_load_dwordx4 v6, s[12:15], s49 offen offset:0 lds
    buffer_load_dwordx4 v7, s[12:15], s49 offen offset:1024 lds
    buffer_load_dwordx4 v8, s[12:15], s49 offen offset:2048 lds
    buffer_load_dwordx4 v9, s[12:15], s49 offen offset:3072 lds
    s_waitcnt vmcnt(8)
    s_waitcnt vmcnt(16)
    v_cmp_ne_u32 vcc, 16, v14
    s_cbranch_vccz L_p1_s0ok
    v_mov_b32 v10, 0
Lpoll_3:
    buffer_load_dword v11, v10, s[4:7], s52 offen sc1
    s_waitcnt vmcnt(0)
    v_cmp_ne_u32 vcc, 16, v11
    s_cbranch_vccz Lpoll_3d
    s_sleep 1
    s_sub_u32 s96, s96, 1
    s_cbranch_scc0 Lpoll_3
    s_mov_b32 s96, 0
Lpoll_3d:
L_p1_s0ok:
    v_lshlrev_b32 v10, 2, v1
    s_and_b32 s48, s97, 1
    s_cmp_ge_u32 s97, 2
    s_cselect_b32 s49, s41, s40
    s_mov_b32 s50, 65536
    s_cselect_b32 s50, 81920, s50
    s_mov_b32 s51, 8192
    s_cselect_b32 s51, 7680, s51
    s_lshl_b32 s49, s49, 1
    s_add_u32 s49, s49, s48
    s_lshl_b32 s49, s49, 8
    s_add_u32 s49, s49, s50
    buffer_load_dword v16, v10, s[4:7], s49 offen sc1
    s_add_u32 s49, s49, s51
    buffer_load_dword v17, v10, s[4:7], s49 offen sc1
    s_add_u32 s49, s49, s51
    buffer_load_dword v18, v10, s[4:7], s49 offen sc1
    s_add_u32 s49, s49, s51
    buffer_load_dword v19, v10, s[4:7], s49 offen sc1
    s_add_u32 s49, s49, s51
    s_barrier
    v_lshlrev_b32 v15, 7, v1
    s_cmp_eq_u32 s97, 0
    s_cselect_b32 s56, s20, s16
    s_cselect_b32 s57, s21, s17
    s_cselect_b32 s58, s22, s18
    s_cselect_b32 s53, 48, -156
    s_mov_b32 s59, 0x20000
    s_add_u32 s53, s2, s53
    s_and_b32 s53, s53, 511
    s_lshl_b32 s53, s53, 13
    s_cmp_ge_u32 s97, 2
    s_cselect_b32 s53, 1073741816, s53
    buffer_load_dword v251, v15, s[56:59], s53 offen
    s_waitcnt vmcnt(5)
    s_barrier
    s_cmp_lt_u32 s41, 5
    s_cselect_b32 s49, 0x3ea52b5c, 1.0
    s_lshl_b32 s50, s48, 9
    s_add_u32 s50, s50, 131072
    v_lshl_add_u32 v11, v1, 3, s50
    s_lshl_b32 s50, s48, 8
    s_add_u32 s50, s50, 132608
    v_add_u32 v10, s50, v10
    s_waitcnt vmcnt(1)
    s_cmp_ge_u32 s97, 2
    s_cbranch_scc1 L_p1_tcs
    v_mul_f32 v17, s49, v17
    ds_write_b64 v11, v[16:17]
    s_branch L_p1_tdone
L_p1_tcs:
    v_add_f32 v16, v16, v17
    v_add_f32 v18, v18, v19
    v_add_f32 v16, v16, v18
    ds_write_b32 v10, v16
L_p1_tdone:
    s_waitcnt lgkmcnt(0)
    s_barrier
    s_mov_b64 s[62:63], 0
    s_branch L_p1_join
L_p1_c:
    s_mov_b32 s4, s82
    s_mov_b32 s5, s83
    s_mov_b32 s6, 24117248
    s_mov_b32 s7, 0x20000
    s_mov_b32 s36, s80
    s_mov_b32 s37, s81
    s_mov_b32 s38, 256
    s_mov_b32 s39, 0x20000
    s_mov_b32 s16, s68
    s_mov_b32 s17, s69
    s_mov_b32 s18, 819200
    s_mov_b32 s19, 0x20000
    s_mov_b32 s20, s72
    s_mov_b32 s21, s73
    s_mov_b32 s22, 2211840
    s_mov_b32 s23, 0x20000
    s_mov_b32 s24, s74
    s_mov_b32 s25, s75
    s_mov_b32 s26, 2211840
    s_mov_b32 s27, 0x20000
    s_mov_b32 s28, s76
    s_mov_b32 s29, s77
    s_mov_b32 s30, 2211840
    s_mov_b32 s31, 0x20000
    s_mov_b32 s32, s78
    s_mov_b32 s33, s79
    s_mov_b32 s34, 2621440
    s_mov_b32 s35, 0x20000
    s_mov_b32 s0, 0
    s_sub_u32 s1, s2, 220
    s_and_b32 s48, s3, 1
    s_lshr_b32 s49, s3, 1
    v_and_b32 v2, 15, v1
    v_lshrrev_b32 v3, 4, v1
    v_lshlrev_b32 v4, 7, v2
    v_bfe_u32 v5, v1, 1, 3
    v_xor_b32 v5, v5, v3
    v_lshl_add_u32 v4, v5, 4, v4
    s_lshl_b32 s50, s48, 13
    v_add_u32 v64, s50, v4
    v_xor_b32 v65, 64, v64
    s_lshl_b32 s50, s49, 1
    s_add_u32 s50, s50, s48
    s_lshl_b32 s50, s50, 1
    v_lshrrev_b32 v5, 4, v1
    v_lshlrev_b32 v68, 11, v5
    v_bfe_u32 v5, v1, 2, 2
    v_lshl_add_u32 v68, v5, 8, v68
    v_and_b32 v5, 3, v1
    v_lshl_add_u32 v68, v5, 3, v68
    v_bfe_u32 v5, v1, 2, 3
    v_xor_b32 v5, s50, v5
    v_lshl_add_u32 v68, v5, 5, v68
    v_add_u32 v68, 16384, v68
    v_xor_b32 v69, 32, v68
    v_xor_b32 v70, 64, v68
    v_xor_b32 v71, 96, v68
    s_lshl_b32 s50, s48, 9
    s_add_u32 s50, s50, 131072
    v_lshl_add_u32 v76, v2, 3, s50
    s_lshl_b32 s50, s3, 7
    s_add_u32 s50, s50, 132096
    v_lshl_add_u32 v77, v3, 4, s50
    v_xor_b32 v79, 128, v77
    v_lshrrev_b32 v78, 5, v1
    v_lshlrev_b32 v78, 15, v78
    v_and_b32 v7, 31, v1
    v_lshl_add_u32 v78, v7, 4, v78
    s_cmp_ge_u32 s41, 10
    s_cselect_b32 s50, 10, 5
    s_cmp_ge_u32 s41, 5
    s_cselect_b32 s50, s50, 0
    s_sub_u32 s51, s41, s50
    s_lshl_b32 s51, s51, 4
    v_mul_u32_u24 v4, 5, v2
    v_add_u32 v4, 4, v4
    v_subrev_u32 v4, s51, v4
    s_sub_u32 s52, 16, s40
    s_min_u32 s52, s52, 3
    s_cmp_eq_u32 s50, 0
    s_cselect_b32 s52, 1, s52
    v_cmp_gt_u32 vcc, 20, v4
    v_cmp_gt_u32 s[50:51], s52, v3
    s_nop 0
    s_and_b64 vcc, vcc, s[50:51]
    s_lshl_b32 s52, s40, 4
    v_add_u32 v247, s52, v1
    v_lshlrev_b32 v247, 7, v247
    s_cmp_eq_u32 s3, 0
    s_cselect_b64 s[62:63], vcc, 0
    s_cmp_ge_u32 s41, 10
    s_cselect_b32 s50, 20, 0
    v_add_u32 v247, s50, v247
    s_cselect_b32 s50, 1073741816, 0
    v_add_u32 v66, s50, v78
    s_lshl_b32 s50, s41, 1
    s_add_u32 s50, s50, s49
    s_lshl_b32 s50, s50, 18
    s_lshl_b32 s51, s40, 1
    s_add_u32 s51, s51, s48
    s_lshl_b32 s51, s51, 10
    s_add_u32 s50, s50, s51
    s_lshl_b32 s51, s48, 17
    s_add_u32 s50, s50, s51
    s_add_u32 s50, s50, 1048576
    s_lshl_b32 s52, s48, 18
    s_sub_u32 s52, 65536, s52
    s_cmp_ge_u32 s41, 10
    s_cselect_b32 s98, s50, 0
    s_cselect_b32 s0, 0, 1
    s_mov_b32 s99, s52
    v_mov_b32 v144, 0
    v_mov_b32 v145, 0
    v_mov_b32 v146, 0
    v_mov_b32 v147, 0
    v_mov_b32 v148, 0
    v_mov_b32 v149, 0
    v_mov_b32 v150, 0
    v_mov_b32 v151, 0
    v_mov_b32 v152, 0
    v_mov_b32 v153, 0
    v_mov_b32 v154, 0
    v_mov_b32 v155, 0
    v_mov_b32 v156, 0
    v_mov_b32 v157, 0
    v_mov_b32 v158, 0
    v_mov_b32 v159, 0
    v_mov_b32 v160, 0
    v_mov_b32 v161, 0
    v_mov_b32 v162, 0
    v_mov_b32 v163, 0
    v_mov_b32 v164, 0
    v_mov_b32 v165, 0
    v_mov_b32 v166, 0
    v_mov_b32 v167, 0
    v_mov_b32 v168, 0
    v_mov_b32 v169, 0
    v_mov_b32 v170, 0
    v_mov_b32 v171, 0
    v_mov_b32 v172, 0
    v_mov_b32 v173, 0
    v_mov_b32 v174, 0
    v_mov_b32 v175, 0
    v_mov_b32 v176, 0
    v_mov_b32 v177, 0
    v_mov_b32 v178, 0
    v_mov_b32 v179, 0
    v_mov_b32 v180, 0
    v_mov_b32 v181, 0
    v_mov_b32 v182, 0
    v_mov_b32 v183, 0
    v_mov_b32 v184, 0
    v_mov_b32 v185, 0
    v_mov_b32 v186, 0
    v_mov_b32 v187, 0
    v_mov_b32 v188, 0
    v_mov_b32 v189, 0
    v_mov_b32 v190, 0
    v_mov_b32 v191, 0
    v_mov_b32 v192, 0
    v_mov_b32 v193, 0
    v_mov_b32 v194, 0
    v_mov_b32 v195, 0
    v_mov_b32 v196, 0
    v_mov_b32 v197, 0
    v_mov_b32 v198, 0
    v_mov_b32 v199, 0
    v_mov_b32 v200, 0
    v_mov_b32 v201, 0
    v_mov_b32 v202, 0
    v_mov_b32 v203, 0
    v_mov_b32 v204, 0
    v_mov_b32 v205, 0
    v_mov_b32 v206, 0
    v_mov_b32 v207, 0
    v_mov_b32 v208, 0
    v_mov_b32 v209, 0
    v_mov_b32 v210, 0
    v_mov_b32 v211, 0
    v_mov_b32 v212, 0
    v_mov_b32 v213, 0
    v_mov_b32 v214, 0
    v_mov_b32 v215, 0
    v_mov_b32 v72, 0x3f803f80
    v_mov_b32 v73, 0x3f803f80
    v_mov_b32 v74, 0x3f803f80
    v_mov_b32 v75, 0x3f803f80
    s_waitcnt vmcnt(0)
    v_lshlrev_b32 v32, 16, v12
    v_and_b32 v33, 0xffff0000, v12
    v_lshlrev_b32 v34, 16, v13
    v_and_b32 v35, 0xffff0000, v13
    v_lshlrev_b32 v36, 16, v14
    v_and_b32 v37, 0xffff0000, v14
    v_lshlrev_b32 v38, 16, v15
    v_and_b32 v39, 0xffff0000, v15
    v_lshlrev_b32 v40, 16, v16
    v_and_b32 v41, 0xffff0000, v16
    v_lshlrev_b32 v44, 16, v20
    v_and_b32 v45, 0xffff0000, v20
    v_lshlrev_b32 v46, 16, v21
    v_and_b32 v47, 0xffff0000, v21
    v_lshlrev_b32 v48, 16, v22
    v_and_b32 v49, 0xffff0000, v22
    v_lshlrev_b32 v50, 16, v23
    v_and_b32 v51, 0xffff0000, v23
    v_lshlrev_b32 v52, 16, v24
    v_and_b32 v53, 0xffff0000, v24
    v_add_f32 v12, v32, v33
    v_add_f32 v20, v44, v45
    v_add_f32 v12, v12, v34
    v_add_f32 v20, v20, v46
    v_add_f32 v12, v12, v35
    v_add_f32 v20, v20, v47
    v_add_f32 v12, v12, v36
    v_add_f32 v20, v20, v48
    v_add_f32 v12, v12, v37
    v_add_f32 v20, v20, v49
    v_add_f32 v12, v12, v38
    v_add_f32 v20, v20, v50
    v_add_f32 v12, v12, v39
    v_add_f32 v20, v20, v51
    v_add_f32 v12, v12, v40
    v_add_f32 v20, v20, v52
    v_add_f32 v12, v12, v41
    v_add_f32 v20, v20, v53
    s_nop 0
    v_add_f32_dpp v12, v12, v12 quad_perm:[1,0,3,2] row_mask:0xf bank_mask:0xf
    v_add_f32_dpp v20, v20, v20 quad_perm:[1,0,3,2] row_mask:0xf bank_mask:0xf
    s_nop 0
    v_add_f32_dpp v12, v12, v12 quad_perm:[2,3,0,1] row_mask:0xf bank_mask:0xf
    v_add_f32_dpp v20, v20, v20 quad_perm:[2,3,0,1] row_mask:0xf bank_mask:0xf
    s_nop 0
    v_add_f32_dpp v12, v12, v12 row_half_mirror row_mask:0xf bank_mask:0xf
    v_add_f32_dpp v20, v20, v20 row_half_mirror row_mask:0xf bank_mask:0xf
    s_nop 0
    v_add_f32_dpp v12, v12, v12 row_mirror row_mask:0xf bank_mask:0xf
    v_add_f32_dpp v20, v20, v20 row_mirror row_mask:0xf bank_mask:0xf
    s_nop 0
    v_add_f32_dpp v12, v12, v12 row_bcast:15 row_mask:0xa bank_mask:0xf
    v_add_f32_dpp v20, v20, v20 row_bcast:15 row_mask:0xa bank_mask:0xf
    s_nop 0
    v_add_f32_dpp v12, v12, v12 row_bcast:31 row_mask:0xc bank_mask:0xf
    v_add_f32_dpp v20, v20, v20 row_bcast:31 row_mask:0xc bank_mask:0xf
    v_readlane_b32 s46, v12, 63
    v_readlane_b32 s47, v20, 63
    v_mov_b32 v10, 0x3acccccd
    v_mul_f32 v13, s46, v10
    v_mul_f32 v21, s47, v10
    v_sub_f32 v32, v32, v13
    v_sub_f32 v44, v44, v21
    v_sub_f32 v33, v33, v13
    v_sub_f32 v45, v45, v21
    v_sub_f32 v34, v34, v13
    v_sub_f32 v46, v46, v21
    v_sub_f32 v35, v35, v13
    v_sub_f32 v47, v47, v21
    v_sub_f32 v36, v36, v13
    v_sub_f32 v48, v48, v21
    v_sub_f32 v37, v37, v13
    v_sub_f32 v49, v49, v21
    v_sub_f32 v38, v38, v13
    v_sub_f32 v50, v50, v21
    v_sub_f32 v39, v39, v13
    v_sub_f32 v51, v51, v21
    v_sub_f32 v40, v40, v13
    v_sub_f32 v52, v52, v21
    v_sub_f32 v41, v41, v13
    v_sub_f32 v53, v53, v21
    v_mul_f32 v12, v32, v32
    v_mul_f32 v20, v44, v44
    v_fmac_f32 v12, v33, v33
    v_fmac_f32 v20, v45, v45
    v_fmac_f32 v12, v34, v34
    v_fmac_f32 v20, v46, v46
    v_fmac_f32 v12, v35, v35
    v_fmac_f32 v20, v47, v47
    v_fmac_f32 v12, v36, v36
    v_fmac_f32 v20, v48, v48
    v_fmac_f32 v12, v37, v37
    v_fmac_f32 v20, v49, v49
    v_fmac_f32 v12, v38, v38
    v_fmac_f32 v20, v50, v50
    v_fmac_f32 v12, v39, v39
    v_fmac_f32 v20, v51, v51
    v_fmac_f32 v12, v40, v40
    v_fmac_f32 v20, v52, v52
    v_fmac_f32 v12, v41, v41
    v_fmac_f32 v20, v53, v53
    s_nop 0
    v_add_f32_dpp v12, v12, v12 quad_perm:[1,0,3,2] row_mask:0xf bank_mask:0xf
    v_add_f32_dpp v20, v20, v20 quad_perm:[1,0,3,2] row_mask:0xf bank_mask:0xf
    s_nop 0
    v_add_f32_dpp v12, v12, v12 quad_perm:[2,3,0,1] row_mask:0xf bank_mask:0xf
    v_add_f32_dpp v20, v20, v20 quad_perm:[2,3,0,1] row_mask:0xf bank_mask:0xf
    s_nop 0
    v_add_f32_dpp v12, v12, v12 row_half_mirror row_mask:0xf bank_mask:0xf
    v_add_f32_dpp v20, v20, v20 row_half_mirror row_mask:0xf bank_mask:0xf
    s_nop 0
    v_add_f32_dpp v12, v12, v12 row_mirror row_mask:0xf bank_mask:0xf
    v_add_f32_dpp v20, v20, v20 row_mirror row_mask:0xf bank_mask:0xf
    s_nop 0
    v_add_f32_dpp v12, v12, v12 row_bcast:15 row_mask:0xa bank_mask:0xf
    v_add_f32_dpp v20, v20, v20 row_bcast:15 row_mask:0xa bank_mask:0xf
    s_nop 0
    v_add_f32_dpp v12, v12, v12 row_bcast:31 row_mask:0xc bank_mask:0xf
    v_add_f32_dpp v20, v20, v20 row_bcast:31 row_mask:0xc bank_mask:0xf
    v_readlane_b32 s46, v12, 63
    v_readlane_b32 s47, v20, 63
    v_mov_b32 v14, 0x3727c5ac
    v_fmac_f32 v14, s46, v10
    v_rsq_f32 v14, v14
    v_mov_b32 v22, 0x3727c5ac
    v_fmac_f32 v22, s47, v10
    v_rsq_f32 v22, v22
    s_lshl_b32 s45, s44, 2
    s_add_u32 s45, s45, 65536
    s_add_u32 s46, s45, 8192
    v_mov_b32 v10, 0
    s_mov_b64 exec, 1
    buffer_store_dword v13, v10, s[4:7], s45 offen offset:0 sc1
    buffer_store_dword v14, v10, s[4:7], s46 offen offset:0 sc1
    buffer_store_dword v21, v10, s[4:7], s45 offen offset:4 sc1
    buffer_store_dword v22, v10, s[4:7], s46 offen offset:4 sc1
    s_mov_b64 exec, -1
    s_barrier
    ds_read_b64_tr_b16 v[96:97], v68 offset:0
    ds_read_b64_tr_b16 v[98:99], v68 offset:1024
    ds_read_b128 v[80:83], v64 offset:0
    ds_read_b64_tr_b16 v[100:101], v69 offset:0
    ds_read_b64_tr_b16 v[102:103], v69 offset:1024
    ds_read_b64_tr_b16 v[104:105], v70 offset:0
    ds_read_b64_tr_b16 v[106:107], v70 offset:1024
    ds_read_b64_tr_b16 v[108:109], v71 offset:0
    ds_read_b64_tr_b16 v[110:111], v71 offset:1024
    ds_read_b128 v[84:87], v64 offset:2048
    ds_read_b128 v[88:91], v64 offset:4096
    ds_read_b128 v[92:95], v64 offset:6144
    s_mov_b32 s51, 4
    .p2align 3
L_p1_loop0:
    s_waitcnt lgkmcnt(3)
    v_mfma_f32_16x16x32_bf16 v[144:147], v[96:99], v[80:83], v[144:147]
    ds_read_b64_tr_b16 v[128:129], v68 offset:8192
    v_mfma_f32_16x16x32_bf16 v[148:151], v[100:103], v[80:83], v[148:151]
    ds_read_b64_tr_b16 v[130:131], v68 offset:9216
    v_mfma_f32_16x16x32_bf16 v[152:155], v[104:107], v[80:83], v[152:155]
    ds_read_b128 v[112:115], v65 offset:0
    v_mfma_f32_16x16x32_bf16 v[156:159], v[108:111], v[80:83], v[156:159]
    ds_read_b64_tr_b16 v[132:133], v69 offset:8192
    s_waitcnt lgkmcnt(4)
    v_mfma_f32_16x16x32_bf16 v[160:163], v[96:99], v[84:87], v[160:163]
    ds_read_b64_tr_b16 v[134:135], v69 offset:9216
    v_mfma_f32_16x16x32_bf16 v[164:167], v[100:103], v[84:87], v[164:167]
    ds_read_b64_tr_b16 v[136:137], v70 offset:8192
    v_mfma_f32_16x16x32_bf16 v[168:171], v[104:107], v[84:87], v[168:171]
    ds_read_b64_tr_b16 v[138:139], v70 offset:9216
    v_mfma_f32_16x16x32_bf16 v[172:175], v[108:111], v[84:87], v[172:175]
    ds_read_b64_tr_b16 v[140:141], v71 offset:8192
    v_mfma_f32_16x16x32_bf16 v[176:179], v[96:99], v[88:91], v[176:179]
    ds_read_b64_tr_b16 v[142:143], v71 offset:9216
    v_mfma_f32_16x16x32_bf16 v[180:183], v[100:103], v[88:91], v[180:183]
    ds_read_b128 v[116:119], v65 offset:2048
    v_mfma_f32_16x16x32_bf16 v[184:187], v[104:107], v[88:91], v[184:187]
    ds_read_b128 v[120:123], v65 offset:4096
    v_mfma_f32_16x16x32_bf16 v[188:191], v[108:111], v[88:91], v[188:191]
    ds_read_b128 v[124:127], v65 offset:6144
    v_mfma_f32_16x16x32_bf16 v[192:195], v[96:99], v[92:95], v[192:195]
    v_mfma_f32_16x16x32_bf16 v[196:199], v[100:103], v[92:95], v[196:199]
    v_mfma_f32_16x16x32_bf16 v[208:211], v[96:99], v[72:75], v[208:211]
    v_mfma_f32_16x16x32_bf16 v[200:203], v[104:107], v[92:95], v[200:203]
    v_mfma_f32_16x16x32_bf16 v[204:207], v[108:111], v[92:95], v[204:207]
    v_mfma_f32_16x16x32_bf16 v[212:215], v[100:103], v[72:75], v[212:215]
    s_waitcnt lgkmcnt(3)
    v_mfma_f32_16x16x32_bf16 v[144:147], v[128:131], v[112:115], v[144:147]
    v_mfma_f32_16x16x32_bf16 v[148:151], v[132:135], v[112:115], v[148:151]
    s_cmp_eq_u32 s51, 4
    s_cbranch_scc1 L_p1_nw
    s_waitcnt vmcnt(0)
L_p1_nw:
    s_nop 0
    s_barrier
    v_mfma_f32_16x16x32_bf16 v[152:155], v[136:139], v[112:115], v[152:155]
    ds_read_b64_tr_b16 v[96:97], v68 offset:32768
    v_mfma_f32_16x16x32_bf16 v[156:159], v[140:143], v[112:115], v[156:159]
    ds_read_b64_tr_b16 v[98:99], v68 offset:33792
    s_waitcnt lgkmcnt(2)
    v_mfma_f32_16x16x32_bf16 v[160:163], v[128:131], v[116:119], v[160:163]
    ds_read_b128 v[80:83], v64 offset:32768
    v_mfma_f32_16x16x32_bf16 v[164:167], v[132:135], v[116:119], v[164:167]
    ds_read_b64_tr_b16 v[100:101], v69 offset:32768
    v_mfma_f32_16x16x32_bf16 v[168:171], v[136:139], v[116:119], v[168:171]
    ds_read_b64_tr_b16 v[102:103], v69 offset:33792
    v_mfma_f32_16x16x32_bf16 v[172:175], v[140:143], v[116:119], v[172:175]
    ds_read_b64_tr_b16 v[104:105], v70 offset:32768
    v_mfma_f32_16x16x32_bf16 v[176:179], v[128:131], v[120:123], v[176:179]
    ds_read_b64_tr_b16 v[106:107], v70 offset:33792
    v_mfma_f32_16x16x32_bf16 v[180:183], v[132:135], v[120:123], v[180:183]
    ds_read_b64_tr_b16 v[108:109], v71 offset:32768
    v_mfma_f32_16x16x32_bf16 v[184:187], v[136:139], v[120:123], v[184:187]
    ds_read_b64_tr_b16 v[110:111], v71 offset:33792
    v_mfma_f32_16x16x32_bf16 v[188:191], v[140:143], v[120:123], v[188:191]
    ds_read_b128 v[84:87], v64 offset:34816
    v_mfma_f32_16x16x32_bf16 v[192:195], v[128:131], v[124:127], v[192:195]
    ds_read_b128 v[88:91], v64 offset:36864
    v_mfma_f32_16x16x32_bf16 v[196:199], v[132:135], v[124:127], v[196:199]
    ds_read_b128 v[92:95], v64 offset:38912
    v_mfma_f32_16x16x32_bf16 v[208:211], v[128:131], v[72:75], v[208:211]
    v_mfma_f32_16x16x32_bf16 v[200:203], v[136:139], v[124:127], v[200:203]
    v_mfma_f32_16x16x32_bf16 v[204:207], v[140:143], v[124:127], v[204:207]
    v_mfma_f32_16x16x32_bf16 v[212:215], v[132:135], v[72:75], v[212:215]
    s_waitcnt lgkmcnt(3)
    v_mfma_f32_16x16x32_bf16 v[144:147], v[96:99], v[80:83], v[144:147]
    ds_read_b64_tr_b16 v[128:129], v68 offset:40960
    v_mfma_f32_16x16x32_bf16 v[148:151], v[100:103], v[80:83], v[148:151]
    ds_read_b64_tr_b16 v[130:131], v68 offset:41984
    v_mfma_f32_16x16x32_bf16 v[152:155], v[104:107], v[80:83], v[152:155]
    ds_read_b128 v[112:115], v65 offset:32768
    v_mfma_f32_16x16x32_bf16 v[156:159], v[108:111], v[80:83], v[156:159]
    ds_read_b64_tr_b16 v[132:133], v69 offset:40960
    s_waitcnt lgkmcnt(4)
    v_mfma_f32_16x16x32_bf16 v[160:163], v[96:99], v[84:87], v[160:163]
    ds_read_b64_tr_b16 v[134:135], v69 offset:41984
    v_mfma_f32_16x16x32_bf16 v[164:167], v[100:103], v[84:87], v[164:167]
    ds_read_b64_tr_b16 v[136:137], v70 offset:40960
    v_mfma_f32_16x16x32_bf16 v[168:171], v[104:107], v[84:87], v[168:171]
    ds_read_b64_tr_b16 v[138:139], v70 offset:41984
    v_mfma_f32_16x16x32_bf16 v[172:175], v[108:111], v[84:87], v[172:175]
    ds_read_b64_tr_b16 v[140:141], v71 offset:40960
    v_mfma_f32_16x16x32_bf16 v[176:179], v[96:99], v[88:91], v[176:179]
    ds_read_b64_tr_b16 v[142:143], v71 offset:41984
    v_mfma_f32_16x16x32_bf16 v[180:183], v[100:103], v[88:91], v[180:183]
    ds_read_b128 v[116:119], v65 offset:34816
    v_mfma_f32_16x16x32_bf16 v[184:187], v[104:107], v[88:91], v[184:187]
    ds_read_b128 v[120:123], v65 offset:36864
    v_mfma_f32_16x16x32_bf16 v[188:191], v[108:111], v[88:91], v[188:191]
    ds_read_b128 v[124:127], v65 offset:38912
    v_mfma_f32_16x16x32_bf16 v[192:195], v[96:99], v[92:95], v[192:195]
    v_xor_b32 v64, 65536, v64
    v_xor_b32 v65, 65536, v65
    v_mfma_f32_16x16x32_bf16 v[196:199], v[100:103], v[92:95], v[196:199]
    v_xor_b32 v68, 65536, v68
    v_xor_b32 v69, 65536, v69
    v_mfma_f32_16x16x32_bf16 v[208:211], v[96:99], v[72:75], v[208:211]
    v_mfma_f32_16x16x32_bf16 v[200:203], v[104:107], v[92:95], v[200:203]
    v_xor_b32 v70, 65536, v70
    v_mfma_f32_16x16x32_bf16 v[204:207], v[108:111], v[92:95], v[204:207]
    v_xor_b32 v71, 65536, v71
    v_mfma_f32_16x16x32_bf16 v[212:215], v[100:103], v[72:75], v[212:215]
    s_waitcnt lgkmcnt(3)
    v_mfma_f32_16x16x32_bf16 v[144:147], v[128:131], v[112:115], v[144:147]
    v_mfma_f32_16x16x32_bf16 v[148:151], v[132:135], v[112:115], v[148:151]
    s_barrier
    v_mfma_f32_16x16x32_bf16 v[152:155], v[136:139], v[112:115], v[152:155]
    ds_read_b64_tr_b16 v[96:97], v68 offset:0
    v_mfma_f32_16x16x32_bf16 v[156:159], v[140:143], v[112:115], v[156:159]
    ds_read_b64_tr_b16 v[98:99], v68 offset:1024
    s_waitcnt lgkmcnt(2)
    v_mfma_f32_16x16x32_bf16 v[160:163], v[128:131], v[116:119], v[160:163]
    ds_read_b128 v[80:83], v64 offset:0
    v_mfma_f32_16x16x32_bf16 v[164:167], v[132:135], v[116:119], v[164:167]
    ds_read_b64_tr_b16 v[100:101], v69 offset:0
    v_mfma_f32_16x16x32_bf16 v[168:171], v[136:139], v[116:119], v[168:171]
    ds_read_b64_tr_b16 v[102:103], v69 offset:1024
    v_mfma_f32_16x16x32_bf16 v[172:175], v[140:143], v[116:119], v[172:175]
    ds_read_b64_tr_b16 v[104:105], v70 offset:0
    v_mfma_f32_16x16x32_bf16 v[176:179], v[128:131], v[120:123], v[176:179]
    ds_read_b64_tr_b16 v[106:107], v70 offset:1024
    v_mfma_f32_16x16x32_bf16 v[180:183], v[132:135], v[120:123], v[180:183]
    ds_read_b64_tr_b16 v[108:109], v71 offset:0
    v_mfma_f32_16x16x32_bf16 v[184:187], v[136:139], v[120:123], v[184:187]
    ds_read_b64_tr_b16 v[110:111], v71 offset:1024
    v_mfma_f32_16x16x32_bf16 v[188:191], v[140:143], v[120:123], v[188:191]
    ds_read_b128 v[84:87], v64 offset:2048
    v_mfma_f32_16x16x32_bf16 v[192:195], v[128:131], v[124:127], v[192:195]
    ds_read_b128 v[88:91], v64 offset:4096
    v_mfma_f32_16x16x32_bf16 v[196:199], v[132:135], v[124:127], v[196:199]
    ds_read_b128 v[92:95], v64 offset:6144
    v_mfma_f32_16x16x32_bf16 v[208:211], v[128:131], v[72:75], v[208:211]
    v_mfma_f32_16x16x32_bf16 v[200:203], v[136:139], v[124:127], v[200:203]
    s_sub_u32 s51, s51, 1
    s_cmp_lg_u32 s51, 0
    v_mfma_f32_16x16x32_bf16 v[204:207], v[140:143], v[124:127], v[204:207]
    v_mfma_f32_16x16x32_bf16 v[212:215], v[132:135], v[72:75], v[212:215]
    s_cbranch_scc1 L_p1_loop0
    s_waitcnt lgkmcnt(3)
    v_mfma_f32_16x16x32_bf16 v[144:147], v[96:99], v[80:83], v[144:147]
    ds_read_b64_tr_b16 v[128:129], v68 offset:8192
    v_mfma_f32_16x16x32_bf16 v[148:151], v[100:103], v[80:83], v[148:151]
    ds_read_b64_tr_b16 v[130:131], v68 offset:9216
    v_mfma_f32_16x16x32_bf16 v[152:155], v[104:107], v[80:83], v[152:155]
    ds_read_b128 v[112:115], v65 offset:0
    v_mfma_f32_16x16x32_bf16 v[156:159], v[108:111], v[80:83], v[156:159]
    ds_read_b64_tr_b16 v[132:133], v69 offset:8192
    s_waitcnt lgkmcnt(4)
    v_mfma_f32_16x16x32_bf16 v[160:163], v[96:99], v[84:87], v[160:163]
    ds_read_b64_tr_b16 v[134:135], v69 offset:9216
    v_mfma_f32_16x16x32_bf16 v[164:167], v[100:103], v[84:87], v[164:167]
    ds_read_b64_tr_b16 v[136:137], v70 offset:8192
    v_mfma_f32_16x16x32_bf16 v[168:171], v[104:107], v[84:87], v[168:171]
    ds_read_b64_tr_b16 v[138:139], v70 offset:9216
    v_mfma_f32_16x16x32_bf16 v[172:175], v[108:111], v[84:87], v[172:175]
    ds_read_b64_tr_b16 v[140:141], v71 offset:8192
    v_mfma_f32_16x16x32_bf16 v[176:179], v[96:99], v[88:91], v[176:179]
    ds_read_b64_tr_b16 v[142:143], v71 offset:9216
    v_mfma_f32_16x16x32_bf16 v[180:183], v[100:103], v[88:91], v[180:183]
    ds_read_b128 v[116:119], v65 offset:2048
    v_mfma_f32_16x16x32_bf16 v[184:187], v[104:107], v[88:91], v[184:187]
    ds_read_b128 v[120:123], v65 offset:4096
    v_mfma_f32_16x16x32_bf16 v[188:191], v[108:111], v[88:91], v[188:191]
    ds_read_b128 v[124:127], v65 offset:6144
    v_mfma_f32_16x16x32_bf16 v[192:195], v[96:99], v[92:95], v[192:195]
    v_mfma_f32_16x16x32_bf16 v[196:199], v[100:103], v[92:95], v[196:199]
    v_mfma_f32_16x16x32_bf16 v[208:211], v[96:99], v[72:75], v[208:211]
    v_mfma_f32_16x16x32_bf16 v[200:203], v[104:107], v[92:95], v[200:203]
    v_mfma_f32_16x16x32_bf16 v[204:207], v[108:111], v[92:95], v[204:207]
    v_mfma_f32_16x16x32_bf16 v[212:215], v[100:103], v[72:75], v[212:215]
    s_waitcnt lgkmcnt(3)
    v_mfma_f32_16x16x32_bf16 v[144:147], v[128:131], v[112:115], v[144:147]
    v_mfma_f32_16x16x32_bf16 v[148:151], v[132:135], v[112:115], v[148:151]
    s_barrier
    v_mfma_f32_16x16x32_bf16 v[152:155], v[136:139], v[112:115], v[152:155]
    ds_read_b64_tr_b16 v[96:97], v68 offset:32768
    v_mfma_f32_16x16x32_bf16 v[156:159], v[140:143], v[112:115], v[156:159]
    ds_read_b64_tr_b16 v[98:99], v68 offset:33792
    s_waitcnt lgkmcnt(2)
    v_mfma_f32_16x16x32_bf16 v[160:163], v[128:131], v[116:119], v[160:163]
    ds_read_b128 v[80:83], v64 offset:32768
    v_mfma_f32_16x16x32_bf16 v[164:167], v[132:135], v[116:119], v[164:167]
    ds_read_b64_tr_b16 v[100:101], v69 offset:32768
    v_mfma_f32_16x16x32_bf16 v[168:171], v[136:139], v[116:119], v[168:171]
    ds_read_b64_tr_b16 v[102:103], v69 offset:33792
    v_mfma_f32_16x16x32_bf16 v[172:175], v[140:143], v[116:119], v[172:175]
    ds_read_b64_tr_b16 v[104:105], v70 offset:32768
    v_mfma_f32_16x16x32_bf16 v[176:179], v[128:131], v[120:123], v[176:179]
    ds_read_b64_tr_b16 v[106:107], v70 offset:33792
    v_mfma_f32_16x16x32_bf16 v[180:183], v[132:135], v[120:123], v[180:183]
    ds_read_b64_tr_b16 v[108:109], v71 offset:32768
    v_mfma_f32_16x16x32_bf16 v[184:187], v[136:139], v[120:123], v[184:187]
    ds_read_b64_tr_b16 v[110:111], v71 offset:33792
    v_mfma_f32_16x16x32_bf16 v[188:191], v[140:143], v[120:123], v[188:191]
    ds_read_b128 v[84:87], v64 offset:34816
    v_mfma_f32_16x16x32_bf16 v[192:195], v[128:131], v[124:127], v[192:195]
    ds_read_b128 v[88:91], v64 offset:36864
    v_mfma_f32_16x16x32_bf16 v[196:199], v[132:135], v[124:127], v[196:199]
    ds_read_b128 v[92:95], v64 offset:38912
    v_mfma_f32_16x16x32_bf16 v[208:211], v[128:131], v[72:75], v[208:211]
    v_mfma_f32_16x16x32_bf16 v[200:203], v[136:139], v[124:127], v[200:203]
    v_mfma_f32_16x16x32_bf16 v[204:207], v[140:143], v[124:127], v[204:207]
    v_mfma_f32_16x16x32_bf16 v[212:215], v[132:135], v[72:75], v[212:215]
    s_waitcnt lgkmcnt(3)
    v_mfma_f32_16x16x32_bf16 v[144:147], v[96:99], v[80:83], v[144:147]
    ds_read_b64_tr_b16 v[128:129], v68 offset:40960
    v_mfma_f32_16x16x32_bf16 v[148:151], v[100:103], v[80:83], v[148:151]
    ds_read_b64_tr_b16 v[130:131], v68 offset:41984
    v_mfma_f32_16x16x32_bf16 v[152:155], v[104:107], v[80:83], v[152:155]
    ds_read_b128 v[112:115], v65 offset:32768
    v_mfma_f32_16x16x32_bf16 v[156:159], v[108:111], v[80:83], v[156:159]
    ds_read_b64_tr_b16 v[132:133], v69 offset:40960
    s_waitcnt lgkmcnt(4)
    v_mfma_f32_16x16x32_bf16 v[160:163], v[96:99], v[84:87], v[160:163]
    ds_read_b64_tr_b16 v[134:135], v69 offset:41984
    v_mfma_f32_16x16x32_bf16 v[164:167], v[100:103], v[84:87], v[164:167]
    ds_read_b64_tr_b16 v[136:137], v70 offset:40960
    v_mfma_f32_16x16x32_bf16 v[168:171], v[104:107], v[84:87], v[168:171]
    ds_read_b64_tr_b16 v[138:139], v70 offset:41984
    v_mfma_f32_16x16x32_bf16 v[172:175], v[108:111], v[84:87], v[172:175]
    ds_read_b64_tr_b16 v[140:141], v71 offset:40960
    v_mfma_f32_16x16x32_bf16 v[176:179], v[96:99], v[88:91], v[176:179]
    ds_read_b64_tr_b16 v[142:143], v71 offset:41984
    v_mfma_f32_16x16x32_bf16 v[180:183], v[100:103], v[88:91], v[180:183]
    ds_read_b128 v[116:119], v65 offset:34816
    v_mfma_f32_16x16x32_bf16 v[184:187], v[104:107], v[88:91], v[184:187]
    ds_read_b128 v[120:123], v65 offset:36864
    v_mfma_f32_16x16x32_bf16 v[188:191], v[108:111], v[88:91], v[188:191]
    ds_read_b128 v[124:127], v65 offset:38912
    v_mfma_f32_16x16x32_bf16 v[192:195], v[96:99], v[92:95], v[192:195]
    v_mfma_f32_16x16x32_bf16 v[196:199], v[100:103], v[92:95], v[196:199]
    v_mfma_f32_16x16x32_bf16 v[208:211], v[96:99], v[72:75], v[208:211]
    v_mfma_f32_16x16x32_bf16 v[200:203], v[104:107], v[92:95], v[200:203]
    v_mfma_f32_16x16x32_bf16 v[204:207], v[108:111], v[92:95], v[204:207]
    v_mfma_f32_16x16x32_bf16 v[212:215], v[100:103], v[72:75], v[212:215]
    s_waitcnt lgkmcnt(0)
    v_mfma_f32_16x16x32_bf16 v[208:211], v[128:131], v[72:75], v[208:211]
    v_mfma_f32_16x16x32_bf16 v[212:215], v[132:135], v[72:75], v[212:215]
    v_mfma_f32_16x16x32_bf16 v[144:147], v[128:131], v[112:115], v[144:147]
    v_mfma_f32_16x16x32_bf16 v[160:163], v[128:131], v[116:119], v[160:163]
    v_mfma_f32_16x16x32_bf16 v[176:179], v[128:131], v[120:123], v[176:179]
    v_mfma_f32_16x16x32_bf16 v[192:195], v[128:131], v[124:127], v[192:195]
    s_mov_b32 exec_lo, 0x00010001
    s_mov_b32 exec_hi, 0x00010001
    s_nop 0
    ds_write_b128 v77, v[208:211] offset:0
    ds_write_b128 v77, v[212:215] offset:64
    s_mov_b64 exec, -1
    v_mfma_f32_16x16x32_bf16 v[148:151], v[132:135], v[112:115], v[148:151]
    v_mfma_f32_16x16x32_bf16 v[164:167], v[132:135], v[116:119], v[164:167]
    v_mfma_f32_16x16x32_bf16 v[180:183], v[132:135], v[120:123], v[180:183]
    v_mfma_f32_16x16x32_bf16 v[196:199], v[132:135], v[124:127], v[196:199]
    s_waitcnt lgkmcnt(0)
    s_barrier
    v_mfma_f32_16x16x32_bf16 v[152:155], v[136:139], v[112:115], v[152:155]
    ds_read_b64 v[80:81], v76 offset:0
    v_mfma_f32_16x16x32_bf16 v[168:171], v[136:139], v[116:119], v[168:171]
    ds_read_b64 v[82:83], v76 offset:128
    v_mfma_f32_16x16x32_bf16 v[184:187], v[136:139], v[120:123], v[184:187]
    ds_read_b64 v[84:85], v76 offset:256
    v_mfma_f32_16x16x32_bf16 v[200:203], v[136:139], v[124:127], v[200:203]
    ds_read_b64 v[86:87], v76 offset:384
    v_mfma_f32_16x16x32_bf16 v[156:159], v[140:143], v[112:115], v[156:159]
    ds_read_b128 v[216:219], v79 offset:0
    v_mfma_f32_16x16x32_bf16 v[172:175], v[140:143], v[116:119], v[172:175]
    ds_read_b128 v[220:223], v79 offset:64
    v_mfma_f32_16x16x32_bf16 v[188:191], v[140:143], v[120:123], v[188:191]
    v_mfma_f32_16x16x32_bf16 v[204:207], v[140:143], v[124:127], v[204:207]
    s_waitcnt lgkmcnt(0)
    .p2align 3
    v_pk_fma_f32 v[144:145], v[208:209], v[80:81], v[144:145] op_sel_hi:[1,0,1] neg_lo:[0,1,0] neg_hi:[0,1,0]
    v_pk_fma_f32 v[146:147], v[210:211], v[80:81], v[146:147] op_sel_hi:[1,0,1] neg_lo:[0,1,0] neg_hi:[0,1,0]
    v_pk_fma_f32 v[160:161], v[208:209], v[82:83], v[160:161] op_sel_hi:[1,0,1] neg_lo:[0,1,0] neg_hi:[0,1,0]
    v_pk_fma_f32 v[162:163], v[210:211], v[82:83], v[162:163] op_sel_hi:[1,0,1] neg_lo:[0,1,0] neg_hi:[0,1,0]
    v_pk_mul_f32 v[144:145], v[144:145], v[80:81] op_sel:[0,1] op_sel_hi:[1,1]
    v_pk_mul_f32 v[146:147], v[146:147], v[80:81] op_sel:[0,1] op_sel_hi:[1,1]
    v_pk_mul_f32 v[160:161], v[160:161], v[82:83] op_sel:[0,1] op_sel_hi:[1,1]
    v_pk_mul_f32 v[162:163], v[162:163], v[82:83] op_sel:[0,1] op_sel_hi:[1,1]
    v_cvt_pk_bf16_f32 v104, v144, v145
    v_cvt_pk_bf16_f32 v106, v160, v161
    v_cvt_pk_bf16_f32 v105, v146, v147
    v_cvt_pk_bf16_f32 v107, v162, v163
    v_permlane16_swap_b32 v104, v106
    s_nop 0
    v_permlane16_swap_b32 v105, v107
    s_nop 0
    buffer_store_dwordx4 v[104:107], v66, s[4:7], s50 offen offset:0 sc1
    v_pk_fma_f32 v[176:177], v[208:209], v[84:85], v[176:177] op_sel_hi:[1,0,1] neg_lo:[0,1,0] neg_hi:[0,1,0]
    v_pk_fma_f32 v[178:179], v[210:211], v[84:85], v[178:179] op_sel_hi:[1,0,1] neg_lo:[0,1,0] neg_hi:[0,1,0]
    v_pk_fma_f32 v[192:193], v[208:209], v[86:87], v[192:193] op_sel_hi:[1,0,1] neg_lo:[0,1,0] neg_hi:[0,1,0]
    v_pk_fma_f32 v[194:195], v[210:211], v[86:87], v[194:195] op_sel_hi:[1,0,1] neg_lo:[0,1,0] neg_hi:[0,1,0]
    v_pk_mul_f32 v[176:177], v[176:177], v[84:85] op_sel:[0,1] op_sel_hi:[1,1]
    v_pk_mul_f32 v[178:179], v[178:179], v[84:85] op_sel:[0,1] op_sel_hi:[1,1]
    v_pk_mul_f32 v[192:193], v[192:193], v[86:87] op_sel:[0,1] op_sel_hi:[1,1]
    v_pk_mul_f32 v[194:195], v[194:195], v[86:87] op_sel:[0,1] op_sel_hi:[1,1]
    v_cvt_pk_bf16_f32 v108, v176, v177
    v_cvt_pk_bf16_f32 v110, v192, v193
    v_cvt_pk_bf16_f32 v109, v178, v179
    v_cvt_pk_bf16_f32 v111, v194, v195
    v_permlane16_swap_b32 v108, v110
    s_nop 0
    v_permlane16_swap_b32 v109, v111
    s_nop 0
    buffer_store_dwordx4 v[108:111], v66, s[4:7], s50 offen offset:512 sc1
    s_add_u32 s50, s50, 65536
    v_pk_fma_f32 v[148:149], v[212:213], v[80:81], v[148:149] op_sel_hi:[1,0,1] neg_lo:[0,1,0] neg_hi:[0,1,0]
    v_pk_fma_f32 v[150:151], v[214:215], v[80:81], v[150:151] op_sel_hi:[1,0,1] neg_lo:[0,1,0] neg_hi:[0,1,0]
    v_pk_fma_f32 v[164:165], v[212:213], v[82:83], v[164:165] op_sel_hi:[1,0,1] neg_lo:[0,1,0] neg_hi:[0,1,0]
    v_pk_fma_f32 v[166:167], v[214:215], v[82:83], v[166:167] op_sel_hi:[1,0,1] neg_lo:[0,1,0] neg_hi:[0,1,0]
    v_pk_mul_f32 v[148:149], v[148:149], v[80:81] op_sel:[0,1] op_sel_hi:[1,1]
    v_pk_mul_f32 v[150:151], v[150:151], v[80:81] op_sel:[0,1] op_sel_hi:[1,1]
    v_pk_mul_f32 v[164:165], v[164:165], v[82:83] op_sel:[0,1] op_sel_hi:[1,1]
    v_pk_mul_f32 v[166:167], v[166:167], v[82:83] op_sel:[0,1] op_sel_hi:[1,1]
    v_cvt_pk_bf16_f32 v112, v148, v149
    v_cvt_pk_bf16_f32 v114, v164, v165
    v_cvt_pk_bf16_f32 v113, v150, v151
    v_cvt_pk_bf16_f32 v115, v166, v167
    v_permlane16_swap_b32 v112, v114
    s_nop 0
    v_permlane16_swap_b32 v113, v115
    s_nop 0
    buffer_store_dwordx4 v[112:115], v66, s[4:7], s50 offen offset:0 sc1
    v_pk_fma_f32 v[180:181], v[212:213], v[84:85], v[180:181] op_sel_hi:[1,0,1] neg_lo:[0,1,0] neg_hi:[0,1,0]
    v_pk_fma_f32 v[182:183], v[214:215], v[84:85], v[182:183] op_sel_hi:[1,0,1] neg_lo:[0,1,0] neg_hi:[0,1,0]
    v_pk_fma_f32 v[196:197], v[212:213], v[86:87], v[196:197] op_sel_hi:[1,0,1] neg_lo:[0,1,0] neg_hi:[0,1,0]
    v_pk_fma_f32 v[198:199], v[214:215], v[86:87], v[198:199] op_sel_hi:[1,0,1] neg_lo:[0,1,0] neg_hi:[0,1,0]
    v_pk_mul_f32 v[180:181], v[180:181], v[84:85] op_sel:[0,1] op_sel_hi:[1,1]
    v_pk_mul_f32 v[182:183], v[182:183], v[84:85] op_sel:[0,1] op_sel_hi:[1,1]
    v_pk_mul_f32 v[196:197], v[196:197], v[86:87] op_sel:[0,1] op_sel_hi:[1,1]
    v_pk_mul_f32 v[198:199], v[198:199], v[86:87] op_sel:[0,1] op_sel_hi:[1,1]
    v_cvt_pk_bf16_f32 v116, v180, v181
    v_cvt_pk_bf16_f32 v118, v196, v197
    v_cvt_pk_bf16_f32 v117, v182, v183
    v_cvt_pk_bf16_f32 v119, v198, v199
    v_permlane16_swap_b32 v116, v118
    s_nop 0
    v_permlane16_swap_b32 v117, v119
    s_nop 0
    buffer_store_dwordx4 v[116:119], v66, s[4:7], s50 offen offset:512 sc1
    s_add_u32 s50, s50, s52
    s_nop 0
    v_pk_fma_f32 v[152:153], v[216:217], v[80:81], v[152:153] op_sel_hi:[1,0,1] neg_lo:[0,1,0] neg_hi:[0,1,0]
    v_pk_fma_f32 v[154:155], v[218:219], v[80:81], v[154:155] op_sel_hi:[1,0,1] neg_lo:[0,1,0] neg_hi:[0,1,0]
    v_pk_fma_f32 v[168:169], v[216:217], v[82:83], v[168:169] op_sel_hi:[1,0,1] neg_lo:[0,1,0] neg_hi:[0,1,0]
    v_pk_fma_f32 v[170:171], v[218:219], v[82:83], v[170:171] op_sel_hi:[1,0,1] neg_lo:[0,1,0] neg_hi:[0,1,0]
    v_pk_mul_f32 v[152:153], v[152:153], v[80:81] op_sel:[0,1] op_sel_hi:[1,1]
    v_pk_mul_f32 v[154:155], v[154:155], v[80:81] op_sel:[0,1] op_sel_hi:[1,1]
    v_pk_mul_f32 v[168:169], v[168:169], v[82:83] op_sel:[0,1] op_sel_hi:[1,1]
    v_pk_mul_f32 v[170:171], v[170:171], v[82:83] op_sel:[0,1] op_sel_hi:[1,1]
    v_cvt_pk_bf16_f32 v120, v152, v153
    v_cvt_pk_bf16_f32 v122, v168, v169
    v_cvt_pk_bf16_f32 v121, v154, v155
    v_cvt_pk_bf16_f32 v123, v170, v171
    v_permlane16_swap_b32 v120, v122
    s_nop 0
    v_permlane16_swap_b32 v121, v123
    s_nop 0
    buffer_store_dwordx4 v[120:123], v66, s[4:7], s50 offen offset:0 sc1
    v_pk_fma_f32 v[184:185], v[216:217], v[84:85], v[184:185] op_sel_hi:[1,0,1] neg_lo:[0,1,0] neg_hi:[0,1,0]
    v_pk_fma_f32 v[186:187], v[218:219], v[84:85], v[186:187] op_sel_hi:[1,0,1] neg_lo:[0,1,0] neg_hi:[0,1,0]
    v_pk_fma_f32 v[200:201], v[216:217], v[86:87], v[200:201] op_sel_hi:[1,0,1] neg_lo:[0,1,0] neg_hi:[0,1,0]
    v_pk_fma_f32 v[202:203], v[218:219], v[86:87], v[202:203] op_sel_hi:[1,0,1] neg_lo:[0,1,0] neg_hi:[0,1,0]
    v_pk_mul_f32 v[184:185], v[184:185], v[84:85] op_sel:[0,1] op_sel_hi:[1,1]
    v_pk_mul_f32 v[186:187], v[186:187], v[84:85] op_sel:[0,1] op_sel_hi:[1,1]
    v_pk_mul_f32 v[200:201], v[200:201], v[86:87] op_sel:[0,1] op_sel_hi:[1,1]
    v_pk_mul_f32 v[202:203], v[202:203], v[86:87] op_sel:[0,1] op_sel_hi:[1,1]
    v_cvt_pk_bf16_f32 v124, v184, v185
    v_cvt_pk_bf16_f32 v126, v200, v201
    v_cvt_pk_bf16_f32 v125, v186, v187
    v_cvt_pk_bf16_f32 v127, v202, v203
    v_permlane16_swap_b32 v124, v126
    s_nop 0
    v_permlane16_swap_b32 v125, v127
    s_nop 0
    buffer_store_dwordx4 v[124:127], v66, s[4:7], s50 offen offset:512 sc1
    s_add_u32 s50, s50, 65536
    v_pk_fma_f32 v[156:157], v[220:221], v[80:81], v[156:157] op_sel_hi:[1,0,1] neg_lo:[0,1,0] neg_hi:[0,1,0]
    v_pk_fma_f32 v[158:159], v[222:223], v[80:81], v[158:159] op_sel_hi:[1,0,1] neg_lo:[0,1,0] neg_hi:[0,1,0]
    v_pk_fma_f32 v[172:173], v[220:221], v[82:83], v[172:173] op_sel_hi:[1,0,1] neg_lo:[0,1,0] neg_hi:[0,1,0]
    v_pk_fma_f32 v[174:175], v[222:223], v[82:83], v[174:175] op_sel_hi:[1,0,1] neg_lo:[0,1,0] neg_hi:[0,1,0]
    v_pk_mul_f32 v[156:157], v[156:157], v[80:81] op_sel:[0,1] op_sel_hi:[1,1]
    v_pk_mul_f32 v[158:159], v[158:159], v[80:81] op_sel:[0,1] op_sel_hi:[1,1]
    v_pk_mul_f32 v[172:173], v[172:173], v[82:83] op_sel:[0,1] op_sel_hi:[1,1]
    v_pk_mul_f32 v[174:175], v[174:175], v[82:83] op_sel:[0,1] op_sel_hi:[1,1]
    v_cvt_pk_bf16_f32 v128, v156, v157
    v_cvt_pk_bf16_f32 v130, v172, v173
    v_cvt_pk_bf16_f32 v129, v158, v159
    v_cvt_pk_bf16_f32 v131, v174, v175
    v_permlane16_swap_b32 v128, v130
    s_nop 0
    v_permlane16_swap_b32 v129, v131
    s_nop 0
    buffer_store_dwordx4 v[128:131], v66, s[4:7], s50 offen offset:0 sc1
    v_pk_fma_f32 v[188:189], v[220:221], v[84:85], v[188:189] op_sel_hi:[1,0,1] neg_lo:[0,1,0] neg_hi:[0,1,0]
    v_pk_fma_f32 v[190:191], v[222:223], v[84:85], v[190:191] op_sel_hi:[1,0,1] neg_lo:[0,1,0] neg_hi:[0,1,0]
    v_pk_fma_f32 v[204:205], v[220:221], v[86:87], v[204:205] op_sel_hi:[1,0,1] neg_lo:[0,1,0] neg_hi:[0,1,0]
    v_pk_fma_f32 v[206:207], v[222:223], v[86:87], v[206:207] op_sel_hi:[1,0,1] neg_lo:[0,1,0] neg_hi:[0,1,0]
    v_pk_mul_f32 v[188:189], v[188:189], v[84:85] op_sel:[0,1] op_sel_hi:[1,1]
    v_pk_mul_f32 v[190:191], v[190:191], v[84:85] op_sel:[0,1] op_sel_hi:[1,1]
    v_pk_mul_f32 v[204:205], v[204:205], v[86:87] op_sel:[0,1] op_sel_hi:[1,1]
    v_pk_mul_f32 v[206:207], v[206:207], v[86:87] op_sel:[0,1] op_sel_hi:[1,1]
    v_cvt_pk_bf16_f32 v132, v188, v189
    v_cvt_pk_bf16_f32 v134, v204, v205
    v_cvt_pk_bf16_f32 v133, v190, v191
    v_cvt_pk_bf16_f32 v135, v206, v207
    v_permlane16_swap_b32 v132, v134
    s_nop 0
    v_permlane16_swap_b32 v133, v135
    s_nop 0
    buffer_store_dwordx4 v[132:135], v66, s[4:7], s50 offen offset:512 sc1
L_p1_join:
    s_nop 2
    s_cmp_eq_u32 s0, 1
    s_cbranch_scc1 L_p1_fin
L_p2_pre:
    s_and_b32 s40, s2, 7
    s_lshl_b32 s40, s40, 1
    s_bfe_u32 s41, s2, 0x10003
    s_add_u32 s40, s40, s41
    s_lshr_b32 s41, s2, 4
    s_mul_i32 s42, s40, 5
    s_lshr_b32 s43, s3, 2
    s_mul_i32 s44, s43, 3
    s_add_u32 s46, s42, 4
    s_lshr_b32 s46, s46, 4
    s_lshr_b32 s47, s42, 4
    s_sub_u32 s46, s46, s47
    s_add_u32 s46, s46, 1
    s_min_u32 s47, s41, 2
    s_add_u32 s47, s47, 1
    s_mul_i32 s48, s46, s47
    s_add_u32 s46, s46, s48
    s_lshl_b32 s47, s41, 4
    s_add_u32 s47, s47, s40
    s_lshl_b32 s47, s47, 7
    s_add_u32 s47, s47, 4
    s_bfe_u32 s58, s2, 0x20001
    s_add_u32 s61, s58, 108
    s_mul_i32 s58, s58, 27
    s_lshr_b32 s59, s2, 3
    s_add_u32 s60, s58, s59
    s_cmp_ge_u32 s2, 216
    s_cselect_b32 s60, s61, s60
    s_mul_i32 s58, s60, 13108
    s_lshr_b32 s58, s58, 16
    s_mul_i32 s59, s58, 5
    s_sub_u32 s61, s60, s59
    s_and_b32 s59, s2, 1
    s_mul_i32 s59, s59, 5
    s_add_u32 s59, s59, s61
    v_lshrrev_b32 v5, 3, v1
    v_mul_u32_u24 v224, 1280, v5
    v_and_b32 v5, 2, v5
    v_and_b32 v6, 7, v1
    v_xor_b32 v5, v5, v6
    v_lshl_add_u32 v224, v5, 4, v224
    s_and_b32 s60, s3, 1
    s_lshl_b32 s61, s60, 6
    v_xor_b32 v224, s61, v224
    v_lshrrev_b32 v5, 5, v1
    v_mul_u32_u24 v5, 46080, v5
    v_add_u32 v225, v224, v5
    s_lshl_b32 s59, s59, 7
    s_lshr_b32 s61, s3, 1
    s_mul_i32 s61, s61, 5
    s_add_u32 s60, s60, s61
    s_mul_i32 s60, s60, 10240
    s_add_u32 s60, s60, s59
    s_mul_i32 s61, s3, 102400
    s_add_u32 s61, s61, s59
    s_lshl_b32 s59, s3, 10
    s_cmp_ge_i32 s1, 0
    s_cselect_b32 s60, 1073741816, s60
    s_cselect_b32 s61, 1073741816, s61
    v_and_b32 v2, 31, v1
    v_lshrrev_b32 v3, 5, v1
    v_lshlrev_b32 v4, 4, v1
    s_lshl_b32 s50, s41, 1
    s_add_u32 s50, s50, s3
    s_cmp_lt_u32 s50, 4
    s_mov_b32 s51, 0x3f803f80
    s_cselect_b32 s50, 0x3f80ff7f, s51
    s_cmp_eq_u32 s3, 7
    s_cselect_b32 s50, 0, s50
    s_cselect_b32 s51, 0, s51
    v_mov_b32 v8, s50
    v_mov_b32 v9, s51
    v_mov_b32 v10, s51
    v_mov_b32 v11, s51
    s_lshl_b32 s49, s3, 10
    s_add_u32 s50, s49, 156288
    v_add_u32 v5, s50, v4
    v_min_u32 v5, 163824, v5
    ds_write_b128 v5, v[8:11]
    s_cmp_lt_u32 s41, 2
    s_cselect_b32 s50, 0xbf803f80, 0
    v_mul_lo_u32 v15, s50, v3
    v_lshlrev_b32 v5, 2, v3
    v_sub_u32 v5, v2, v5
    v_cmp_le_i32 s[64:65], 0, v5
    v_cmp_le_i32 s[66:67], 1, v5
    v_cmp_le_i32 s[68:69], 2, v5
    v_cmp_le_i32 s[70:71], 3, v5
    v_cmp_le_i32 s[72:73], 8, v5
    v_cmp_le_i32 s[74:75], 9, v5
    v_cmp_le_i32 s[76:77], 10, v5
    v_cmp_le_i32 s[78:79], 11, v5
    v_cmp_le_i32 s[80:81], 16, v5
    v_cmp_le_i32 s[82:83], 17, v5
    v_cmp_le_i32 s[84:85], 18, v5
    v_cmp_le_i32 s[86:87], 19, v5
    v_cmp_le_i32 s[88:89], 24, v5
    v_cmp_le_i32 s[90:91], 25, v5
    v_cmp_le_i32 s[92:93], 26, v5
    v_cmp_le_i32 s[94:95], 27, v5
    v_mov_b32 v6, 0xffff
    v_mov_b32 v7, 0xffff0000
    v_cndmask_b32 v52, 0, v6, s[64:65]
    v_cndmask_b32 v8, 0, v7, s[66:67]
    v_or_b32 v52, v52, v8
    v_cndmask_b32 v53, 0, v6, s[68:69]
    v_cndmask_b32 v8, 0, v7, s[70:71]
    v_or_b32 v53, v53, v8
    v_cndmask_b32 v54, 0, v6, s[72:73]
    v_cndmask_b32 v8, 0, v7, s[74:75]
    v_or_b32 v54, v54, v8
    v_cndmask_b32 v55, 0, v6, s[76:77]
    v_cndmask_b32 v8, 0, v7, s[78:79]
    v_or_b32 v55, v55, v8
    v_cndmask_b32 v56, 0, v6, s[80:81]
    v_cndmask_b32 v8, 0, v7, s[82:83]
    v_or_b32 v56, v56, v8
    v_cndmask_b32 v57, 0, v6, s[84:85]
    v_cndmask_b32 v8, 0, v7, s[86:87]
    v_or_b32 v57, v57, v8
    v_cndmask_b32 v58, 0, v6, s[88:89]
    v_cndmask_b32 v8, 0, v7, s[90:91]
    v_or_b32 v58, v58, v8
    v_cndmask_b32 v59, 0, v6, s[92:93]
    v_cndmask_b32 v8, 0, v7, s[94:95]
    v_or_b32 v59, v59, v8
    s_lshl_b32 s50, s97, 9
    s_add_u32 s50, s50, 94208
    v_lshl_add_u32 v13, v2, 4, s50
    v_mul_u32_u24 v12, 6208, v3
    v_lshl_add_u32 v5, v12, 3, v13
    s_mul_i32 s51, s44, 6208
    v_add3_u32 v12, v12, v13, s51
    v_add_u32 v13, 12416, v5
    v_bfe_u32 v5, v1, 2, 2
    v_lshl_add_u32 v5, v3, 2, v5
    v_lshl_add_u32 v14, v5, 4, s50
    v_and_b32 v5, 1, v1
    v_bfe_u32 v6, v1, 1, 1
    v_mov_b32 v7, s43
    v_cmp_eq_u32 vcc, 1, v6
    s_nop 1
    v_cndmask_b32 v7, v7, v5, vcc
    s_lshl_b32 s52, s43, 7
    s_sub_u32 s52, 31168, s52
    v_mov_b32 v8, 12416
    v_mov_b32 v9, s52
    v_cndmask_b32 v8, v8, v9, vcc
    v_mul_u32_u24 v10, 6208, v5
    v_add_u32 v10, s51, v10
    v_and_b32 v9, 16, v1
    v_cmp_eq_u32 vcc, 0, v9
    s_nop 1
    v_cndmask_b32 v8, v8, v10, vcc
    v_cndmask_b32 v7, v7, v6, vcc
    v_lshl_add_u32 v8, v7, 3, v8
    v_add_u32 v14, v14, v8
    v_add_u32 v14, 31040, v14
    s_lshl_b32 s50, s41, 1
    s_add_u32 s50, s50, s3
    s_sub_u32 s50, s50, 4
    s_max_i32 s50, s50, 0
    s_lshl_b32 s50, s50, 10
    s_lshl_b32 s51, s42, 15
    s_add_u32 s51, s51, s50
    s_add_u32 s51, s51, 3670016
    s_add_u32 s49, s49, 94208
    s_lshl_b32 s53, s41, 2
    s_add_u32 s53, s53, s97
    s_lshl_b32 s54, s53, 9
    s_lshl_b32 s56, s42, 15
    s_add_u32 s54, s54, s56
    s_add_u32 s54, s54, 1048576
    s_lshl_b32 s55, s44, 15
    s_add_u32 s55, s55, s54
    s_add_u32 s56, s54, 65536
    v_lshlrev_b32 v5, 15, v3
    v_lshl_add_u32 v5, v2, 4, v5
    v_lshlrev_b32 v6, 4, v2
    v_mov_b32 v8, 2147483632
    v_add_u32 v9, s43, v3
    v_cmp_eq_u32 vcc, 0, v9
    s_nop 1
    v_cndmask_b32 v7, v8, v6, vcc
    v_cmp_gt_u32 vcc, s43, v3
    s_nop 1
    v_cndmask_b32 v6, v8, v6, vcc
    s_cmp_eq_u32 s0, 1
    s_cbranch_scc1 L_p2_poll
    s_cmp_eq_u32 s98, 0
    s_cbranch_scc1 L_p1_nov
    buffer_store_dwordx4 v[104:107], v78, s[4:7], s98 offen offset:0 sc1
    buffer_store_dwordx4 v[108:111], v78, s[4:7], s98 offen offset:512 sc1
    s_add_u32 s98, s98, 65536
    buffer_store_dwordx4 v[112:115], v78, s[4:7], s98 offen offset:0 sc1
    buffer_store_dwordx4 v[116:119], v78, s[4:7], s98 offen offset:512 sc1
    s_add_u32 s98, s98, s99
    buffer_store_dwordx4 v[120:123], v78, s[4:7], s98 offen offset:0 sc1
    buffer_store_dwordx4 v[124:127], v78, s[4:7], s98 offen offset:512 sc1
    s_add_u32 s98, s98, 65536
    buffer_store_dwordx4 v[128:131], v78, s[4:7], s98 offen offset:0 sc1
    buffer_store_dwordx4 v[132:135], v78, s[4:7], s98 offen offset:512 sc1
L_p1_nov:
    s_cmp_lg_u32 s0, 2
    s_cbranch_scc1 L_p1_fin
    s_cmp_lg_u32 s3, 5
    s_cbranch_scc1 L_p1_fin
    v_mov_b32 v8, 0
    s_mov_b64 exec, 1
    v_mov_b32 v248, 0
    buffer_atomic_add v248, v8, s[4:7], s47 offen sc0 sc1
    s_sleep 3
    v_mov_b32 v249, 0
    buffer_atomic_add v249, v8, s[4:7], s47 offen sc0 sc1
    s_sleep 3
Lpoll_4:
    v_mov_b32 v250, 0
    buffer_atomic_add v250, v8, s[4:7], s47 offen sc0 sc1
    s_waitcnt vmcnt(2)
    v_cmp_ne_u32 vcc, s46, v248
    s_cbranch_vccz Lpoll_4d
    v_mov_b32 v248, 0
    buffer_atomic_add v248, v8, s[4:7], s47 offen sc0 sc1
    s_waitcnt vmcnt(2)
    v_cmp_ne_u32 vcc, s46, v249
    s_cbranch_vccz Lpoll_4d
    v_mov_b32 v249, 0
    buffer_atomic_add v249, v8, s[4:7], s47 offen sc0 sc1
    s_waitcnt vmcnt(2)
    v_cmp_ne_u32 vcc, s46, v250
    s_cbranch_vccz Lpoll_4d
    s_sub_u32 s96, s96, 1
    s_cbranch_scc0 Lpoll_4
    s_mov_b32 s96, 0
Lpoll_4d:
    s_mov_b64 exec, -1
    s_branch L_p1_fin2
L_p1_fin:
    s_waitcnt vmcnt(0)
L_p1_fin2:
    s_barrier
    s_cmp_eq_u64 s[62:63], 0
    s_cbranch_scc1 Lfin_5
    v_mov_b32 v246, 1
    s_mov_b64 exec, s[62:63]
    buffer_atomic_add v246, v247, s[4:7], 0 offen offset:4 sc1
    s_mov_b64 exec, -1
Lfin_5:
    s_cmp_eq_u32 s0, 1
    s_cbranch_scc1 L_p2_pre
L_p2_poll:
    s_cmp_eq_u32 s0, 2
    s_cbranch_scc1 L_p2_polled
    s_cmp_lg_u32 s3, 5
    s_cbranch_scc1 L_p2_polled
    v_mov_b32 v8, 0
    s_mov_b64 exec, 1
    v_mov_b32 v248, 0
    buffer_atomic_add v248, v8, s[4:7], s47 offen sc0 sc1
    s_sleep 3
    v_mov_b32 v249, 0
    buffer_atomic_add v249, v8, s[4:7], s47 offen sc0 sc1
    s_sleep 3
Lpoll_6:
    v_mov_b32 v250, 0
    buffer_atomic_add v250, v8, s[4:7], s47 offen sc0 sc1
    s_waitcnt vmcnt(2)
    v_cmp_ne_u32 vcc, s46, v248
    s_cbranch_vccz Lpoll_6d
    v_mov_b32 v248, 0
    buffer_atomic_add v248, v8, s[4:7], s47 offen sc0 sc1
    s_waitcnt vmcnt(2)
    v_cmp_ne_u32 vcc, s46, v249
    s_cbranch_vccz Lpoll_6d
    v_mov_b32 v249, 0
    buffer_atomic_add v249, v8, s[4:7], s47 offen sc0 sc1
    s_waitcnt vmcnt(2)
    v_cmp_ne_u32 vcc, s46, v250
    s_cbranch_vccz Lpoll_6d
    s_sub_u32 s96, s96, 1
    s_cbranch_scc0 Lpoll_6
    s_mov_b32 s96, 0
Lpoll_6d:
    s_mov_b64 exec, -1
L_p2_polled:
    s_barrier
    s_cmp_ge_u32 s3, 6
    s_cbranch_scc1 Lkv_7
    s_add_u32 m0, s49, 0
    s_add_u32 s57, s51, 0
    buffer_load_dwordx4 v4, s[4:7], s57 offen sc1 lds
    s_add_u32 m0, s49, 6208
    s_add_u32 s57, s51, 32768
    buffer_load_dwordx4 v4, s[4:7], s57 offen sc1 lds
    s_add_u32 m0, s49, 12416
    s_add_u32 s57, s51, 65536
    buffer_load_dwordx4 v4, s[4:7], s57 offen sc1 lds
    s_add_u32 m0, s49, 18624
    s_add_u32 s57, s51, 98304
    buffer_load_dwordx4 v4, s[4:7], s57 offen sc1 lds
    s_add_u32 m0, s49, 24832
    s_add_u32 s57, s51, 131072
    buffer_load_dwordx4 v4, s[4:7], s57 offen sc1 lds
Lkv_7:
    buffer_load_dwordx4 v[16:19], v5, s[4:7], s55 offen sc1
    buffer_load_dwordx2 v[20:21], v7, s[4:7], s56 offen sc1
    buffer_load_dwordx2 v[22:23], v6, s[4:7], s56 offen offset:8 sc1
    s_add_u32 s47, s47, 20
    s_cmp_lg_u32 s3, 7
    s_cbranch_scc1 L_p2_vok
    v_mov_b32 v8, 0
    s_mov_b64 exec, 1
Lpoll_8:
    v_mov_b32 v9, 0
    buffer_atomic_add v9, v8, s[4:7], s47 offen sc0 sc1
    s_waitcnt vmcnt(0)
    v_cmp_ne_u32 vcc, s48, v9
    s_cbranch_vccz Lpoll_8d
    s_sub_u32 s96, s96, 1
    s_cbranch_scc0 Lpoll_8
    s_mov_b32 s96, 0
Lpoll_8d:
    s_mov_b64 exec, -1
L_p2_vok:
    s_waitcnt vmcnt(0) lgkmcnt(0)
    v_or_b32 v20, v20, v15
    s_barrier
    s_cmp_ge_u32 s3, 4
    s_cbranch_scc1 L_p2_lo
    s_setprio 2
L_p2_lo:
    ds_read_b128 v[24:27], v12 offset:512
    ds_read_b128 v[28:31], v13 offset:512
    ds_read_b128 v[32:35], v12 offset:4096
    ds_read_b128 v[36:39], v13 offset:4096
    ds_read_b128 v[40:43], v12 offset:0
    ds_read_b128 v[44:47], v13 offset:0
    s_cmp_ge_u32 s3, 6
    s_cbranch_scc1 Lkv_9
    s_add_u32 m0, s49, 31040
    s_add_u32 s57, s51, 2621440
    buffer_load_dwordx4 v4, s[4:7], s57 offen sc1 lds
    s_add_u32 m0, s49, 37248
    s_add_u32 s57, s51, 2654208
    buffer_load_dwordx4 v4, s[4:7], s57 offen sc1 lds
    s_add_u32 m0, s49, 43456
    s_add_u32 s57, s51, 2686976
    buffer_load_dwordx4 v4, s[4:7], s57 offen sc1 lds
    s_add_u32 m0, s49, 49664
    s_add_u32 s57, s51, 2719744
    buffer_load_dwordx4 v4, s[4:7], s57 offen sc1 lds
    s_add_u32 m0, s49, 55872
    s_add_u32 s57, s51, 2752512
    buffer_load_dwordx4 v4, s[4:7], s57 offen sc1 lds
Lkv_9:
    s_waitcnt lgkmcnt(5)
    v_mfma_f32_32x32x16_bf16 v[80:95], v[24:27], v[16:19], 0
    s_waitcnt lgkmcnt(4)
    v_mfma_f32_32x32x16_bf16 v[80:95], v[28:31], v[20:23], v[80:95]
    ds_read_b128 v[24:27], v12 offset:1024
    ds_read_b128 v[28:31], v13 offset:1024
    s_waitcnt lgkmcnt(5)
    v_mfma_f32_32x32x16_bf16 v[192:207], v[32:35], v[16:19], 0
    s_nop 7
    v_exp_f32 v80, v80
    s_add_u32 m0, s59, 0
    v_exp_f32 v81, v81
    s_add_u32 s98, s60, 0
    v_exp_f32 v82, v82
    buffer_load_dwordx4 v224, s[16:19], s98 offen lds
    v_exp_f32 v83, v83
    s_waitcnt lgkmcnt(4)
    v_mfma_f32_32x32x16_bf16 v[192:207], v[36:39], v[20:23], v[192:207]
    ds_read_b128 v[32:35], v12 offset:1536
    v_exp_f32 v84, v84
    ds_read_b128 v[36:39], v13 offset:1536
    v_exp_f32 v85, v85
    s_waitcnt lgkmcnt(4)
    v_exp_f32 v86, v86
    s_add_u32 m0, s59, 8192
    v_exp_f32 v87, v87
    v_mfma_f32_32x32x16_bf16 v[64:79], v[40:43], v[16:19], 0
    s_add_u32 s98, s60, 204800
    v_exp_f32 v88, v88
    buffer_load_dwordx4 v224, s[16:19], s98 offen lds
    v_exp_f32 v89, v89
    s_add_u32 m0, s59, 16384
    v_exp_f32 v90, v90
    s_add_u32 s98, s60, 409600
    v_exp_f32 v91, v91
    v_mfma_f32_32x32x16_bf16 v[64:79], v[44:47], v[20:23], v[64:79]
    ds_read_b128 v[40:43], v12 offset:2048
    v_exp_f32 v92, v92
    ds_read_b128 v[44:47], v13 offset:2048
    v_exp_f32 v93, v93
    s_waitcnt lgkmcnt(4)
    v_exp_f32 v94, v94
    buffer_load_dwordx4 v224, s[16:19], s98 offen lds
    v_exp_f32 v95, v95
    v_mfma_f32_32x32x16_bf16 v[96:111], v[24:27], v[16:19], 0
    s_add_u32 m0, s59, 24576
    .p2align 3
    v_cvt_pk_bf16_f32 v80, v80, v81
    v_cvt_pk_bf16_f32 v81, v82, v83
    v_cvt_pk_bf16_f32 v82, v84, v85
    v_cvt_pk_bf16_f32 v83, v86, v87
    v_cvt_pk_bf16_f32 v84, v88, v89
    v_cvt_pk_bf16_f32 v85, v90, v91
    v_cvt_pk_bf16_f32 v86, v92, v93
    v_cvt_pk_bf16_f32 v87, v94, v95
    v_cndmask_b32 v192, v64, v192, s[64:65]
    v_cndmask_b32 v193, v65, v193, s[66:67]
    v_cndmask_b32 v194, v66, v194, s[68:69]
    v_cndmask_b32 v195, v67, v195, s[70:71]
    v_cndmask_b32 v196, v68, v196, s[72:73]
    v_cndmask_b32 v197, v69, v197, s[74:75]
    v_cndmask_b32 v198, v70, v198, s[76:77]
    v_cndmask_b32 v199, v71, v199, s[78:79]
    v_cndmask_b32 v200, v72, v200, s[80:81]
    v_cndmask_b32 v201, v73, v201, s[82:83]
    v_cndmask_b32 v202, v74, v202, s[84:85]
    v_cndmask_b32 v203, v75, v203, s[86:87]
    v_cndmask_b32 v204, v76, v204, s[88:89]
    v_cndmask_b32 v205, v77, v205, s[90:91]
    v_cndmask_b32 v206, v78, v206, s[92:93]
    v_cndmask_b32 v207, v79, v207, s[94:95]
    v_exp_f32 v192, v192
    v_mfma_f32_32x32x16_bf16 v[96:111], v[28:31], v[20:23], v[96:111]
    ds_read_b128 v[24:27], v12 offset:2560
    v_exp_f32 v193, v193
    ds_read_b128 v[28:31], v13 offset:2560
    v_exp_f32 v194, v194
    s_waitcnt lgkmcnt(4)
    v_exp_f32 v195, v195
    s_add_u32 s98, s60, 614400
    v_exp_f32 v196, v196
    v_mfma_f32_32x32x16_bf16 v[112:127], v[32:35], v[16:19], 0
    buffer_load_dwordx4 v224, s[16:19], s98 offen lds
    v_exp_f32 v197, v197
    s_add_u32 m0, s59, 32768
    v_exp_f32 v198, v198
    s_add_u32 s98, s61, 20480
    v_exp_f32 v199, v199
    buffer_load_dwordx4 v225, s[16:19], s98 offen lds
    v_exp_f32 v200, v200
    v_mfma_f32_32x32x16_bf16 v[112:127], v[36:39], v[20:23], v[112:127]
    ds_read_b128 v[32:35], v12 offset:3072
    v_exp_f32 v201, v201
    ds_read_b128 v[36:39], v13 offset:3072
    v_exp_f32 v202, v202
    s_waitcnt lgkmcnt(4)
    v_exp_f32 v203, v203
    s_add_u32 m0, s59, 40960
    v_exp_f32 v204, v204
    v_mfma_f32_32x32x16_bf16 v[128:143], v[40:43], v[16:19], 0
    s_add_u32 s98, s60, 30720
    v_exp_f32 v205, v205
    buffer_load_dwordx4 v224, s[16:19], s98 offen lds
    v_exp_f32 v206, v206
    s_add_u32 m0, s59, 49152
    v_exp_f32 v207, v207
    s_add_u32 s98, s60, 235520
    .p2align 3
    v_cvt_pk_bf16_f32 v192, v192, v193
    v_cvt_pk_bf16_f32 v193, v194, v195
    v_cvt_pk_bf16_f32 v194, v196, v197
    v_cvt_pk_bf16_f32 v195, v198, v199
    v_cvt_pk_bf16_f32 v196, v200, v201
    v_cvt_pk_bf16_f32 v197, v202, v203
    v_cvt_pk_bf16_f32 v198, v204, v205
    v_cvt_pk_bf16_f32 v199, v206, v207
    v_and_b32_e64 v200, v192, v52
    v_bfi_b32 v64, v52, 0, v192
    v_and_b32_e64 v201, v193, v53
    v_bfi_b32 v65, v53, 0, v193
    v_and_b32_e64 v202, v194, v54
    v_bfi_b32 v66, v54, 0, v194
    v_and_b32_e64 v203, v195, v55
    v_bfi_b32 v67, v55, 0, v195
    v_and_b32_e64 v204, v196, v56
    v_bfi_b32 v68, v56, 0, v196
    v_and_b32_e64 v205, v197, v57
    v_bfi_b32 v69, v57, 0, v197
    v_and_b32_e64 v206, v198, v58
    v_bfi_b32 v70, v58, 0, v198
    v_and_b32_e64 v207, v199, v59
    v_bfi_b32 v71, v59, 0, v199
    s_cmp_lt_u32 s3, 4
    s_cbranch_scc1 L_p2_nb1
    s_waitcnt vmcnt(6)
    s_barrier
    v_lshlrev_b32 v242, 7, v1
    s_and_b32 s57, s3, 1
    s_lshl_b32 s57, s57, 8
    s_add_u32 s57, s57, s2
    s_lshl_b32 s57, s57, 13
    s_cmp_lt_u32 s3, 6
    s_cbranch_scc1 L_p2_tu
    buffer_load_dword v248, v242, s[28:31], s57 offen
    s_branch L_p2_nb1
L_p2_tu:
    s_add_u32 s57, s57, 524288
    buffer_load_dword v248, v242, s[24:27], s57 offen
L_p2_nb1:
    v_exp_f32 v96, v96
    v_mfma_f32_32x32x16_bf16 v[128:143], v[44:47], v[20:23], v[128:143]
    ds_read_b128 v[40:43], v12 offset:3584
    v_exp_f32 v97, v97
    ds_read_b128 v[44:47], v13 offset:3584
    v_exp_f32 v98, v98
    s_waitcnt lgkmcnt(4)
    v_exp_f32 v99, v99
    buffer_load_dwordx4 v224, s[16:19], s98 offen lds
    v_exp_f32 v100, v100
    v_mfma_f32_32x32x16_bf16 v[144:159], v[24:27], v[16:19], 0
    s_add_u32 m0, s59, 57344
    v_exp_f32 v101, v101
    s_add_u32 s98, s60, 440320
    v_exp_f32 v102, v102
    buffer_load_dwordx4 v224, s[16:19], s98 offen lds
    v_exp_f32 v103, v103
    s_add_u32 m0, s59, 65536
    v_exp_f32 v104, v104
    v_mfma_f32_32x32x16_bf16 v[144:159], v[28:31], v[20:23], v[144:159]
    s_waitcnt lgkmcnt(2)
    v_exp_f32 v105, v105
    s_add_u32 s98, s60, 645120
    v_exp_f32 v106, v106
    buffer_load_dwordx4 v224, s[16:19], s98 offen lds
    v_exp_f32 v107, v107
    s_add_u32 m0, s59, 73728
    v_exp_f32 v108, v108
    v_mfma_f32_32x32x16_bf16 v[160:175], v[32:35], v[16:19], 0
    s_add_u32 s98, s61, 25600
    v_exp_f32 v109, v109
    buffer_load_dwordx4 v225, s[16:19], s98 offen lds
    v_exp_f32 v110, v110
    v_exp_f32 v111, v111
    .p2align 3
    v_cvt_pk_bf16_f32 v96, v96, v97
    v_cvt_pk_bf16_f32 v97, v98, v99
    v_cvt_pk_bf16_f32 v98, v100, v101
    v_cvt_pk_bf16_f32 v99, v102, v103
    v_cvt_pk_bf16_f32 v100, v104, v105
    v_cvt_pk_bf16_f32 v101, v106, v107
    v_cvt_pk_bf16_f32 v102, v108, v109
    v_cvt_pk_bf16_f32 v103, v110, v111
    s_cmp_ge_u32 s3, 4
    s_cbranch_scc1 L_p2_nb2
    s_waitcnt vmcnt(10)
    s_barrier
L_p2_nb2:
    v_exp_f32 v112, v112
    v_mfma_f32_32x32x16_bf16 v[160:175], v[36:39], v[20:23], v[160:175]
    s_waitcnt lgkmcnt(0)
    v_exp_f32 v113, v113
    ds_read_b64_tr_b16 v[226:227], v14 offset:512
    v_exp_f32 v114, v114
    ds_read_b64_tr_b16 v[228:229], v14 offset:640
    v_exp_f32 v115, v115
    ds_read_b64_tr_b16 v[230:231], v14 offset:768
    v_exp_f32 v116, v116
    v_mfma_f32_32x32x16_bf16 v[176:191], v[40:43], v[16:19], 0
    ds_read_b64_tr_b16 v[232:233], v14 offset:896
    v_exp_f32 v117, v117
    ds_read_b64_tr_b16 v[88:89], v14 offset:4096
    v_exp_f32 v118, v118
    ds_read_b64_tr_b16 v[90:91], v14 offset:4224
    v_exp_f32 v119, v119
    ds_read_b64_tr_b16 v[92:93], v14 offset:4352
    v_exp_f32 v120, v120
    v_mfma_f32_32x32x16_bf16 v[176:191], v[44:47], v[20:23], v[176:191]
    ds_read_b64_tr_b16 v[94:95], v14 offset:4480
    v_exp_f32 v121, v121
    ds_read_b64_tr_b16 v[192:193], v14 offset:0
    v_exp_f32 v122, v122
    ds_read_b64_tr_b16 v[194:195], v14 offset:128
    v_exp_f32 v123, v123
    ds_read_b64_tr_b16 v[196:197], v14 offset:256
    v_exp_f32 v124, v124
    s_waitcnt lgkmcnt(9)
    v_mfma_f32_32x32x16_bf16 v[208:223], v[226:229], v[80:83], 0
    ds_read_b64_tr_b16 v[198:199], v14 offset:384
    v_exp_f32 v125, v125
    ds_read_b64_tr_b16 v[72:73], v14 offset:1024
    v_exp_f32 v126, v126
    ds_read_b64_tr_b16 v[74:75], v14 offset:1152
    v_exp_f32 v127, v127
    ds_read_b64_tr_b16 v[76:77], v14 offset:1280
    .p2align 3
    v_cvt_pk_bf16_f32 v112, v112, v113
    v_cvt_pk_bf16_f32 v113, v114, v115
    v_cvt_pk_bf16_f32 v114, v116, v117
    v_cvt_pk_bf16_f32 v115, v118, v119
    v_cvt_pk_bf16_f32 v116, v120, v121
    v_cvt_pk_bf16_f32 v117, v122, v123
    v_cvt_pk_bf16_f32 v118, v124, v125
    v_cvt_pk_bf16_f32 v119, v126, v127
    v_exp_f32 v128, v128
    s_waitcnt lgkmcnt(11)
    v_mfma_f32_32x32x16_bf16 v[208:223], v[230:233], v[84:87], v[208:223]
    ds_read_b64_tr_b16 v[78:79], v14 offset:1408
    v_exp_f32 v129, v129
    ds_read_b64_tr_b16 v[104:105], v14 offset:1536
    v_exp_f32 v130, v130
    ds_read_b64_tr_b16 v[106:107], v14 offset:1664
    v_exp_f32 v131, v131
    ds_read_b64_tr_b16 v[108:109], v14 offset:1792
    v_exp_f32 v132, v132
    s_waitcnt lgkmcnt(13)
    v_mfma_f32_32x32x16_bf16 v[208:223], v[88:91], v[200:203], v[208:223]
    ds_read_b64_tr_b16 v[110:111], v14 offset:1920
    v_exp_f32 v133, v133
    ds_read_b64_tr_b16 v[120:121], v14 offset:2048
    v_exp_f32 v134, v134
    ds_read_b64_tr_b16 v[122:123], v14 offset:2176
    v_exp_f32 v135, v135
    ds_read_b64_tr_b16 v[124:125], v14 offset:2304
    v_exp_f32 v136, v136
    s_waitcnt lgkmcnt(15)
    v_mfma_f32_32x32x16_bf16 v[208:223], v[92:95], v[204:207], v[208:223]
    ds_read_b64_tr_b16 v[126:127], v14 offset:2432
    v_exp_f32 v137, v137
    s_waitcnt lgkmcnt(12)
    v_exp_f32 v138, v138
    v_exp_f32 v139, v139
    v_exp_f32 v140, v140
    v_mfma_f32_32x32x16_bf16 v[208:223], v[192:195], v[64:67], v[208:223]
    v_exp_f32 v141, v141
    v_exp_f32 v142, v142
    v_exp_f32 v143, v143
    .p2align 3
    v_cvt_pk_bf16_f32 v128, v128, v129
    v_cvt_pk_bf16_f32 v129, v130, v131
    v_cvt_pk_bf16_f32 v130, v132, v133
    v_cvt_pk_bf16_f32 v131, v134, v135
    v_cvt_pk_bf16_f32 v132, v136, v137
    v_cvt_pk_bf16_f32 v133, v138, v139
    v_cvt_pk_bf16_f32 v134, v140, v141
    v_cvt_pk_bf16_f32 v135, v142, v143
    v_exp_f32 v144, v144
    v_mfma_f32_32x32x16_bf16 v[208:223], v[196:199], v[68:71], v[208:223]
    ds_read_b64_tr_b16 v[136:137], v14 offset:2560
    v_exp_f32 v145, v145
    ds_read_b64_tr_b16 v[138:139], v14 offset:2688
    v_exp_f32 v146, v146
    ds_read_b64_tr_b16 v[140:141], v14 offset:2816
    v_exp_f32 v147, v147
    ds_read_b64_tr_b16 v[142:143], v14 offset:2944
    v_exp_f32 v148, v148
    s_waitcnt lgkmcnt(14)
    v_mfma_f32_32x32x16_bf16 v[208:223], v[72:75], v[96:99], v[208:223]
    v_exp_f32 v149, v149
    v_exp_f32 v150, v150
    v_exp_f32 v151, v151
    v_exp_f32 v152, v152
    s_waitcnt lgkmcnt(12)
    v_mfma_f32_32x32x16_bf16 v[208:223], v[76:79], v[100:103], v[208:223]
    s_waitcnt lgkmcnt(8)
    v_exp_f32 v153, v153
    v_exp_f32 v154, v154
    v_exp_f32 v155, v155
    v_exp_f32 v156, v156
    v_mfma_f32_32x32x16_bf16 v[208:223], v[104:107], v[112:115], v[208:223]
    v_exp_f32 v157, v157
    v_exp_f32 v158, v158
    v_exp_f32 v159, v159
    .p2align 3
    v_cvt_pk_bf16_f32 v144, v144, v145
    v_cvt_pk_bf16_f32 v145, v146, v147
    v_cvt_pk_bf16_f32 v146, v148, v149
    v_cvt_pk_bf16_f32 v147, v150, v151
    v_cvt_pk_bf16_f32 v148, v152, v153
    v_cvt_pk_bf16_f32 v149, v154, v155
    v_cvt_pk_bf16_f32 v150, v156, v157
    v_cvt_pk_bf16_f32 v151, v158, v159
    v_exp_f32 v160, v160
    v_mfma_f32_32x32x16_bf16 v[208:223], v[108:111], v[116:119], v[208:223]
    ds_read_b64_tr_b16 v[152:153], v14 offset:3072
    v_exp_f32 v161, v161
    ds_read_b64_tr_b16 v[154:155], v14 offset:3200
    v_exp_f32 v162, v162
    ds_read_b64_tr_b16 v[156:157], v14 offset:3328
    v_exp_f32 v163, v163
    ds_read_b64_tr_b16 v[158:159], v14 offset:3456
    v_exp_f32 v164, v164
    s_waitcnt lgkmcnt(10)
    v_mfma_f32_32x32x16_bf16 v[208:223], v[120:123], v[128:131], v[208:223]
    v_exp_f32 v165, v165
    v_exp_f32 v166, v166
    v_exp_f32 v167, v167
    v_exp_f32 v168, v168
    s_waitcnt lgkmcnt(8)
    v_mfma_f32_32x32x16_bf16 v[208:223], v[124:127], v[132:135], v[208:223]
    s_waitcnt lgkmcnt(4)
    v_exp_f32 v169, v169
    v_exp_f32 v170, v170
    v_exp_f32 v171, v171
    v_exp_f32 v172, v172
    v_mfma_f32_32x32x16_bf16 v[208:223], v[136:139], v[144:147], v[208:223]
    v_exp_f32 v173, v173
    v_exp_f32 v174, v174
    v_exp_f32 v175, v175
    .p2align 3
    v_cvt_pk_bf16_f32 v160, v160, v161
    v_cvt_pk_bf16_f32 v161, v162, v163
    v_cvt_pk_bf16_f32 v162, v164, v165
    v_cvt_pk_bf16_f32 v163, v166, v167
    v_cvt_pk_bf16_f32 v164, v168, v169
    v_cvt_pk_bf16_f32 v165, v170, v171
    v_cvt_pk_bf16_f32 v166, v172, v173
    v_cvt_pk_bf16_f32 v167, v174, v175
    v_exp_f32 v176, v176
    v_mfma_f32_32x32x16_bf16 v[208:223], v[140:143], v[148:151], v[208:223]
    ds_read_b64_tr_b16 v[168:169], v14 offset:3584
    v_exp_f32 v177, v177
    ds_read_b64_tr_b16 v[170:171], v14 offset:3712
    v_exp_f32 v178, v178
    ds_read_b64_tr_b16 v[172:173], v14 offset:3840
    v_exp_f32 v179, v179
    ds_read_b64_tr_b16 v[174:175], v14 offset:3968
    v_exp_f32 v180, v180
    s_waitcnt lgkmcnt(6)
    v_mfma_f32_32x32x16_bf16 v[208:223], v[152:155], v[160:163], v[208:223]
    v_exp_f32 v181, v181
    v_exp_f32 v182, v182
    v_exp_f32 v183, v183
    v_exp_f32 v184, v184
    s_waitcnt lgkmcnt(4)
    v_mfma_f32_32x32x16_bf16 v[208:223], v[156:159], v[164:167], v[208:223]
    v_exp_f32 v185, v185
    v_exp_f32 v186, v186
    v_exp_f32 v187, v187
    v_exp_f32 v188, v188
    v_exp_f32 v189, v189
    v_exp_f32 v190, v190
    v_exp_f32 v191, v191
    .p2align 3
    v_cvt_pk_bf16_f32 v176, v176, v177
    v_cvt_pk_bf16_f32 v177, v178, v179
    v_cvt_pk_bf16_f32 v178, v180, v181
    v_cvt_pk_bf16_f32 v179, v182, v183
    v_cvt_pk_bf16_f32 v180, v184, v185
    v_cvt_pk_bf16_f32 v181, v186, v187
    v_cvt_pk_bf16_f32 v182, v188, v189
    v_cvt_pk_bf16_f32 v183, v190, v191
    s_waitcnt lgkmcnt(2)
    v_mfma_f32_32x32x16_bf16 v[208:223], v[168:171], v[176:179], v[208:223]
    s_waitcnt lgkmcnt(0)
    v_mfma_f32_32x32x16_bf16 v[208:223], v[172:175], v[180:183], v[208:223]
    v_bfe_u32 v5, v1, 4, 1
    v_mul_u32_u24 v5, 20480, v5
    v_and_b32 v7, 15, v1
    v_lshl_add_u32 v6, v7, 3, v5
    v_lshl_add_u32 v5, v7, 4, v5
    v_mov_b32 v8, 2147483632
    v_cmp_eq_u32 vcc, 0, v3
    s_nop 1
    v_cndmask_b32 v6, v8, v6, vcc
    v_lshl_add_u32 v5, v3, 8, v5
    s_lshl_b32 s54, s53, 2
    s_add_u32 s54, s54, s43
    s_mul_i32 s54, s54, 10240
    s_add_u32 s54, s54, 9437184
    s_lshl_b32 s55, s40, 9
    s_add_u32 s55, s55, s54
    s_lshl_b32 s56, s40, 7
    s_add_u32 s56, s56, s54
    s_add_u32 s56, s56, 8192
    s_mov_b32 s57, 1073741824
    v_subrev_u32 v8, 528482304, v220
    v_cmp_lt_u32 vcc, s57, v8
    s_cbranch_vccnz L_p2_slow
L_p2_norm:
    v_rcp_f32 v8, v220
    s_nop 0
    v_mul_f32 v208, v208, v8
    v_mul_f32 v209, v209, v8
    v_mul_f32 v210, v210, v8
    v_mul_f32 v211, v211, v8
    v_mul_f32 v212, v212, v8
    v_mul_f32 v213, v213, v8
    v_mul_f32 v214, v214, v8
    v_mul_f32 v215, v215, v8
    v_mul_f32 v216, v216, v8
    v_mul_f32 v217, v217, v8
    v_mul_f32 v218, v218, v8
    v_mul_f32 v219, v219, v8
    v_cvt_pk_bf16_f32 v16, v208, v209
    v_cvt_pk_bf16_f32 v17, v210, v211
    v_cvt_pk_bf16_f32 v18, v212, v213
    v_cvt_pk_bf16_f32 v19, v214, v215
    v_cvt_pk_bf16_f32 v20, v216, v217
    v_cvt_pk_bf16_f32 v21, v218, v219
    buffer_store_dwordx4 v[16:19], v5, s[4:7], s55 offen sc1
    buffer_store_dwordx2 v[20:21], v6, s[4:7], s56 offen sc1
    s_setprio 0
    s_mul_i32 s51, s41, 87384
    s_lshr_b32 s51, s51, 16
    s_mul_i32 s51, s51, 10
    v_add_u32 v247, s51, v1
    v_lshlrev_b32 v247, 7, v247
    s_mul_i32 s51, s43, 20
    v_add_u32 v247, s51, v247
    s_lshl_b32 s51, s43, 2
    s_add_u32 s51, s51, 163456
    v_mov_b32 v8, s51
    v_mov_b32 v246, 1
    s_mov_b64 exec, 1
    s_waitcnt vmcnt(0)
    ds_add_rtn_u32 v9, v8, v246
    s_waitcnt lgkmcnt(0)
    v_cmp_ne_u32 vcc, 3, v9
    s_cbranch_vccnz L_p2_nosig
    s_mov_b64 exec, 0xfffff
    buffer_atomic_add v246, v247, s[4:7], 0 offen offset:8 sc1
L_p2_nosig:
    s_mov_b64 exec, -1
    s_cmp_ge_u32 s3, 4
    s_cbranch_scc1 L_h345
    s_bfe_u32 s40, s2, 0x20001
    s_add_u32 s43, s40, 108
    s_mul_i32 s40, s40, 27
    s_lshr_b32 s41, s2, 3
    s_add_u32 s42, s40, s41
    s_cmp_ge_u32 s2, 216
    s_cselect_b32 s42, s43, s42
    s_mul_i32 s40, s42, 13108
    s_lshr_b32 s40, s40, 16
    s_mul_i32 s41, s40, 5
    s_sub_u32 s43, s42, s41
    s_and_b32 s41, s2, 1
    s_mul_i32 s41, s41, 5
    s_add_u32 s41, s41, s43
    s_and_b32 s48, s3, 1
    s_lshr_b32 s49, s3, 1
    v_and_b32 v2, 15, v1
    v_lshrrev_b32 v3, 4, v1
    v_lshrrev_b32 v4, 4, v1
    v_lshlrev_b32 v14, 10, v4
    v_bfe_u32 v4, v1, 2, 2
    v_lshl_add_u32 v14, v4, 7, v14
    v_and_b32 v4, 3, v1
    v_lshl_add_u32 v14, v4, 3, v14
    v_bfe_u32 v4, v1, 3, 2
    v_lshl_add_u32 v14, v4, 5, v14
    s_lshl_b32 s50, s49, 6
    v_xor_b32 v14, s50, v14
    s_lshl_b32 s50, s49, 12
    v_add_u32 v10, s50, v14
    v_xor_b32 v11, 32, v10
    v_xor_b32 v12, 64, v10
    v_xor_b32 v13, 96, v10
    s_mul_i32 s50, s3, 6144
    s_add_u32 s50, s50, 106496
    v_lshl_add_u32 v8, v1, 4, s50
    s_xor_b32 s50, s3, 2
    s_mul_i32 s50, s50, 6144
    s_add_u32 s50, s50, 106496
    v_lshl_add_u32 v15, v1, 4, s50
    s_lshl_b32 s55, s40, 1
    s_add_u32 s55, s55, s48
    s_mul_i32 s55, s55, 3
    v_lshlrev_b32 v9, 8, v3
    v_lshl_add_u32 v9, v2, 3, v9
    s_add_u32 s56, s55, 0
    s_cmp_ge_u32 s56, 128
    s_mov_b32 s57, 0
    s_cselect_b32 s56, 1073741816, s57
    v_lshl_add_u32 v236, v1, 4, s56
    v_add_u32 v239, s56, v9
    s_add_u32 s56, s55, 1
    s_cmp_ge_u32 s56, 128
    s_mov_b32 s57, 20480
    s_cselect_b32 s56, 1073741816, s57
    v_lshl_add_u32 v237, v1, 4, s56
    v_add_u32 v240, s56, v9
    s_add_u32 s56, s55, 2
    s_cmp_ge_u32 s56, 128
    s_mov_b32 s57, 40960
    s_cselect_b32 s56, 1073741816, s57
    v_lshl_add_u32 v238, v1, 4, s56
    v_add_u32 v241, s56, v9
    s_mul_i32 s50, s55, 20480
    s_lshl_b32 s56, s49, 10
    s_add_u32 s56, s56, s50
    s_add_u32 s56, s56, 9437184
    s_mul_i32 s57, s40, 10
    s_add_u32 s57, s57, s41
    s_lshl_b32 s57, s57, 7
    s_add_u32 s57, s57, 8
    s_mul_i32 s58, s40, 3
    s_add_u32 s59, s58, 2
    s_min_u32 s59, s59, 63
    s_lshr_b32 s58, s58, 2
    s_lshr_b32 s59, s59, 2
    s_cmp_eq_u32 s58, s59
    s_cselect_b32 s58, 16, 32
    v_lshrrev_b32 v7, 1, v3
    s_lshl_b32 s51, s49, 2
    v_add_u32 v4, s51, v7
    v_and_b32 v5, 7, v2
    v_xor_b32 v4, v4, v5
    v_lshlrev_b32 v4, 4, v4
    v_lshl_add_u32 v4, v2, 7, v4
    v_and_b32 v5, 1, v3
    v_lshl_add_u32 v4, v5, 3, v4
    s_mul_i32 s51, s48, 6144
    s_add_u32 s51, s51, 81920
    v_add_u32 v4, s51, v4
    v_xor_b32 v9, 32, v4
    v_lshlrev_b32 v6, 9, v5
    v_lshl_add_u32 v6, v7, 8, v6
    v_lshl_add_u32 v6, v2, 4, v6
    s_lshl_b32 s53, s41, 1
    s_add_u32 s53, s53, s49
    s_lshl_b32 s53, s53, 10
    s_add_u32 s53, s53, s50
    s_add_u32 s53, s53, 12582912
    v_lshlrev_b32 v7, 3, v2
    v_lshl_add_u32 v7, v5, 2, v7
    s_mul_i32 s51, s3, 384
    s_add_u32 s51, s51, 155648
    v_add_u32 v7, s51, v7
    s_mov_b64 s[62:63], 0
    s_cmp_ge_i32 s1, 0
    s_cbranch_scc1 L_p3_skip
    v_lshrrev_b32 v16, 3, v1
    v_and_b32 v17, 7, v1
    v_xor_b32 v17, v17, v16
    v_mul_u32_u24 v16, 1280, v16
    v_lshl_add_u32 v16, v17, 4, v16
    s_lshl_b32 s44, s40, 2
    s_add_u32 s44, s44, s3
    s_mul_i32 s44, s44, 30720
    s_lshl_b32 s45, s41, 7
    s_add_u32 s44, s44, s45
    s_mul_i32 s45, s3, 3072
    s_add_u32 m0, s45, 81920
    s_nop 0
    buffer_load_dwordx4 v16, s[8:11], s44 offen lds
    s_add_u32 s44, s44, 10240
    s_add_u32 m0, s45, 82944
    s_nop 0
    buffer_load_dwordx4 v16, s[8:11], s44 offen lds
    s_add_u32 s44, s44, 10240
    s_add_u32 m0, s45, 83968
    s_nop 0
    buffer_load_dwordx4 v16, s[8:11], s44 offen lds
    v_mov_b32 v234, 0
    s_mov_b64 exec, 1
Lpoll_10:
    v_mov_b32 v235, 0
    buffer_atomic_add v235, v234, s[4:7], s57 offen sc0 sc1
    s_waitcnt vmcnt(0)
    v_cmp_ne_u32 vcc, s58, v235
    s_cbranch_vccz Lpoll_10d
    s_sleep 1
    s_sub_u32 s96, s96, 1
    s_cbranch_scc0 Lpoll_10
    s_mov_b32 s96, 0
Lpoll_10d:
    s_mov_b64 exec, -1
    s_add_u32 s59, s56, 0
    buffer_load_dwordx4 v[112:115], v236, s[4:7], s59 offen sc1
    buffer_load_dwordx4 v[116:119], v237, s[4:7], s59 offen sc1
    buffer_load_dwordx4 v[120:123], v238, s[4:7], s59 offen sc1
    s_add_u32 s59, s56, 2048
    buffer_load_dwordx4 v[124:127], v236, s[4:7], s59 offen sc1
    buffer_load_dwordx4 v[128:131], v237, s[4:7], s59 offen sc1
    buffer_load_dwordx4 v[132:135], v238, s[4:7], s59 offen sc1
    s_add_u32 s59, s56, 4096
    buffer_load_dwordx4 v[136:139], v236, s[4:7], s59 offen sc1
    buffer_load_dwordx4 v[140:143], v237, s[4:7], s59 offen sc1
    buffer_load_dwordx4 v[144:147], v238, s[4:7], s59 offen sc1
    s_add_u32 s59, s56, 6144
    buffer_load_dwordx4 v[148:151], v236, s[4:7], s59 offen sc1
    buffer_load_dwordx4 v[152:155], v237, s[4:7], s59 offen sc1
    buffer_load_dwordx4 v[156:159], v238, s[4:7], s59 offen sc1
    v_mov_b32 v234, 163456
L_p3_w8:
    ds_read_b64 v[232:233], v234
    s_waitcnt lgkmcnt(0)
    v_add_u32 v232, v232, v233
    v_cmp_ne_u32 vcc, 8, v232
    s_cbranch_vccz L_p3_w8d
    s_sleep 1
    s_sub_u32 s96, s96, 1
    s_cbranch_scc0 L_p3_w8
    s_mov_b32 s96, 0
L_p3_w8d:
    ds_read_b64_tr_b16 v[64:65], v10 offset:0
    ds_read_b64_tr_b16 v[66:67], v10 offset:512
    ds_read_b64_tr_b16 v[68:69], v11 offset:0
    ds_read_b64_tr_b16 v[70:71], v11 offset:512
    ds_read_b64_tr_b16 v[72:73], v12 offset:0
    ds_read_b64_tr_b16 v[74:75], v12 offset:512
    ds_read_b64_tr_b16 v[76:77], v13 offset:0
    ds_read_b64_tr_b16 v[78:79], v13 offset:512
    ds_read_b64_tr_b16 v[80:81], v10 offset:8192
    ds_read_b64_tr_b16 v[82:83], v10 offset:8704
    ds_read_b64_tr_b16 v[84:85], v11 offset:8192
    ds_read_b64_tr_b16 v[86:87], v11 offset:8704
    ds_read_b64_tr_b16 v[88:89], v12 offset:8192
    ds_read_b64_tr_b16 v[90:91], v12 offset:8704
    ds_read_b64_tr_b16 v[92:93], v13 offset:8192
    ds_read_b64_tr_b16 v[94:95], v13 offset:8704
    s_waitcnt vmcnt(9)
    s_waitcnt lgkmcnt(8)
    v_mfma_f32_16x16x32_bf16 v[16:19], v[64:67], v[112:115], 0
    ds_read_b64_tr_b16 v[96:97], v10 offset:16384
    v_mfma_f32_16x16x32_bf16 v[20:23], v[68:71], v[112:115], 0
    ds_read_b64_tr_b16 v[98:99], v10 offset:16896
    s_add_u32 s59, s56, 8192
    v_mfma_f32_16x16x32_bf16 v[24:27], v[72:75], v[112:115], 0
    ds_read_b64_tr_b16 v[100:101], v11 offset:16384
    v_mfma_f32_16x16x32_bf16 v[28:31], v[76:79], v[112:115], 0
    ds_read_b64_tr_b16 v[102:103], v11 offset:16896
    buffer_load_dwordx2 v[160:161], v239, s[4:7], s59 offen offset:0 sc1
    v_mfma_f32_16x16x32_bf16 v[32:35], v[64:67], v[116:119], 0
    ds_read_b64_tr_b16 v[104:105], v12 offset:16384
    v_mfma_f32_16x16x32_bf16 v[36:39], v[68:71], v[116:119], 0
    ds_read_b64_tr_b16 v[106:107], v12 offset:16896
    buffer_load_dwordx2 v[162:163], v239, s[4:7], s59 offen offset:128 sc1
    v_mfma_f32_16x16x32_bf16 v[40:43], v[72:75], v[116:119], 0
    ds_read_b64_tr_b16 v[108:109], v13 offset:16384
    v_mfma_f32_16x16x32_bf16 v[44:47], v[76:79], v[116:119], 0
    ds_read_b64_tr_b16 v[110:111], v13 offset:16896
    buffer_load_dwordx2 v[164:165], v240, s[4:7], s59 offen offset:0 sc1
    v_mfma_f32_16x16x32_bf16 v[48:51], v[64:67], v[120:123], 0
    v_mfma_f32_16x16x32_bf16 v[52:55], v[68:71], v[120:123], 0
    buffer_load_dwordx2 v[166:167], v240, s[4:7], s59 offen offset:128 sc1
    v_mfma_f32_16x16x32_bf16 v[56:59], v[72:75], v[120:123], 0
    v_mfma_f32_16x16x32_bf16 v[60:63], v[76:79], v[120:123], 0
    buffer_load_dwordx2 v[168:169], v241, s[4:7], s59 offen offset:0 sc1
    s_waitcnt vmcnt(11)
    s_waitcnt lgkmcnt(8)
    v_mfma_f32_16x16x32_bf16 v[16:19], v[80:83], v[124:127], v[16:19]
    ds_read_b64_tr_b16 v[64:65], v10 offset:24576
    v_mfma_f32_16x16x32_bf16 v[20:23], v[84:87], v[124:127], v[20:23]
    ds_read_b64_tr_b16 v[66:67], v10 offset:25088
    buffer_load_dwordx2 v[170:171], v241, s[4:7], s59 offen offset:128 sc1
    v_mfma_f32_16x16x32_bf16 v[24:27], v[88:91], v[124:127], v[24:27]
    ds_read_b64_tr_b16 v[68:69], v11 offset:24576
    v_mfma_f32_16x16x32_bf16 v[28:31], v[92:95], v[124:127], v[28:31]
    ds_read_b64_tr_b16 v[70:71], v11 offset:25088
    v_mfma_f32_16x16x32_bf16 v[32:35], v[80:83], v[128:131], v[32:35]
    ds_read_b64_tr_b16 v[72:73], v12 offset:24576
    v_mfma_f32_16x16x32_bf16 v[36:39], v[84:87], v[128:131], v[36:39]
    ds_read_b64_tr_b16 v[74:75], v12 offset:25088
    v_mfma_f32_16x16x32_bf16 v[40:43], v[88:91], v[128:131], v[40:43]
    ds_read_b64_tr_b16 v[76:77], v13 offset:24576
    v_mfma_f32_16x16x32_bf16 v[44:47], v[92:95], v[128:131], v[44:47]
    ds_read_b64_tr_b16 v[78:79], v13 offset:25088
    v_mfma_f32_16x16x32_bf16 v[48:51], v[80:83], v[132:135], v[48:51]
    v_mfma_f32_16x16x32_bf16 v[52:55], v[84:87], v[132:135], v[52:55]
    v_mfma_f32_16x16x32_bf16 v[56:59], v[88:91], v[132:135], v[56:59]
    v_mfma_f32_16x16x32_bf16 v[60:63], v[92:95], v[132:135], v[60:63]
    s_waitcnt vmcnt(9)
    s_waitcnt lgkmcnt(8)
    v_mfma_f32_16x16x32_bf16 v[16:19], v[96:99], v[136:139], v[16:19]
    ds_read_b64_tr_b16 v[80:81], v10 offset:32768
    v_mfma_f32_16x16x32_bf16 v[20:23], v[100:103], v[136:139], v[20:23]
    ds_read_b64_tr_b16 v[82:83], v10 offset:33280
    v_mfma_f32_16x16x32_bf16 v[24:27], v[104:107], v[136:139], v[24:27]
    ds_read_b64_tr_b16 v[84:85], v11 offset:32768
    v_mfma_f32_16x16x32_bf16 v[28:31], v[108:111], v[136:139], v[28:31]
    ds_read_b64_tr_b16 v[86:87], v11 offset:33280
    v_mfma_f32_16x16x32_bf16 v[32:35], v[96:99], v[140:143], v[32:35]
    ds_read_b64_tr_b16 v[88:89], v12 offset:32768
    v_mfma_f32_16x16x32_bf16 v[36:39], v[100:103], v[140:143], v[36:39]
    ds_read_b64_tr_b16 v[90:91], v12 offset:33280
    v_mfma_f32_16x16x32_bf16 v[40:43], v[104:107], v[140:143], v[40:43]
    ds_read_b64_tr_b16 v[92:93], v13 offset:32768
    v_mfma_f32_16x16x32_bf16 v[44:47], v[108:111], v[140:143], v[44:47]
    ds_read_b64_tr_b16 v[94:95], v13 offset:33280
    v_mfma_f32_16x16x32_bf16 v[48:51], v[96:99], v[144:147], v[48:51]
    v_mfma_f32_16x16x32_bf16 v[52:55], v[100:103], v[144:147], v[52:55]
    v_mfma_f32_16x16x32_bf16 v[56:59], v[104:107], v[144:147], v[56:59]
    v_mfma_f32_16x16x32_bf16 v[60:63], v[108:111], v[144:147], v[60:63]
    s_barrier
    s_add_u32 s59, s56, 10240
    buffer_load_dwordx4 v[172:175], v236, s[4:7], s59 offen sc1
    buffer_load_dwordx4 v[176:179], v237, s[4:7], s59 offen sc1
    buffer_load_dwordx4 v[180:183], v238, s[4:7], s59 offen sc1
    s_add_u32 s59, s56, 12288
    buffer_load_dwordx4 v[184:187], v236, s[4:7], s59 offen sc1
    buffer_load_dwordx4 v[188:191], v237, s[4:7], s59 offen sc1
    buffer_load_dwordx4 v[192:195], v238, s[4:7], s59 offen sc1
    s_add_u32 s59, s56, 14336
    buffer_load_dwordx4 v[196:199], v236, s[4:7], s59 offen sc1
    buffer_load_dwordx4 v[200:203], v237, s[4:7], s59 offen sc1
    buffer_load_dwordx4 v[204:207], v238, s[4:7], s59 offen sc1
    s_add_u32 s59, s56, 16384
    buffer_load_dwordx4 v[208:211], v236, s[4:7], s59 offen sc1
    buffer_load_dwordx4 v[212:215], v237, s[4:7], s59 offen sc1
    buffer_load_dwordx4 v[216:219], v238, s[4:7], s59 offen sc1
    s_waitcnt vmcnt(18)
    s_waitcnt lgkmcnt(8)
    v_mfma_f32_16x16x32_bf16 v[16:19], v[64:67], v[148:151], v[16:19]
    ds_read_b64_tr_b16 v[96:97], v10 offset:40960
    v_mfma_f32_16x16x32_bf16 v[20:23], v[68:71], v[148:151], v[20:23]
    ds_read_b64_tr_b16 v[98:99], v10 offset:41472
    s_add_u32 s59, s56, 18432
    v_mfma_f32_16x16x32_bf16 v[24:27], v[72:75], v[148:151], v[24:27]
    ds_read_b64_tr_b16 v[100:101], v11 offset:40960
    v_mfma_f32_16x16x32_bf16 v[28:31], v[76:79], v[148:151], v[28:31]
    ds_read_b64_tr_b16 v[102:103], v11 offset:41472
    buffer_load_dwordx2 v[220:221], v239, s[4:7], s59 offen offset:0 sc1
    v_mfma_f32_16x16x32_bf16 v[32:35], v[64:67], v[152:155], v[32:35]
    ds_read_b64_tr_b16 v[104:105], v12 offset:40960
    v_mfma_f32_16x16x32_bf16 v[36:39], v[68:71], v[152:155], v[36:39]
    ds_read_b64_tr_b16 v[106:107], v12 offset:41472
    buffer_load_dwordx2 v[222:223], v239, s[4:7], s59 offen offset:128 sc1
    v_mfma_f32_16x16x32_bf16 v[40:43], v[72:75], v[152:155], v[40:43]
    ds_read_b64_tr_b16 v[108:109], v13 offset:40960
    v_mfma_f32_16x16x32_bf16 v[44:47], v[76:79], v[152:155], v[44:47]
    ds_read_b64_tr_b16 v[110:111], v13 offset:41472
    buffer_load_dwordx2 v[224:225], v240, s[4:7], s59 offen offset:0 sc1
    v_mfma_f32_16x16x32_bf16 v[48:51], v[64:67], v[156:159], v[48:51]
    v_mfma_f32_16x16x32_bf16 v[52:55], v[68:71], v[156:159], v[52:55]
    buffer_load_dwordx2 v[226:227], v240, s[4:7], s59 offen offset:128 sc1
    v_mfma_f32_16x16x32_bf16 v[56:59], v[72:75], v[156:159], v[56:59]
    v_mfma_f32_16x16x32_bf16 v[60:63], v[76:79], v[156:159], v[60:63]
    buffer_load_dwordx2 v[228:229], v241, s[4:7], s59 offen offset:0 sc1
    s_waitcnt vmcnt(17)
    s_waitcnt lgkmcnt(8)
    v_mfma_f32_16x16x32_bf16 v[16:19], v[80:83], v[160:163], v[16:19]
    ds_read_b64_tr_b16 v[64:65], v10 offset:49152
    v_mfma_f32_16x16x32_bf16 v[20:23], v[84:87], v[160:163], v[20:23]
    ds_read_b64_tr_b16 v[66:67], v10 offset:49664
    buffer_load_dwordx2 v[230:231], v241, s[4:7], s59 offen offset:128 sc1
    v_mfma_f32_16x16x32_bf16 v[24:27], v[88:91], v[160:163], v[24:27]
    ds_read_b64_tr_b16 v[68:69], v11 offset:49152
    v_mfma_f32_16x16x32_bf16 v[28:31], v[92:95], v[160:163], v[28:31]
    ds_read_b64_tr_b16 v[70:71], v11 offset:49664
    v_mfma_f32_16x16x32_bf16 v[32:35], v[80:83], v[164:167], v[32:35]
    ds_read_b64_tr_b16 v[72:73], v12 offset:49152
    v_mfma_f32_16x16x32_bf16 v[36:39], v[84:87], v[164:167], v[36:39]
    ds_read_b64_tr_b16 v[74:75], v12 offset:49664
    v_mfma_f32_16x16x32_bf16 v[40:43], v[88:91], v[164:167], v[40:43]
    ds_read_b64_tr_b16 v[76:77], v13 offset:49152
    v_mfma_f32_16x16x32_bf16 v[44:47], v[92:95], v[164:167], v[44:47]
    ds_read_b64_tr_b16 v[78:79], v13 offset:49664
    v_mfma_f32_16x16x32_bf16 v[48:51], v[80:83], v[168:171], v[48:51]
    v_mfma_f32_16x16x32_bf16 v[52:55], v[84:87], v[168:171], v[52:55]
    v_mfma_f32_16x16x32_bf16 v[56:59], v[88:91], v[168:171], v[56:59]
    v_mfma_f32_16x16x32_bf16 v[60:63], v[92:95], v[168:171], v[60:63]
    s_waitcnt vmcnt(15)
    s_waitcnt lgkmcnt(8)
    v_mfma_f32_16x16x32_bf16 v[16:19], v[96:99], v[172:175], v[16:19]
    v_add_u32 v10, 57344, v10
    v_add_u32 v11, 57344, v11
    v_add_u32 v12, 57344, v12
    v_add_u32 v13, 57344, v13
    v_mfma_f32_16x16x32_bf16 v[20:23], v[100:103], v[172:175], v[20:23]
    ds_read_b64_tr_b16 v[80:81], v10 offset:0
    v_mfma_f32_16x16x32_bf16 v[24:27], v[104:107], v[172:175], v[24:27]
    ds_read_b64_tr_b16 v[82:83], v10 offset:512
    v_mfma_f32_16x16x32_bf16 v[28:31], v[108:111], v[172:175], v[28:31]
    ds_read_b64_tr_b16 v[84:85], v11 offset:0
    v_mfma_f32_16x16x32_bf16 v[32:35], v[96:99], v[176:179], v[32:35]
    ds_read_b64_tr_b16 v[86:87], v11 offset:512
    v_mfma_f32_16x16x32_bf16 v[36:39], v[100:103], v[176:179], v[36:39]
    ds_read_b64_tr_b16 v[88:89], v12 offset:0
    v_mfma_f32_16x16x32_bf16 v[40:43], v[104:107], v[176:179], v[40:43]
    ds_read_b64_tr_b16 v[90:91], v12 offset:512
    v_mfma_f32_16x16x32_bf16 v[44:47], v[108:111], v[176:179], v[44:47]
    ds_read_b64_tr_b16 v[92:93], v13 offset:0
    v_mfma_f32_16x16x32_bf16 v[48:51], v[96:99], v[180:183], v[48:51]
    ds_read_b64_tr_b16 v[94:95], v13 offset:512
    v_mfma_f32_16x16x32_bf16 v[52:55], v[100:103], v[180:183], v[52:55]
    v_mfma_f32_16x16x32_bf16 v[56:59], v[104:107], v[180:183], v[56:59]
    v_mfma_f32_16x16x32_bf16 v[60:63], v[108:111], v[180:183], v[60:63]
    s_waitcnt vmcnt(12)
    s_waitcnt lgkmcnt(8)
    v_mfma_f32_16x16x32_bf16 v[16:19], v[64:67], v[184:187], v[16:19]
    ds_read_b64_tr_b16 v[96:97], v10 offset:8192
    v_mfma_f32_16x16x32_bf16 v[20:23], v[68:71], v[184:187], v[20:23]
    ds_read_b64_tr_b16 v[98:99], v10 offset:8704
    v_mfma_f32_16x16x32_bf16 v[24:27], v[72:75], v[184:187], v[24:27]
    ds_read_b64_tr_b16 v[100:101], v11 offset:8192
    v_mfma_f32_16x16x32_bf16 v[28:31], v[76:79], v[184:187], v[28:31]
    ds_read_b64_tr_b16 v[102:103], v11 offset:8704
    v_mfma_f32_16x16x32_bf16 v[32:35], v[64:67], v[188:191], v[32:35]
    ds_read_b64_tr_b16 v[104:105], v12 offset:8192
    v_mfma_f32_16x16x32_bf16 v[36:39], v[68:71], v[188:191], v[36:39]
    ds_read_b64_tr_b16 v[106:107], v12 offset:8704
    v_mfma_f32_16x16x32_bf16 v[40:43], v[72:75], v[188:191], v[40:43]
    ds_read_b64_tr_b16 v[108:109], v13 offset:8192
    v_mfma_f32_16x16x32_bf16 v[44:47], v[76:79], v[188:191], v[44:47]
    ds_read_b64_tr_b16 v[110:111], v13 offset:8704
    v_mfma_f32_16x16x32_bf16 v[48:51], v[64:67], v[192:195], v[48:51]
    v_mfma_f32_16x16x32_bf16 v[52:55], v[68:71], v[192:195], v[52:55]
    v_mfma_f32_16x16x32_bf16 v[56:59], v[72:75], v[192:195], v[56:59]
    v_mfma_f32_16x16x32_bf16 v[60:63], v[76:79], v[192:195], v[60:63]
    s_waitcnt vmcnt(9)
    s_waitcnt lgkmcnt(8)
    v_mfma_f32_16x16x32_bf16 v[16:19], v[80:83], v[196:199], v[16:19]
    ds_read_b64_tr_b16 v[64:65], v10 offset:16384
    v_mfma_f32_16x16x32_bf16 v[20:23], v[84:87], v[196:199], v[20:23]
    ds_read_b64_tr_b16 v[66:67], v10 offset:16896
    v_mfma_f32_16x16x32_bf16 v[24:27], v[88:91], v[196:199], v[24:27]
    ds_read_b64_tr_b16 v[68:69], v11 offset:16384
    v_mfma_f32_16x16x32_bf16 v[28:31], v[92:95], v[196:199], v[28:31]
    ds_read_b64_tr_b16 v[70:71], v11 offset:16896
    v_mfma_f32_16x16x32_bf16 v[32:35], v[80:83], v[200:203], v[32:35]
    ds_read_b64_tr_b16 v[72:73], v12 offset:16384
    v_mfma_f32_16x16x32_bf16 v[36:39], v[84:87], v[200:203], v[36:39]
    ds_read_b64_tr_b16 v[74:75], v12 offset:16896
    v_mfma_f32_16x16x32_bf16 v[40:43], v[88:91], v[200:203], v[40:43]
    ds_read_b64_tr_b16 v[76:77], v13 offset:16384
    v_mfma_f32_16x16x32_bf16 v[44:47], v[92:95], v[200:203], v[44:47]
    ds_read_b64_tr_b16 v[78:79], v13 offset:16896
    v_mfma_f32_16x16x32_bf16 v[48:51], v[80:83], v[204:207], v[48:51]
    v_mfma_f32_16x16x32_bf16 v[52:55], v[84:87], v[204:207], v[52:55]
    v_mfma_f32_16x16x32_bf16 v[56:59], v[88:91], v[204:207], v[56:59]
    v_mfma_f32_16x16x32_bf16 v[60:63], v[92:95], v[204:207], v[60:63]
    s_waitcnt vmcnt(6)
    s_waitcnt lgkmcnt(8)
    v_mfma_f32_16x16x32_bf16 v[16:19], v[96:99], v[208:211], v[16:19]
    ds_read_b64 v[112:113], v4 offset:0
    v_mfma_f32_16x16x32_bf16 v[20:23], v[100:103], v[208:211], v[20:23]
    ds_read_b64 v[114:115], v9 offset:0
    v_mfma_f32_16x16x32_bf16 v[24:27], v[104:107], v[208:211], v[24:27]
    ds_read_b64 v[116:117], v4 offset:2048
    v_mfma_f32_16x16x32_bf16 v[28:31], v[108:111], v[208:211], v[28:31]
    ds_read_b64 v[118:119], v9 offset:2048
    v_mfma_f32_16x16x32_bf16 v[32:35], v[96:99], v[212:215], v[32:35]
    ds_read_b64 v[120:121], v4 offset:4096
    v_mfma_f32_16x16x32_bf16 v[36:39], v[100:103], v[212:215], v[36:39]
    ds_read_b64 v[122:123], v9 offset:4096
    v_mfma_f32_16x16x32_bf16 v[40:43], v[104:107], v[212:215], v[40:43]
    v_mfma_f32_16x16x32_bf16 v[44:47], v[108:111], v[212:215], v[44:47]
    v_mfma_f32_16x16x32_bf16 v[48:51], v[96:99], v[216:219], v[48:51]
    v_mfma_f32_16x16x32_bf16 v[52:55], v[100:103], v[216:219], v[52:55]
    v_mfma_f32_16x16x32_bf16 v[56:59], v[104:107], v[216:219], v[56:59]
    v_mfma_f32_16x16x32_bf16 v[60:63], v[108:111], v[216:219], v[60:63]
    s_waitcnt vmcnt(0)
    s_waitcnt lgkmcnt(6)
    v_mfma_f32_16x16x32_bf16 v[24:27], v[72:75], v[220:223], v[24:27]
    s_waitcnt lgkmcnt(0)
    v_lshlrev_b32 v136, 16, v112
    v_and_b32 v137, 0xffff0000, v112
    v_mfma_f32_16x16x32_bf16 v[28:31], v[76:79], v[220:223], v[28:31]
    v_lshlrev_b32 v138, 16, v113
    v_and_b32 v139, 0xffff0000, v113
    v_mfma_f32_16x16x32_bf16 v[40:43], v[72:75], v[224:227], v[40:43]
    v_lshlrev_b32 v140, 16, v114
    v_and_b32 v141, 0xffff0000, v114
    v_mfma_f32_16x16x32_bf16 v[44:47], v[76:79], v[224:227], v[44:47]
    v_lshlrev_b32 v142, 16, v115
    v_and_b32 v143, 0xffff0000, v115
    v_mfma_f32_16x16x32_bf16 v[56:59], v[72:75], v[228:231], v[56:59]
    v_lshlrev_b32 v144, 16, v116
    v_and_b32 v145, 0xffff0000, v116
    v_mfma_f32_16x16x32_bf16 v[60:63], v[76:79], v[228:231], v[60:63]
    v_lshlrev_b32 v146, 16, v117
    v_and_b32 v147, 0xffff0000, v117
    v_mfma_f32_16x16x32_bf16 v[16:19], v[64:67], v[220:223], v[16:19]
    v_lshlrev_b32 v148, 16, v118
    v_and_b32 v149, 0xffff0000, v118
    ds_write_b128 v8, v[24:27] offset:0
    v_mfma_f32_16x16x32_bf16 v[20:23], v[68:71], v[220:223], v[20:23]
    v_lshlrev_b32 v150, 16, v119
    v_and_b32 v151, 0xffff0000, v119
    ds_write_b128 v8, v[28:31] offset:1024
    v_mfma_f32_16x16x32_bf16 v[32:35], v[64:67], v[224:227], v[32:35]
    v_lshlrev_b32 v152, 16, v120
    v_and_b32 v153, 0xffff0000, v120
    ds_write_b128 v8, v[40:43] offset:2048
    v_mfma_f32_16x16x32_bf16 v[36:39], v[68:71], v[224:227], v[36:39]
    v_lshlrev_b32 v154, 16, v121
    v_and_b32 v155, 0xffff0000, v121
    ds_write_b128 v8, v[44:47] offset:3072
    v_mfma_f32_16x16x32_bf16 v[48:51], v[64:67], v[228:231], v[48:51]
    v_lshlrev_b32 v156, 16, v122
    v_and_b32 v157, 0xffff0000, v122
    ds_write_b128 v8, v[56:59] offset:4096
    v_mfma_f32_16x16x32_bf16 v[52:55], v[68:71], v[228:231], v[52:55]
    v_lshlrev_b32 v158, 16, v123
    v_and_b32 v159, 0xffff0000, v123
    ds_write_b128 v8, v[60:63] offset:5120
    s_waitcnt lgkmcnt(0)
    s_barrier
    ds_read_b128 v[188:191], v15 offset:0
    ds_read_b128 v[192:195], v15 offset:1024
    ds_read_b128 v[196:199], v15 offset:2048
    ds_read_b128 v[200:203], v15 offset:3072
    ds_read_b128 v[204:207], v15 offset:4096
    ds_read_b128 v[208:211], v15 offset:5120
    v_pk_add_f32 v[136:137], v[136:137], v[16:17]
    v_pk_add_f32 v[138:139], v[138:139], v[18:19]
    v_pk_add_f32 v[140:141], v[140:141], v[20:21]
    v_pk_add_f32 v[142:143], v[142:143], v[22:23]
    v_pk_add_f32 v[144:145], v[144:145], v[32:33]
    v_pk_add_f32 v[146:147], v[146:147], v[34:35]
    v_pk_add_f32 v[148:149], v[148:149], v[36:37]
    v_pk_add_f32 v[150:151], v[150:151], v[38:39]
    v_pk_add_f32 v[152:153], v[152:153], v[48:49]
    v_pk_add_f32 v[154:155], v[154:155], v[50:51]
    v_pk_add_f32 v[156:157], v[156:157], v[52:53]
    v_pk_add_f32 v[158:159], v[158:159], v[54:55]
    s_waitcnt lgkmcnt(4)
    v_pk_add_f32 v[136:137], v[136:137], v[188:189]
    v_pk_add_f32 v[138:139], v[138:139], v[190:191]
    v_pk_add_f32 v[140:141], v[140:141], v[192:193]
    v_pk_add_f32 v[142:143], v[142:143], v[194:195]
    v_cvt_pk_bf16_f32 v160, v136, v137
    v_cvt_pk_bf16_f32 v162, v140, v141
    v_cvt_pk_bf16_f32 v161, v138, v139
    v_cvt_pk_bf16_f32 v163, v142, v143
    v_permlane16_swap_b32 v160, v162
    s_nop 0
    v_permlane16_swap_b32 v161, v163
    buffer_store_dwordx4 v[160:163], v6, s[4:7], s53 offen sc1
    s_add_u32 s53, s53, 20480
    s_waitcnt lgkmcnt(2)
    v_pk_add_f32 v[144:145], v[144:145], v[196:197]
    v_pk_add_f32 v[146:147], v[146:147], v[198:199]
    v_pk_add_f32 v[148:149], v[148:149], v[200:201]
    v_pk_add_f32 v[150:151], v[150:151], v[202:203]
    v_cvt_pk_bf16_f32 v164, v144, v145
    v_cvt_pk_bf16_f32 v166, v148, v149
    v_cvt_pk_bf16_f32 v165, v146, v147
    v_cvt_pk_bf16_f32 v167, v150, v151
    v_permlane16_swap_b32 v164, v166
    s_nop 0
    v_permlane16_swap_b32 v165, v167
    buffer_store_dwordx4 v[164:167], v6, s[4:7], s53 offen sc1
    s_add_u32 s53, s53, 20480
    s_waitcnt lgkmcnt(0)
    v_pk_add_f32 v[152:153], v[152:153], v[204:205]
    v_pk_add_f32 v[154:155], v[154:155], v[206:207]
    v_pk_add_f32 v[156:157], v[156:157], v[208:209]
    v_pk_add_f32 v[158:159], v[158:159], v[210:211]
    v_cvt_pk_bf16_f32 v168, v152, v153
    v_cvt_pk_bf16_f32 v170, v156, v157
    v_cvt_pk_bf16_f32 v169, v154, v155
    v_cvt_pk_bf16_f32 v171, v158, v159
    v_permlane16_swap_b32 v168, v170
    s_nop 0
    v_permlane16_swap_b32 v169, v171
    buffer_store_dwordx4 v[168:171], v6, s[4:7], s53 offen sc1
    s_waitcnt vmcnt(0)
    s_barrier
    s_cmp_eq_u64 s[62:63], 0
    s_cbranch_scc1 Lfin_11
    v_mov_b32 v246, 1
    s_mov_b64 exec, s[62:63]
    buffer_atomic_add v246, v247, s[4:7], 0 offen offset:12 sc1
    s_mov_b64 exec, -1
Lfin_11:
    v_pk_add_f32 v[176:177], v[136:137], v[138:139]
    v_pk_mul_f32 v[178:179], v[136:137], v[136:137]
    v_pk_add_f32 v[180:181], v[144:145], v[146:147]
    v_pk_mul_f32 v[182:183], v[144:145], v[144:145]
    v_pk_add_f32 v[184:185], v[152:153], v[154:155]
    v_pk_mul_f32 v[186:187], v[152:153], v[152:153]
    v_pk_fma_f32 v[178:179], v[138:139], v[138:139], v[178:179]
    v_pk_fma_f32 v[182:183], v[146:147], v[146:147], v[182:183]
    v_pk_fma_f32 v[186:187], v[154:155], v[154:155], v[186:187]
    v_pk_add_f32 v[176:177], v[176:177], v[140:141]
    v_pk_fma_f32 v[178:179], v[140:141], v[140:141], v[178:179]
    v_pk_add_f32 v[180:181], v[180:181], v[148:149]
    v_pk_fma_f32 v[182:183], v[148:149], v[148:149], v[182:183]
    v_pk_add_f32 v[184:185], v[184:185], v[156:157]
    v_pk_fma_f32 v[186:187], v[156:157], v[156:157], v[186:187]
    v_pk_add_f32 v[176:177], v[176:177], v[142:143]
    v_pk_fma_f32 v[178:179], v[142:143], v[142:143], v[178:179]
    v_pk_add_f32 v[180:181], v[180:181], v[150:151]
    v_pk_fma_f32 v[182:183], v[150:151], v[150:151], v[182:183]
    v_pk_add_f32 v[184:185], v[184:185], v[158:159]
    v_pk_fma_f32 v[186:187], v[158:159], v[158:159], v[186:187]
    v_add_f32 v176, v176, v177
    v_add_f32 v177, v178, v179
    v_add_f32 v180, v180, v181
    v_add_f32 v181, v182, v183
    v_add_f32 v184, v184, v185
    v_add_f32 v185, v186, v187
    v_permlane16_swap_b32 v176, v177
    v_permlane16_swap_b32 v180, v181
    v_permlane16_swap_b32 v184, v185
    v_add_f32 v176, v176, v177
    v_add_f32 v180, v180, v181
    v_add_f32 v184, v184, v185
    v_mov_b32 v177, v176
    v_mov_b32 v181, v180
    v_mov_b32 v185, v184
    v_permlane32_swap_b32 v176, v177
    v_permlane32_swap_b32 v180, v181
    v_permlane32_swap_b32 v184, v185
    v_add_f32 v176, v176, v177
    v_add_f32 v180, v180, v181
    v_add_f32 v184, v184, v185
    ds_write_b32 v7, v176 offset:0
    ds_write_b32 v7, v180 offset:128
    ds_write_b32 v7, v184 offset:256
L_p4_c_in:
    s_and_b32 s40, s2, 7
    s_min_u32 s41, s40, 3
    s_mul_i32 s40, s40, 30
    s_add_u32 s40, s40, s41
    s_lshr_b32 s41, s2, 3
    s_add_u32 s40, s40, s41
    s_mul_i32 s41, s40, 1041
    s_lshr_b32 s41, s41, 16
    s_mul_i32 s42, s41, 63
    s_sub_u32 s40, s40, s42
    s_cmp_eq_u32 s41, 3
    s_cselect_b32 s42, 6, 7
    s_mov_b32 s43, 9363
    s_cselect_b32 s43, 10923, s43
    s_mul_i32 s41, s41, 7
    s_add_u32 s41, s41, s40
    s_mul_i32 s40, s40, s43
    s_lshr_b32 s40, s40, 16
    s_mul_i32 s42, s42, s40
    s_sub_u32 s41, s41, s42
    s_mul_i32 s50, s48, 14336
    v_lshl_add_u32 v8, v1, 4, s50
    v_add_u32 v10, 28672, v14
    v_xor_b32 v11, 32, v10
    s_mul_i32 s50, s48, 1792
    s_add_u32 s50, s50, 135168
    v_lshl_add_u32 v4, v2, 4, s50
    s_lshl_b32 s50, s49, 7
    s_add_u32 s50, s50, 139264
    v_lshl_add_u32 v5, v3, 4, s50
    v_and_b32 v6, 1, v3
    v_lshlrev_b32 v6, 9, v6
    v_lshrrev_b32 v7, 1, v3
    v_lshl_add_u32 v6, v7, 8, v6
    v_lshl_add_u32 v6, v2, 4, v6
    s_lshl_b32 s50, s40, 1
    s_add_u32 s50, s50, s48
    s_mul_i32 s50, s50, 387072
    s_lshl_b32 s51, s41, 1
    s_add_u32 s51, s51, s49
    s_lshl_b32 s51, s51, 10
    s_add_u32 s50, s50, s51
    s_add_u32 s50, s50, 16777216
    s_waitcnt lgkmcnt(0)
    s_mul_i32 s51, s40, 152922
    s_lshr_b32 s51, s51, 16
    s_mul_i32 s51, s51, 10
    v_add_u32 v247, s51, v1
    v_cmp_gt_u32 vcc, 30, v1
    v_lshlrev_b32 v247, 7, v247
    s_cmp_eq_u32 s3, 0
    s_cselect_b64 s[62:63], vcc, 0
    s_barrier
    s_barrier
    ds_read_b64_tr_b16 v[16:17], v10 offset:0
    ds_read_b64_tr_b16 v[18:19], v10 offset:512
    ds_read_b64_tr_b16 v[20:21], v10 offset:4096
    ds_read_b64_tr_b16 v[22:23], v10 offset:4608
    ds_read_b128 v[80:83], v8 offset:0
    ds_read_b128 v[84:87], v8 offset:1024
    ds_read_b64_tr_b16 v[24:25], v11 offset:0
    ds_read_b64_tr_b16 v[26:27], v11 offset:512
    ds_read_b64_tr_b16 v[28:29], v11 offset:4096
    ds_read_b64_tr_b16 v[30:31], v11 offset:4608
    ds_read_b64_tr_b16 v[32:33], v10 offset:8192
    ds_read_b64_tr_b16 v[34:35], v10 offset:8704
    ds_read_b64_tr_b16 v[36:37], v10 offset:12288
    ds_read_b64_tr_b16 v[38:39], v10 offset:12800
    ds_read_b64_tr_b16 v[40:41], v11 offset:8192
    ds_read_b64_tr_b16 v[42:43], v11 offset:8704
    ds_read_b64_tr_b16 v[44:45], v11 offset:12288
    ds_read_b64_tr_b16 v[46:47], v11 offset:12800
    ds_read_b128 v[88:91], v8 offset:2048
    ds_read_b128 v[92:95], v8 offset:3072
    ds_read_b128 v[96:99], v8 offset:4096
    ds_read_b128 v[100:103], v8 offset:5120
    s_waitcnt lgkmcnt(15)
    v_mfma_f32_16x16x32_bf16 v[128:131], v[16:19], v[80:83], 0
    v_mfma_f32_16x16x32_bf16 v[128:131], v[20:23], v[84:87], v[128:131]
    s_waitcnt lgkmcnt(12)
    v_mfma_f32_16x16x32_bf16 v[132:135], v[24:27], v[80:83], 0
    v_mfma_f32_16x16x32_bf16 v[132:135], v[28:31], v[84:87], v[132:135]
    s_waitcnt lgkmcnt(8)
    v_mfma_f32_16x16x32_bf16 v[136:139], v[32:35], v[80:83], 0
    v_mfma_f32_16x16x32_bf16 v[136:139], v[36:39], v[84:87], v[136:139]
    s_waitcnt lgkmcnt(4)
    v_mfma_f32_16x16x32_bf16 v[140:143], v[40:43], v[80:83], 0
    v_mfma_f32_16x16x32_bf16 v[140:143], v[44:47], v[84:87], v[140:143]
    s_barrier
    s_waitcnt lgkmcnt(2)
    v_mfma_f32_16x16x32_bf16 v[144:147], v[16:19], v[88:91], 0
    ds_read_b128 v[104:107], v8 offset:6144
    v_mfma_f32_16x16x32_bf16 v[144:147], v[20:23], v[92:95], v[144:147]
    ds_read_b128 v[108:111], v8 offset:7168
    v_mfma_f32_16x16x32_bf16 v[148:151], v[24:27], v[88:91], 0
    ds_read_b128 v[80:83], v8 offset:8192
    v_mfma_f32_16x16x32_bf16 v[148:151], v[28:31], v[92:95], v[148:151]
    ds_read_b128 v[84:87], v8 offset:9216
    v_mfma_f32_16x16x32_bf16 v[152:155], v[32:35], v[88:91], 0
    v_mfma_f32_16x16x32_bf16 v[152:155], v[36:39], v[92:95], v[152:155]
    v_mfma_f32_16x16x32_bf16 v[156:159], v[40:43], v[88:91], 0
    v_mfma_f32_16x16x32_bf16 v[156:159], v[44:47], v[92:95], v[156:159]
    s_waitcnt lgkmcnt(4)
    v_mfma_f32_16x16x32_bf16 v[160:163], v[16:19], v[96:99], 0
    ds_read_b128 v[88:91], v8 offset:10240
    v_mfma_f32_16x16x32_bf16 v[160:163], v[20:23], v[100:103], v[160:163]
    ds_read_b128 v[92:95], v8 offset:11264
    v_mfma_f32_16x16x32_bf16 v[164:167], v[24:27], v[96:99], 0
    v_mfma_f32_16x16x32_bf16 v[164:167], v[28:31], v[100:103], v[164:167]
    v_mfma_f32_16x16x32_bf16 v[168:171], v[32:35], v[96:99], 0
    v_mfma_f32_16x16x32_bf16 v[168:171], v[36:39], v[100:103], v[168:171]
    v_mfma_f32_16x16x32_bf16 v[172:175], v[40:43], v[96:99], 0
    v_mfma_f32_16x16x32_bf16 v[172:175], v[44:47], v[100:103], v[172:175]
    s_waitcnt lgkmcnt(4)
    v_mfma_f32_16x16x32_bf16 v[176:179], v[16:19], v[104:107], 0
    ds_read_b128 v[96:99], v8 offset:12288
    v_mfma_f32_16x16x32_bf16 v[176:179], v[20:23], v[108:111], v[176:179]
    ds_read_b128 v[100:103], v8 offset:13312
    v_mfma_f32_16x16x32_bf16 v[180:183], v[24:27], v[104:107], 0
    v_mfma_f32_16x16x32_bf16 v[180:183], v[28:31], v[108:111], v[180:183]
    v_add_u32 v8, 45056, v8
    v_mfma_f32_16x16x32_bf16 v[184:187], v[32:35], v[104:107], 0
    v_add_u32 v10, 45056, v10
    v_mfma_f32_16x16x32_bf16 v[184:187], v[36:39], v[108:111], v[184:187]
    v_add_u32 v11, 45056, v11
    v_mfma_f32_16x16x32_bf16 v[188:191], v[40:43], v[104:107], 0
    s_waitcnt lgkmcnt(0)
    v_mfma_f32_16x16x32_bf16 v[188:191], v[44:47], v[108:111], v[188:191]
    s_barrier
    v_mfma_f32_16x16x32_bf16 v[192:195], v[16:19], v[80:83], 0
    ds_read_b128 v[104:107], v8 offset:0
    v_mfma_f32_16x16x32_bf16 v[192:195], v[20:23], v[84:87], v[192:195]
    ds_read_b128 v[108:111], v8 offset:1024
    v_mfma_f32_16x16x32_bf16 v[196:199], v[24:27], v[80:83], 0
    ds_read_b64_tr_b16 v[48:49], v10 offset:0
    v_mfma_f32_16x16x32_bf16 v[196:199], v[28:31], v[84:87], v[196:199]
    ds_read_b64_tr_b16 v[50:51], v10 offset:512
    v_mfma_f32_16x16x32_bf16 v[200:203], v[32:35], v[80:83], 0
    ds_read_b64_tr_b16 v[52:53], v10 offset:4096
    v_mfma_f32_16x16x32_bf16 v[200:203], v[36:39], v[84:87], v[200:203]
    ds_read_b64_tr_b16 v[54:55], v10 offset:4608
    v_mfma_f32_16x16x32_bf16 v[204:207], v[40:43], v[80:83], 0
    ds_read_b64_tr_b16 v[56:57], v11 offset:0
    v_mfma_f32_16x16x32_bf16 v[204:207], v[44:47], v[84:87], v[204:207]
    ds_read_b64_tr_b16 v[58:59], v11 offset:512
    v_mfma_f32_16x16x32_bf16 v[208:211], v[16:19], v[88:91], 0
    ds_read_b128 v[80:83], v8 offset:2048
    v_mfma_f32_16x16x32_bf16 v[208:211], v[20:23], v[92:95], v[208:211]
    ds_read_b128 v[84:87], v8 offset:3072
    v_mfma_f32_16x16x32_bf16 v[212:215], v[24:27], v[88:91], 0
    ds_read_b64_tr_b16 v[60:61], v11 offset:4096
    v_mfma_f32_16x16x32_bf16 v[212:215], v[28:31], v[92:95], v[212:215]
    ds_read_b64_tr_b16 v[62:63], v11 offset:4608
    v_mfma_f32_16x16x32_bf16 v[216:219], v[32:35], v[88:91], 0
    ds_read_b64_tr_b16 v[64:65], v10 offset:8192
    v_mfma_f32_16x16x32_bf16 v[216:219], v[36:39], v[92:95], v[216:219]
    ds_read_b64_tr_b16 v[66:67], v10 offset:8704
    v_mfma_f32_16x16x32_bf16 v[220:223], v[40:43], v[88:91], 0
    ds_read_b64_tr_b16 v[68:69], v10 offset:12288
    v_mfma_f32_16x16x32_bf16 v[220:223], v[44:47], v[92:95], v[220:223]
    ds_read_b64_tr_b16 v[70:71], v10 offset:12800
    v_mfma_f32_16x16x32_bf16 v[224:227], v[16:19], v[96:99], 0
    ds_read_b128 v[88:91], v8 offset:4096
    v_mfma_f32_16x16x32_bf16 v[224:227], v[20:23], v[100:103], v[224:227]
    ds_read_b128 v[92:95], v8 offset:5120
    v_mfma_f32_16x16x32_bf16 v[228:231], v[24:27], v[96:99], 0
    ds_read_b64_tr_b16 v[72:73], v11 offset:8192
    v_mfma_f32_16x16x32_bf16 v[228:231], v[28:31], v[100:103], v[228:231]
    ds_read_b64_tr_b16 v[74:75], v11 offset:8704
    v_mfma_f32_16x16x32_bf16 v[232:235], v[32:35], v[96:99], 0
    ds_read_b64_tr_b16 v[76:77], v11 offset:12288
    v_mfma_f32_16x16x32_bf16 v[232:235], v[36:39], v[100:103], v[232:235]
    ds_read_b64_tr_b16 v[78:79], v11 offset:12800
    v_mfma_f32_16x16x32_bf16 v[236:239], v[40:43], v[96:99], 0
    v_mfma_f32_16x16x32_bf16 v[236:239], v[44:47], v[100:103], v[236:239]
    s_waitcnt lgkmcnt(0)
    v_mfma_f32_16x16x32_bf16 v[128:131], v[48:51], v[104:107], v[128:131]
    ds_read_b128 v[96:99], v8 offset:6144
    v_mfma_f32_16x16x32_bf16 v[128:131], v[52:55], v[108:111], v[128:131]
    ds_read_b128 v[100:103], v8 offset:7168
    v_mfma_f32_16x16x32_bf16 v[132:135], v[56:59], v[104:107], v[132:135]
    v_mfma_f32_16x16x32_bf16 v[132:135], v[60:63], v[108:111], v[132:135]
    v_mfma_f32_16x16x32_bf16 v[136:139], v[64:67], v[104:107], v[136:139]
    v_mfma_f32_16x16x32_bf16 v[136:139], v[68:71], v[108:111], v[136:139]
    v_mfma_f32_16x16x32_bf16 v[140:143], v[72:75], v[104:107], v[140:143]
    v_mfma_f32_16x16x32_bf16 v[140:143], v[76:79], v[108:111], v[140:143]
    v_mfma_f32_16x16x32_bf16 v[144:147], v[48:51], v[80:83], v[144:147]
    ds_read_b128 v[104:107], v8 offset:8192
    v_mfma_f32_16x16x32_bf16 v[144:147], v[52:55], v[84:87], v[144:147]
    ds_read_b128 v[108:111], v8 offset:9216
    v_mfma_f32_16x16x32_bf16 v[148:151], v[56:59], v[80:83], v[148:151]
    v_mfma_f32_16x16x32_bf16 v[148:151], v[60:63], v[84:87], v[148:151]
    v_mfma_f32_16x16x32_bf16 v[152:155], v[64:67], v[80:83], v[152:155]
    v_mfma_f32_16x16x32_bf16 v[152:155], v[68:71], v[84:87], v[152:155]
    v_mfma_f32_16x16x32_bf16 v[156:159], v[72:75], v[80:83], v[156:159]
    v_mfma_f32_16x16x32_bf16 v[156:159], v[76:79], v[84:87], v[156:159]
    v_mfma_f32_16x16x32_bf16 v[160:163], v[48:51], v[88:91], v[160:163]
    ds_read_b128 v[80:83], v8 offset:10240
    v_mfma_f32_16x16x32_bf16 v[160:163], v[52:55], v[92:95], v[160:163]
    ds_read_b128 v[84:87], v8 offset:11264
    v_mfma_f32_16x16x32_bf16 v[164:167], v[56:59], v[88:91], v[164:167]
    v_mfma_f32_16x16x32_bf16 v[164:167], v[60:63], v[92:95], v[164:167]
    v_mfma_f32_16x16x32_bf16 v[168:171], v[64:67], v[88:91], v[168:171]
    v_mfma_f32_16x16x32_bf16 v[168:171], v[68:71], v[92:95], v[168:171]
    v_mfma_f32_16x16x32_bf16 v[172:175], v[72:75], v[88:91], v[172:175]
    v_mfma_f32_16x16x32_bf16 v[172:175], v[76:79], v[92:95], v[172:175]
    s_waitcnt lgkmcnt(4)
    v_mfma_f32_16x16x32_bf16 v[176:179], v[48:51], v[96:99], v[176:179]
    ds_read_b128 v[88:91], v8 offset:12288
    v_mfma_f32_16x16x32_bf16 v[176:179], v[52:55], v[100:103], v[176:179]
    ds_read_b128 v[92:95], v8 offset:13312
    v_mfma_f32_16x16x32_bf16 v[180:183], v[56:59], v[96:99], v[180:183]
    v_mfma_f32_16x16x32_bf16 v[180:183], v[60:63], v[100:103], v[180:183]
    v_add_u32 v8, 45056, v8
    v_mfma_f32_16x16x32_bf16 v[184:187], v[64:67], v[96:99], v[184:187]
    v_add_u32 v10, 45056, v10
    v_mfma_f32_16x16x32_bf16 v[184:187], v[68:71], v[100:103], v[184:187]
    v_add_u32 v11, 45056, v11
    v_mfma_f32_16x16x32_bf16 v[188:191], v[72:75], v[96:99], v[188:191]
    s_waitcnt lgkmcnt(0)
    v_mfma_f32_16x16x32_bf16 v[188:191], v[76:79], v[100:103], v[188:191]
    s_barrier
    v_mfma_f32_16x16x32_bf16 v[192:195], v[48:51], v[104:107], v[192:195]
    ds_read_b128 v[96:99], v8 offset:0
    v_mfma_f32_16x16x32_bf16 v[192:195], v[52:55], v[108:111], v[192:195]
    ds_read_b128 v[100:103], v8 offset:1024
    v_mfma_f32_16x16x32_bf16 v[196:199], v[56:59], v[104:107], v[196:199]
    ds_read_b64_tr_b16 v[16:17], v10 offset:0
    v_mfma_f32_16x16x32_bf16 v[196:199], v[60:63], v[108:111], v[196:199]
    ds_read_b64_tr_b16 v[18:19], v10 offset:512
    v_mfma_f32_16x16x32_bf16 v[200:203], v[64:67], v[104:107], v[200:203]
    ds_read_b64_tr_b16 v[20:21], v10 offset:4096
    v_mfma_f32_16x16x32_bf16 v[200:203], v[68:71], v[108:111], v[200:203]
    ds_read_b64_tr_b16 v[22:23], v10 offset:4608
    v_mfma_f32_16x16x32_bf16 v[204:207], v[72:75], v[104:107], v[204:207]
    ds_read_b64_tr_b16 v[24:25], v11 offset:0
    v_mfma_f32_16x16x32_bf16 v[204:207], v[76:79], v[108:111], v[204:207]
    ds_read_b64_tr_b16 v[26:27], v11 offset:512
    v_mfma_f32_16x16x32_bf16 v[208:211], v[48:51], v[80:83], v[208:211]
    ds_read_b128 v[104:107], v8 offset:2048
    v_mfma_f32_16x16x32_bf16 v[208:211], v[52:55], v[84:87], v[208:211]
    ds_read_b128 v[108:111], v8 offset:3072
    v_mfma_f32_16x16x32_bf16 v[212:215], v[56:59], v[80:83], v[212:215]
    ds_read_b64_tr_b16 v[28:29], v11 offset:4096
    v_mfma_f32_16x16x32_bf16 v[212:215], v[60:63], v[84:87], v[212:215]
    ds_read_b64_tr_b16 v[30:31], v11 offset:4608
    v_mfma_f32_16x16x32_bf16 v[216:219], v[64:67], v[80:83], v[216:219]
    ds_read_b64_tr_b16 v[32:33], v10 offset:8192
    v_mfma_f32_16x16x32_bf16 v[216:219], v[68:71], v[84:87], v[216:219]
    ds_read_b64_tr_b16 v[34:35], v10 offset:8704
    v_mfma_f32_16x16x32_bf16 v[220:223], v[72:75], v[80:83], v[220:223]
    ds_read_b64_tr_b16 v[36:37], v10 offset:12288
    v_mfma_f32_16x16x32_bf16 v[220:223], v[76:79], v[84:87], v[220:223]
    ds_read_b64_tr_b16 v[38:39], v10 offset:12800
    v_mfma_f32_16x16x32_bf16 v[224:227], v[48:51], v[88:91], v[224:227]
    ds_read_b128 v[80:83], v8 offset:4096
    v_mfma_f32_16x16x32_bf16 v[224:227], v[52:55], v[92:95], v[224:227]
    ds_read_b128 v[84:87], v8 offset:5120
    v_mfma_f32_16x16x32_bf16 v[228:231], v[56:59], v[88:91], v[228:231]
    ds_read_b64_tr_b16 v[40:41], v11 offset:8192
    v_mfma_f32_16x16x32_bf16 v[228:231], v[60:63], v[92:95], v[228:231]
    ds_read_b64_tr_b16 v[42:43], v11 offset:8704
    v_mfma_f32_16x16x32_bf16 v[232:235], v[64:67], v[88:91], v[232:235]
    ds_read_b64_tr_b16 v[44:45], v11 offset:12288
    v_mfma_f32_16x16x32_bf16 v[232:235], v[68:71], v[92:95], v[232:235]
    ds_read_b64_tr_b16 v[46:47], v11 offset:12800
    v_mfma_f32_16x16x32_bf16 v[236:239], v[72:75], v[88:91], v[236:239]
    v_mfma_f32_16x16x32_bf16 v[236:239], v[76:79], v[92:95], v[236:239]
    s_waitcnt lgkmcnt(0)
    v_mfma_f32_16x16x32_bf16 v[128:131], v[16:19], v[96:99], v[128:131]
    ds_read_b128 v[88:91], v8 offset:6144
    v_mfma_f32_16x16x32_bf16 v[128:131], v[20:23], v[100:103], v[128:131]
    ds_read_b128 v[92:95], v8 offset:7168
    v_mfma_f32_16x16x32_bf16 v[132:135], v[24:27], v[96:99], v[132:135]
    v_mfma_f32_16x16x32_bf16 v[132:135], v[28:31], v[100:103], v[132:135]
    v_mfma_f32_16x16x32_bf16 v[136:139], v[32:35], v[96:99], v[136:139]
    v_mfma_f32_16x16x32_bf16 v[136:139], v[36:39], v[100:103], v[136:139]
    v_mfma_f32_16x16x32_bf16 v[140:143], v[40:43], v[96:99], v[140:143]
    v_mfma_f32_16x16x32_bf16 v[140:143], v[44:47], v[100:103], v[140:143]
    v_mfma_f32_16x16x32_bf16 v[144:147], v[16:19], v[104:107], v[144:147]
    ds_read_b128 v[96:99], v8 offset:8192
    v_mfma_f32_16x16x32_bf16 v[144:147], v[20:23], v[108:111], v[144:147]
    ds_read_b128 v[100:103], v8 offset:9216
    v_mfma_f32_16x16x32_bf16 v[148:151], v[24:27], v[104:107], v[148:151]
    v_mfma_f32_16x16x32_bf16 v[148:151], v[28:31], v[108:111], v[148:151]
    v_mfma_f32_16x16x32_bf16 v[152:155], v[32:35], v[104:107], v[152:155]
    v_mfma_f32_16x16x32_bf16 v[152:155], v[36:39], v[108:111], v[152:155]
    v_mfma_f32_16x16x32_bf16 v[156:159], v[40:43], v[104:107], v[156:159]
    v_mfma_f32_16x16x32_bf16 v[156:159], v[44:47], v[108:111], v[156:159]
    v_mfma_f32_16x16x32_bf16 v[160:163], v[16:19], v[80:83], v[160:163]
    ds_read_b128 v[104:107], v8 offset:10240
    v_mfma_f32_16x16x32_bf16 v[160:163], v[20:23], v[84:87], v[160:163]
    ds_read_b128 v[108:111], v8 offset:11264
    v_mfma_f32_16x16x32_bf16 v[164:167], v[24:27], v[80:83], v[164:167]
    v_mfma_f32_16x16x32_bf16 v[164:167], v[28:31], v[84:87], v[164:167]
    v_mfma_f32_16x16x32_bf16 v[168:171], v[32:35], v[80:83], v[168:171]
    v_mfma_f32_16x16x32_bf16 v[168:171], v[36:39], v[84:87], v[168:171]
    v_mfma_f32_16x16x32_bf16 v[172:175], v[40:43], v[80:83], v[172:175]
    v_mfma_f32_16x16x32_bf16 v[172:175], v[44:47], v[84:87], v[172:175]
    s_waitcnt lgkmcnt(4)
    v_mfma_f32_16x16x32_bf16 v[176:179], v[16:19], v[88:91], v[176:179]
    ds_read_b128 v[80:83], v8 offset:12288
    v_mfma_f32_16x16x32_bf16 v[176:179], v[20:23], v[92:95], v[176:179]
    ds_read_b128 v[84:87], v8 offset:13312
    v_mfma_f32_16x16x32_bf16 v[180:183], v[24:27], v[88:91], v[180:183]
    v_mfma_f32_16x16x32_bf16 v[180:183], v[28:31], v[92:95], v[180:183]
    v_add_u32 v8, 4294877184, v8
    v_mfma_f32_16x16x32_bf16 v[184:187], v[32:35], v[88:91], v[184:187]
    v_add_u32 v10, 4294877184, v10
    v_mfma_f32_16x16x32_bf16 v[184:187], v[36:39], v[92:95], v[184:187]
    v_add_u32 v11, 4294877184, v11
    v_mfma_f32_16x16x32_bf16 v[188:191], v[40:43], v[88:91], v[188:191]
    s_waitcnt lgkmcnt(0)
    v_mfma_f32_16x16x32_bf16 v[188:191], v[44:47], v[92:95], v[188:191]
    s_barrier
    v_mfma_f32_16x16x32_bf16 v[192:195], v[16:19], v[96:99], v[192:195]
    ds_read_b128 v[88:91], v8 offset:0
    v_mfma_f32_16x16x32_bf16 v[192:195], v[20:23], v[100:103], v[192:195]
    ds_read_b128 v[92:95], v8 offset:1024
    v_mfma_f32_16x16x32_bf16 v[196:199], v[24:27], v[96:99], v[196:199]
    ds_read_b64_tr_b16 v[48:49], v10 offset:0
    v_mfma_f32_16x16x32_bf16 v[196:199], v[28:31], v[100:103], v[196:199]
    ds_read_b64_tr_b16 v[50:51], v10 offset:512
    v_mfma_f32_16x16x32_bf16 v[200:203], v[32:35], v[96:99], v[200:203]
    ds_read_b64_tr_b16 v[52:53], v10 offset:4096
    v_mfma_f32_16x16x32_bf16 v[200:203], v[36:39], v[100:103], v[200:203]
    ds_read_b64_tr_b16 v[54:55], v10 offset:4608
    v_mfma_f32_16x16x32_bf16 v[204:207], v[40:43], v[96:99], v[204:207]
    ds_read_b64_tr_b16 v[56:57], v11 offset:0
    v_mfma_f32_16x16x32_bf16 v[204:207], v[44:47], v[100:103], v[204:207]
    ds_read_b64_tr_b16 v[58:59], v11 offset:512
    v_mfma_f32_16x16x32_bf16 v[208:211], v[16:19], v[104:107], v[208:211]
    ds_read_b128 v[96:99], v8 offset:2048
    v_mfma_f32_16x16x32_bf16 v[208:211], v[20:23], v[108:111], v[208:211]
    ds_read_b128 v[100:103], v8 offset:3072
    v_mfma_f32_16x16x32_bf16 v[212:215], v[24:27], v[104:107], v[212:215]
    ds_read_b64_tr_b16 v[60:61], v11 offset:4096
    v_mfma_f32_16x16x32_bf16 v[212:215], v[28:31], v[108:111], v[212:215]
    ds_read_b64_tr_b16 v[62:63], v11 offset:4608
    v_mfma_f32_16x16x32_bf16 v[216:219], v[32:35], v[104:107], v[216:219]
    ds_read_b64_tr_b16 v[64:65], v10 offset:8192
    v_mfma_f32_16x16x32_bf16 v[216:219], v[36:39], v[108:111], v[216:219]
    ds_read_b64_tr_b16 v[66:67], v10 offset:8704
    v_mfma_f32_16x16x32_bf16 v[220:223], v[40:43], v[104:107], v[220:223]
    ds_read_b64_tr_b16 v[68:69], v10 offset:12288
    v_mfma_f32_16x16x32_bf16 v[220:223], v[44:47], v[108:111], v[220:223]
    ds_read_b64_tr_b16 v[70:71], v10 offset:12800
    v_mfma_f32_16x16x32_bf16 v[224:227], v[16:19], v[80:83], v[224:227]
    ds_read_b128 v[104:107], v8 offset:4096
    v_mfma_f32_16x16x32_bf16 v[224:227], v[20:23], v[84:87], v[224:227]
    ds_read_b128 v[108:111], v8 offset:5120
    v_mfma_f32_16x16x32_bf16 v[228:231], v[24:27], v[80:83], v[228:231]
    ds_read_b64_tr_b16 v[72:73], v11 offset:8192
    v_mfma_f32_16x16x32_bf16 v[228:231], v[28:31], v[84:87], v[228:231]
    ds_read_b64_tr_b16 v[74:75], v11 offset:8704
    v_mfma_f32_16x16x32_bf16 v[232:235], v[32:35], v[80:83], v[232:235]
    ds_read_b64_tr_b16 v[76:77], v11 offset:12288
    v_mfma_f32_16x16x32_bf16 v[232:235], v[36:39], v[84:87], v[232:235]
    ds_read_b64_tr_b16 v[78:79], v11 offset:12800
    v_mfma_f32_16x16x32_bf16 v[236:239], v[40:43], v[80:83], v[236:239]
    v_mfma_f32_16x16x32_bf16 v[236:239], v[44:47], v[84:87], v[236:239]
    s_waitcnt lgkmcnt(0)
    v_mfma_f32_16x16x32_bf16 v[128:131], v[48:51], v[88:91], v[128:131]
    ds_read_b128 v[80:83], v8 offset:6144
    v_mfma_f32_16x16x32_bf16 v[128:131], v[52:55], v[92:95], v[128:131]
    ds_read_b128 v[84:87], v8 offset:7168
    v_mfma_f32_16x16x32_bf16 v[132:135], v[56:59], v[88:91], v[132:135]
    v_mfma_f32_16x16x32_bf16 v[132:135], v[60:63], v[92:95], v[132:135]
    v_mfma_f32_16x16x32_bf16 v[136:139], v[64:67], v[88:91], v[136:139]
    v_mfma_f32_16x16x32_bf16 v[136:139], v[68:71], v[92:95], v[136:139]
    v_mfma_f32_16x16x32_bf16 v[140:143], v[72:75], v[88:91], v[140:143]
    v_mfma_f32_16x16x32_bf16 v[140:143], v[76:79], v[92:95], v[140:143]
    v_mfma_f32_16x16x32_bf16 v[144:147], v[48:51], v[96:99], v[144:147]
    ds_read_b128 v[88:91], v8 offset:8192
    v_mfma_f32_16x16x32_bf16 v[144:147], v[52:55], v[100:103], v[144:147]
    ds_read_b128 v[92:95], v8 offset:9216
    v_mfma_f32_16x16x32_bf16 v[148:151], v[56:59], v[96:99], v[148:151]
    v_mfma_f32_16x16x32_bf16 v[148:151], v[60:63], v[100:103], v[148:151]
    v_mfma_f32_16x16x32_bf16 v[152:155], v[64:67], v[96:99], v[152:155]
    v_mfma_f32_16x16x32_bf16 v[152:155], v[68:71], v[100:103], v[152:155]
    v_mfma_f32_16x16x32_bf16 v[156:159], v[72:75], v[96:99], v[156:159]
    v_mfma_f32_16x16x32_bf16 v[156:159], v[76:79], v[100:103], v[156:159]
    v_mfma_f32_16x16x32_bf16 v[160:163], v[48:51], v[104:107], v[160:163]
    ds_read_b128 v[96:99], v8 offset:10240
    v_mfma_f32_16x16x32_bf16 v[160:163], v[52:55], v[108:111], v[160:163]
    ds_read_b128 v[100:103], v8 offset:11264
    v_mfma_f32_16x16x32_bf16 v[164:167], v[56:59], v[104:107], v[164:167]
    v_mfma_f32_16x16x32_bf16 v[164:167], v[60:63], v[108:111], v[164:167]
    v_mfma_f32_16x16x32_bf16 v[168:171], v[64:67], v[104:107], v[168:171]
    v_mfma_f32_16x16x32_bf16 v[168:171], v[68:71], v[108:111], v[168:171]
    v_mfma_f32_16x16x32_bf16 v[172:175], v[72:75], v[104:107], v[172:175]
    v_mfma_f32_16x16x32_bf16 v[172:175], v[76:79], v[108:111], v[172:175]
    s_waitcnt lgkmcnt(4)
    v_mfma_f32_16x16x32_bf16 v[176:179], v[48:51], v[80:83], v[176:179]
    ds_read_b128 v[104:107], v8 offset:12288
    v_mfma_f32_16x16x32_bf16 v[176:179], v[52:55], v[84:87], v[176:179]
    ds_read_b128 v[108:111], v8 offset:13312
    v_mfma_f32_16x16x32_bf16 v[180:183], v[56:59], v[80:83], v[180:183]
    v_mfma_f32_16x16x32_bf16 v[180:183], v[60:63], v[84:87], v[180:183]
    v_add_u32 v8, 45056, v8
    v_mfma_f32_16x16x32_bf16 v[184:187], v[64:67], v[80:83], v[184:187]
    v_add_u32 v10, 45056, v10
    v_mfma_f32_16x16x32_bf16 v[184:187], v[68:71], v[84:87], v[184:187]
    v_add_u32 v11, 45056, v11
    v_mfma_f32_16x16x32_bf16 v[188:191], v[72:75], v[80:83], v[188:191]
    s_waitcnt lgkmcnt(0)
    v_mfma_f32_16x16x32_bf16 v[188:191], v[76:79], v[84:87], v[188:191]
    s_barrier
    v_mfma_f32_16x16x32_bf16 v[192:195], v[48:51], v[88:91], v[192:195]
    ds_read_b128 v[80:83], v8 offset:0
    v_mfma_f32_16x16x32_bf16 v[192:195], v[52:55], v[92:95], v[192:195]
    ds_read_b128 v[84:87], v8 offset:1024
    v_mfma_f32_16x16x32_bf16 v[196:199], v[56:59], v[88:91], v[196:199]
    ds_read_b64_tr_b16 v[16:17], v10 offset:0
    v_mfma_f32_16x16x32_bf16 v[196:199], v[60:63], v[92:95], v[196:199]
    ds_read_b64_tr_b16 v[18:19], v10 offset:512
    v_mfma_f32_16x16x32_bf16 v[200:203], v[64:67], v[88:91], v[200:203]
    ds_read_b64_tr_b16 v[20:21], v10 offset:4096
    v_mfma_f32_16x16x32_bf16 v[200:203], v[68:71], v[92:95], v[200:203]
    ds_read_b64_tr_b16 v[22:23], v10 offset:4608
    v_mfma_f32_16x16x32_bf16 v[204:207], v[72:75], v[88:91], v[204:207]
    ds_read_b64_tr_b16 v[24:25], v11 offset:0
    v_mfma_f32_16x16x32_bf16 v[204:207], v[76:79], v[92:95], v[204:207]
    ds_read_b64_tr_b16 v[26:27], v11 offset:512
    v_mfma_f32_16x16x32_bf16 v[208:211], v[48:51], v[96:99], v[208:211]
    ds_read_b128 v[88:91], v8 offset:2048
    v_mfma_f32_16x16x32_bf16 v[208:211], v[52:55], v[100:103], v[208:211]
    ds_read_b128 v[92:95], v8 offset:3072
    v_mfma_f32_16x16x32_bf16 v[212:215], v[56:59], v[96:99], v[212:215]
    ds_read_b64_tr_b16 v[28:29], v11 offset:4096
    v_mfma_f32_16x16x32_bf16 v[212:215], v[60:63], v[100:103], v[212:215]
    ds_read_b64_tr_b16 v[30:31], v11 offset:4608
    v_mfma_f32_16x16x32_bf16 v[216:219], v[64:67], v[96:99], v[216:219]
    ds_read_b64_tr_b16 v[32:33], v10 offset:8192
    v_mfma_f32_16x16x32_bf16 v[216:219], v[68:71], v[100:103], v[216:219]
    ds_read_b64_tr_b16 v[34:35], v10 offset:8704
    v_mfma_f32_16x16x32_bf16 v[220:223], v[72:75], v[96:99], v[220:223]
    ds_read_b64_tr_b16 v[36:37], v10 offset:12288
    v_mfma_f32_16x16x32_bf16 v[220:223], v[76:79], v[100:103], v[220:223]
    ds_read_b64_tr_b16 v[38:39], v10 offset:12800
    v_mfma_f32_16x16x32_bf16 v[224:227], v[48:51], v[104:107], v[224:227]
    ds_read_b128 v[96:99], v8 offset:4096
    v_mfma_f32_16x16x32_bf16 v[224:227], v[52:55], v[108:111], v[224:227]
    ds_read_b128 v[100:103], v8 offset:5120
    v_mfma_f32_16x16x32_bf16 v[228:231], v[56:59], v[104:107], v[228:231]
    ds_read_b64_tr_b16 v[40:41], v11 offset:8192
    v_mfma_f32_16x16x32_bf16 v[228:231], v[60:63], v[108:111], v[228:231]
    ds_read_b64_tr_b16 v[42:43], v11 offset:8704
    v_mfma_f32_16x16x32_bf16 v[232:235], v[64:67], v[104:107], v[232:235]
    ds_read_b64_tr_b16 v[44:45], v11 offset:12288
    v_mfma_f32_16x16x32_bf16 v[232:235], v[68:71], v[108:111], v[232:235]
    ds_read_b64_tr_b16 v[46:47], v11 offset:12800
    v_mfma_f32_16x16x32_bf16 v[236:239], v[72:75], v[104:107], v[236:239]
    v_mfma_f32_16x16x32_bf16 v[236:239], v[76:79], v[108:111], v[236:239]
    s_waitcnt lgkmcnt(0)
    v_mfma_f32_16x16x32_bf16 v[128:131], v[16:19], v[80:83], v[128:131]
    ds_read_b128 v[104:107], v8 offset:6144
    v_mfma_f32_16x16x32_bf16 v[128:131], v[20:23], v[84:87], v[128:131]
    ds_read_b128 v[108:111], v8 offset:7168
    v_mfma_f32_16x16x32_bf16 v[132:135], v[24:27], v[80:83], v[132:135]
    v_mfma_f32_16x16x32_bf16 v[132:135], v[28:31], v[84:87], v[132:135]
    v_mfma_f32_16x16x32_bf16 v[136:139], v[32:35], v[80:83], v[136:139]
    v_mfma_f32_16x16x32_bf16 v[136:139], v[36:39], v[84:87], v[136:139]
    v_mfma_f32_16x16x32_bf16 v[140:143], v[40:43], v[80:83], v[140:143]
    v_mfma_f32_16x16x32_bf16 v[140:143], v[44:47], v[84:87], v[140:143]
    v_mfma_f32_16x16x32_bf16 v[144:147], v[16:19], v[88:91], v[144:147]
    ds_read_b128 v[80:83], v8 offset:8192
    v_mfma_f32_16x16x32_bf16 v[144:147], v[20:23], v[92:95], v[144:147]
    ds_read_b128 v[84:87], v8 offset:9216
    v_mfma_f32_16x16x32_bf16 v[148:151], v[24:27], v[88:91], v[148:151]
    v_mfma_f32_16x16x32_bf16 v[148:151], v[28:31], v[92:95], v[148:151]
    v_mfma_f32_16x16x32_bf16 v[152:155], v[32:35], v[88:91], v[152:155]
    v_mfma_f32_16x16x32_bf16 v[152:155], v[36:39], v[92:95], v[152:155]
    v_mfma_f32_16x16x32_bf16 v[156:159], v[40:43], v[88:91], v[156:159]
    v_mfma_f32_16x16x32_bf16 v[156:159], v[44:47], v[92:95], v[156:159]
    v_mfma_f32_16x16x32_bf16 v[160:163], v[16:19], v[96:99], v[160:163]
    ds_read_b128 v[88:91], v8 offset:10240
    v_mfma_f32_16x16x32_bf16 v[160:163], v[20:23], v[100:103], v[160:163]
    ds_read_b128 v[92:95], v8 offset:11264
    v_mfma_f32_16x16x32_bf16 v[164:167], v[24:27], v[96:99], v[164:167]
    v_mfma_f32_16x16x32_bf16 v[164:167], v[28:31], v[100:103], v[164:167]
    v_mfma_f32_16x16x32_bf16 v[168:171], v[32:35], v[96:99], v[168:171]
    v_mfma_f32_16x16x32_bf16 v[168:171], v[36:39], v[100:103], v[168:171]
    v_mfma_f32_16x16x32_bf16 v[172:175], v[40:43], v[96:99], v[172:175]
    v_mfma_f32_16x16x32_bf16 v[172:175], v[44:47], v[100:103], v[172:175]
    s_waitcnt lgkmcnt(4)
    v_mfma_f32_16x16x32_bf16 v[176:179], v[16:19], v[104:107], v[176:179]
    ds_read_b128 v[96:99], v8 offset:12288
    v_mfma_f32_16x16x32_bf16 v[176:179], v[20:23], v[108:111], v[176:179]
    ds_read_b128 v[100:103], v8 offset:13312
    v_mfma_f32_16x16x32_bf16 v[180:183], v[24:27], v[104:107], v[180:183]
    v_mfma_f32_16x16x32_bf16 v[180:183], v[28:31], v[108:111], v[180:183]
    v_add_u32 v8, 45056, v8
    v_mfma_f32_16x16x32_bf16 v[184:187], v[32:35], v[104:107], v[184:187]
    v_add_u32 v10, 45056, v10
    v_mfma_f32_16x16x32_bf16 v[184:187], v[36:39], v[108:111], v[184:187]
    v_add_u32 v11, 45056, v11
    v_mfma_f32_16x16x32_bf16 v[188:191], v[40:43], v[104:107], v[188:191]
    s_waitcnt lgkmcnt(0)
    v_mfma_f32_16x16x32_bf16 v[188:191], v[44:47], v[108:111], v[188:191]
    s_barrier
    v_mfma_f32_16x16x32_bf16 v[192:195], v[16:19], v[80:83], v[192:195]
    ds_read_b128 v[104:107], v8 offset:0
    v_mfma_f32_16x16x32_bf16 v[192:195], v[20:23], v[84:87], v[192:195]
    ds_read_b128 v[108:111], v8 offset:1024
    v_mfma_f32_16x16x32_bf16 v[196:199], v[24:27], v[80:83], v[196:199]
    ds_read_b64_tr_b16 v[48:49], v10 offset:0
    v_mfma_f32_16x16x32_bf16 v[196:199], v[28:31], v[84:87], v[196:199]
    ds_read_b64_tr_b16 v[50:51], v10 offset:512
    v_mfma_f32_16x16x32_bf16 v[200:203], v[32:35], v[80:83], v[200:203]
    ds_read_b64_tr_b16 v[52:53], v10 offset:4096
    v_mfma_f32_16x16x32_bf16 v[200:203], v[36:39], v[84:87], v[200:203]
    ds_read_b64_tr_b16 v[54:55], v10 offset:4608
    v_mfma_f32_16x16x32_bf16 v[204:207], v[40:43], v[80:83], v[204:207]
    ds_read_b64_tr_b16 v[56:57], v11 offset:0
    v_mfma_f32_16x16x32_bf16 v[204:207], v[44:47], v[84:87], v[204:207]
    ds_read_b64_tr_b16 v[58:59], v11 offset:512
    v_mfma_f32_16x16x32_bf16 v[208:211], v[16:19], v[88:91], v[208:211]
    ds_read_b128 v[80:83], v8 offset:2048
    v_mfma_f32_16x16x32_bf16 v[208:211], v[20:23], v[92:95], v[208:211]
    ds_read_b128 v[84:87], v8 offset:3072
    v_mfma_f32_16x16x32_bf16 v[212:215], v[24:27], v[88:91], v[212:215]
    ds_read_b64_tr_b16 v[60:61], v11 offset:4096
    v_mfma_f32_16x16x32_bf16 v[212:215], v[28:31], v[92:95], v[212:215]
    ds_read_b64_tr_b16 v[62:63], v11 offset:4608
    v_mfma_f32_16x16x32_bf16 v[216:219], v[32:35], v[88:91], v[216:219]
    ds_read_b64_tr_b16 v[64:65], v10 offset:8192
    v_mfma_f32_16x16x32_bf16 v[216:219], v[36:39], v[92:95], v[216:219]
    ds_read_b64_tr_b16 v[66:67], v10 offset:8704
    v_mfma_f32_16x16x32_bf16 v[220:223], v[40:43], v[88:91], v[220:223]
    ds_read_b64_tr_b16 v[68:69], v10 offset:12288
    v_mfma_f32_16x16x32_bf16 v[220:223], v[44:47], v[92:95], v[220:223]
    ds_read_b64_tr_b16 v[70:71], v10 offset:12800
    v_mfma_f32_16x16x32_bf16 v[224:227], v[16:19], v[96:99], v[224:227]
    ds_read_b128 v[88:91], v8 offset:4096
    v_mfma_f32_16x16x32_bf16 v[224:227], v[20:23], v[100:103], v[224:227]
    ds_read_b128 v[92:95], v8 offset:5120
    v_mfma_f32_16x16x32_bf16 v[228:231], v[24:27], v[96:99], v[228:231]
    ds_read_b64_tr_b16 v[72:73], v11 offset:8192
    v_mfma_f32_16x16x32_bf16 v[228:231], v[28:31], v[100:103], v[228:231]
    ds_read_b64_tr_b16 v[74:75], v11 offset:8704
    v_mfma_f32_16x16x32_bf16 v[232:235], v[32:35], v[96:99], v[232:235]
    ds_read_b64_tr_b16 v[76:77], v11 offset:12288
    v_mfma_f32_16x16x32_bf16 v[232:235], v[36:39], v[100:103], v[232:235]
    ds_read_b64_tr_b16 v[78:79], v11 offset:12800
    v_mfma_f32_16x16x32_bf16 v[236:239], v[40:43], v[96:99], v[236:239]
    v_mfma_f32_16x16x32_bf16 v[236:239], v[44:47], v[100:103], v[236:239]
    s_waitcnt lgkmcnt(0)
    v_mfma_f32_16x16x32_bf16 v[128:131], v[48:51], v[104:107], v[128:131]
    ds_read_b128 v[96:99], v8 offset:6144
    v_mfma_f32_16x16x32_bf16 v[128:131], v[52:55], v[108:111], v[128:131]
    ds_read_b128 v[100:103], v8 offset:7168
    v_mfma_f32_16x16x32_bf16 v[132:135], v[56:59], v[104:107], v[132:135]
    v_mfma_f32_16x16x32_bf16 v[132:135], v[60:63], v[108:111], v[132:135]
    v_mfma_f32_16x16x32_bf16 v[136:139], v[64:67], v[104:107], v[136:139]
    v_mfma_f32_16x16x32_bf16 v[136:139], v[68:71], v[108:111], v[136:139]
    v_mfma_f32_16x16x32_bf16 v[140:143], v[72:75], v[104:107], v[140:143]
    v_mfma_f32_16x16x32_bf16 v[140:143], v[76:79], v[108:111], v[140:143]
    v_mfma_f32_16x16x32_bf16 v[144:147], v[48:51], v[80:83], v[144:147]
    ds_read_b128 v[104:107], v8 offset:8192
    v_mfma_f32_16x16x32_bf16 v[144:147], v[52:55], v[84:87], v[144:147]
    ds_read_b128 v[108:111], v8 offset:9216
    v_mfma_f32_16x16x32_bf16 v[148:151], v[56:59], v[80:83], v[148:151]
    v_mfma_f32_16x16x32_bf16 v[148:151], v[60:63], v[84:87], v[148:151]
    v_mfma_f32_16x16x32_bf16 v[152:155], v[64:67], v[80:83], v[152:155]
    v_mfma_f32_16x16x32_bf16 v[152:155], v[68:71], v[84:87], v[152:155]
    v_mfma_f32_16x16x32_bf16 v[156:159], v[72:75], v[80:83], v[156:159]
    v_mfma_f32_16x16x32_bf16 v[156:159], v[76:79], v[84:87], v[156:159]
    v_mfma_f32_16x16x32_bf16 v[160:163], v[48:51], v[88:91], v[160:163]
    ds_read_b128 v[80:83], v8 offset:10240
    v_mfma_f32_16x16x32_bf16 v[160:163], v[52:55], v[92:95], v[160:163]
    ds_read_b128 v[84:87], v8 offset:11264
    v_mfma_f32_16x16x32_bf16 v[164:167], v[56:59], v[88:91], v[164:167]
    v_mfma_f32_16x16x32_bf16 v[164:167], v[60:63], v[92:95], v[164:167]
    v_mfma_f32_16x16x32_bf16 v[168:171], v[64:67], v[88:91], v[168:171]
    v_mfma_f32_16x16x32_bf16 v[168:171], v[68:71], v[92:95], v[168:171]
    v_mfma_f32_16x16x32_bf16 v[172:175], v[72:75], v[88:91], v[172:175]
    v_mfma_f32_16x16x32_bf16 v[172:175], v[76:79], v[92:95], v[172:175]
    s_waitcnt lgkmcnt(4)
    v_mfma_f32_16x16x32_bf16 v[176:179], v[48:51], v[96:99], v[176:179]
    ds_read_b128 v[88:91], v8 offset:12288
    v_mfma_f32_16x16x32_bf16 v[176:179], v[52:55], v[100:103], v[176:179]
    ds_read_b128 v[92:95], v8 offset:13312
    v_mfma_f32_16x16x32_bf16 v[180:183], v[56:59], v[96:99], v[180:183]
    v_mfma_f32_16x16x32_bf16 v[180:183], v[60:63], v[100:103], v[180:183]
    v_add_u32 v8, 4294877184, v8
    v_mfma_f32_16x16x32_bf16 v[184:187], v[64:67], v[96:99], v[184:187]
    v_add_u32 v10, 4294877184, v10
    v_mfma_f32_16x16x32_bf16 v[184:187], v[68:71], v[100:103], v[184:187]
    v_add_u32 v11, 4294877184, v11
    v_mfma_f32_16x16x32_bf16 v[188:191], v[72:75], v[96:99], v[188:191]
    s_waitcnt lgkmcnt(0)
    v_mfma_f32_16x16x32_bf16 v[188:191], v[76:79], v[100:103], v[188:191]
    s_barrier
    v_mfma_f32_16x16x32_bf16 v[192:195], v[48:51], v[104:107], v[192:195]
    ds_read_b128 v[96:99], v8 offset:0
    v_mfma_f32_16x16x32_bf16 v[192:195], v[52:55], v[108:111], v[192:195]
    ds_read_b128 v[100:103], v8 offset:1024
    v_mfma_f32_16x16x32_bf16 v[196:199], v[56:59], v[104:107], v[196:199]
    ds_read_b64_tr_b16 v[16:17], v10 offset:0
    v_mfma_f32_16x16x32_bf16 v[196:199], v[60:63], v[108:111], v[196:199]
    ds_read_b64_tr_b16 v[18:19], v10 offset:512
    v_mfma_f32_16x16x32_bf16 v[200:203], v[64:67], v[104:107], v[200:203]
    ds_read_b64_tr_b16 v[20:21], v10 offset:4096
    v_mfma_f32_16x16x32_bf16 v[200:203], v[68:71], v[108:111], v[200:203]
    ds_read_b64_tr_b16 v[22:23], v10 offset:4608
    v_mfma_f32_16x16x32_bf16 v[204:207], v[72:75], v[104:107], v[204:207]
    ds_read_b64_tr_b16 v[24:25], v11 offset:0
    v_mfma_f32_16x16x32_bf16 v[204:207], v[76:79], v[108:111], v[204:207]
    ds_read_b64_tr_b16 v[26:27], v11 offset:512
    v_mfma_f32_16x16x32_bf16 v[208:211], v[48:51], v[80:83], v[208:211]
    ds_read_b128 v[104:107], v8 offset:2048
    v_mfma_f32_16x16x32_bf16 v[208:211], v[52:55], v[84:87], v[208:211]
    ds_read_b128 v[108:111], v8 offset:3072
    v_mfma_f32_16x16x32_bf16 v[212:215], v[56:59], v[80:83], v[212:215]
    ds_read_b64_tr_b16 v[28:29], v11 offset:4096
    v_mfma_f32_16x16x32_bf16 v[212:215], v[60:63], v[84:87], v[212:215]
    ds_read_b64_tr_b16 v[30:31], v11 offset:4608
    v_mfma_f32_16x16x32_bf16 v[216:219], v[64:67], v[80:83], v[216:219]
    ds_read_b64_tr_b16 v[32:33], v10 offset:8192
    v_mfma_f32_16x16x32_bf16 v[216:219], v[68:71], v[84:87], v[216:219]
    ds_read_b64_tr_b16 v[34:35], v10 offset:8704
    v_mfma_f32_16x16x32_bf16 v[220:223], v[72:75], v[80:83], v[220:223]
    ds_read_b64_tr_b16 v[36:37], v10 offset:12288
    v_mfma_f32_16x16x32_bf16 v[220:223], v[76:79], v[84:87], v[220:223]
    ds_read_b64_tr_b16 v[38:39], v10 offset:12800
    v_mfma_f32_16x16x32_bf16 v[224:227], v[48:51], v[88:91], v[224:227]
    ds_read_b128 v[80:83], v8 offset:4096
    v_mfma_f32_16x16x32_bf16 v[224:227], v[52:55], v[92:95], v[224:227]
    ds_read_b128 v[84:87], v8 offset:5120
    v_mfma_f32_16x16x32_bf16 v[228:231], v[56:59], v[88:91], v[228:231]
    ds_read_b64_tr_b16 v[40:41], v11 offset:8192
    v_mfma_f32_16x16x32_bf16 v[228:231], v[60:63], v[92:95], v[228:231]
    ds_read_b64_tr_b16 v[42:43], v11 offset:8704
    v_mfma_f32_16x16x32_bf16 v[232:235], v[64:67], v[88:91], v[232:235]
    ds_read_b64_tr_b16 v[44:45], v11 offset:12288
    v_mfma_f32_16x16x32_bf16 v[232:235], v[68:71], v[92:95], v[232:235]
    ds_read_b64_tr_b16 v[46:47], v11 offset:12800
    v_mfma_f32_16x16x32_bf16 v[236:239], v[72:75], v[88:91], v[236:239]
    v_mfma_f32_16x16x32_bf16 v[236:239], v[76:79], v[92:95], v[236:239]
    s_waitcnt lgkmcnt(0)
    v_mfma_f32_16x16x32_bf16 v[128:131], v[16:19], v[96:99], v[128:131]
    ds_read_b128 v[88:91], v8 offset:6144
    v_mfma_f32_16x16x32_bf16 v[128:131], v[20:23], v[100:103], v[128:131]
    ds_read_b128 v[92:95], v8 offset:7168
    v_mfma_f32_16x16x32_bf16 v[132:135], v[24:27], v[96:99], v[132:135]
    v_mfma_f32_16x16x32_bf16 v[132:135], v[28:31], v[100:103], v[132:135]
    v_mfma_f32_16x16x32_bf16 v[136:139], v[32:35], v[96:99], v[136:139]
    v_mfma_f32_16x16x32_bf16 v[136:139], v[36:39], v[100:103], v[136:139]
    v_mfma_f32_16x16x32_bf16 v[140:143], v[40:43], v[96:99], v[140:143]
    v_mfma_f32_16x16x32_bf16 v[140:143], v[44:47], v[100:103], v[140:143]
    v_mfma_f32_16x16x32_bf16 v[144:147], v[16:19], v[104:107], v[144:147]
    ds_read_b128 v[96:99], v8 offset:8192
    v_mfma_f32_16x16x32_bf16 v[144:147], v[20:23], v[108:111], v[144:147]
    ds_read_b128 v[100:103], v8 offset:9216
    v_mfma_f32_16x16x32_bf16 v[148:151], v[24:27], v[104:107], v[148:151]
    v_mfma_f32_16x16x32_bf16 v[148:151], v[28:31], v[108:111], v[148:151]
    v_mfma_f32_16x16x32_bf16 v[152:155], v[32:35], v[104:107], v[152:155]
    v_mfma_f32_16x16x32_bf16 v[152:155], v[36:39], v[108:111], v[152:155]
    v_mfma_f32_16x16x32_bf16 v[156:159], v[40:43], v[104:107], v[156:159]
    v_mfma_f32_16x16x32_bf16 v[156:159], v[44:47], v[108:111], v[156:159]
    v_mfma_f32_16x16x32_bf16 v[160:163], v[16:19], v[80:83], v[160:163]
    ds_read_b128 v[104:107], v8 offset:10240
    v_mfma_f32_16x16x32_bf16 v[160:163], v[20:23], v[84:87], v[160:163]
    ds_read_b128 v[108:111], v8 offset:11264
    v_mfma_f32_16x16x32_bf16 v[164:167], v[24:27], v[80:83], v[164:167]
    v_mfma_f32_16x16x32_bf16 v[164:167], v[28:31], v[84:87], v[164:167]
    v_mfma_f32_16x16x32_bf16 v[168:171], v[32:35], v[80:83], v[168:171]
    v_mfma_f32_16x16x32_bf16 v[168:171], v[36:39], v[84:87], v[168:171]
    v_mfma_f32_16x16x32_bf16 v[172:175], v[40:43], v[80:83], v[172:175]
    v_mfma_f32_16x16x32_bf16 v[172:175], v[44:47], v[84:87], v[172:175]
    s_waitcnt lgkmcnt(4)
    v_mfma_f32_16x16x32_bf16 v[176:179], v[16:19], v[88:91], v[176:179]
    ds_read_b128 v[80:83], v8 offset:12288
    v_mfma_f32_16x16x32_bf16 v[176:179], v[20:23], v[92:95], v[176:179]
    ds_read_b128 v[84:87], v8 offset:13312
    v_mfma_f32_16x16x32_bf16 v[180:183], v[24:27], v[88:91], v[180:183]
    v_mfma_f32_16x16x32_bf16 v[180:183], v[28:31], v[92:95], v[180:183]
    v_add_u32 v8, 45056, v8
    v_mfma_f32_16x16x32_bf16 v[184:187], v[32:35], v[88:91], v[184:187]
    v_add_u32 v10, 45056, v10
    v_mfma_f32_16x16x32_bf16 v[184:187], v[36:39], v[92:95], v[184:187]
    v_add_u32 v11, 45056, v11
    v_mfma_f32_16x16x32_bf16 v[188:191], v[40:43], v[88:91], v[188:191]
    s_waitcnt lgkmcnt(0)
    v_mfma_f32_16x16x32_bf16 v[188:191], v[44:47], v[92:95], v[188:191]
    s_barrier
    v_mfma_f32_16x16x32_bf16 v[192:195], v[16:19], v[96:99], v[192:195]
    ds_read_b128 v[88:91], v8 offset:0
    v_mfma_f32_16x16x32_bf16 v[192:195], v[20:23], v[100:103], v[192:195]
    ds_read_b128 v[92:95], v8 offset:1024
    v_mfma_f32_16x16x32_bf16 v[196:199], v[24:27], v[96:99], v[196:199]
    ds_read_b64_tr_b16 v[48:49], v10 offset:0
    v_mfma_f32_16x16x32_bf16 v[196:199], v[28:31], v[100:103], v[196:199]
    ds_read_b64_tr_b16 v[50:51], v10 offset:512
    v_mfma_f32_16x16x32_bf16 v[200:203], v[32:35], v[96:99], v[200:203]
    ds_read_b64_tr_b16 v[52:53], v10 offset:4096
    v_mfma_f32_16x16x32_bf16 v[200:203], v[36:39], v[100:103], v[200:203]
    ds_read_b64_tr_b16 v[54:55], v10 offset:4608
    v_mfma_f32_16x16x32_bf16 v[204:207], v[40:43], v[96:99], v[204:207]
    ds_read_b64_tr_b16 v[56:57], v11 offset:0
    v_mfma_f32_16x16x32_bf16 v[204:207], v[44:47], v[100:103], v[204:207]
    ds_read_b64_tr_b16 v[58:59], v11 offset:512
    v_mfma_f32_16x16x32_bf16 v[208:211], v[16:19], v[104:107], v[208:211]
    ds_read_b128 v[96:99], v8 offset:2048
    v_mfma_f32_16x16x32_bf16 v[208:211], v[20:23], v[108:111], v[208:211]
    ds_read_b128 v[100:103], v8 offset:3072
    v_mfma_f32_16x16x32_bf16 v[212:215], v[24:27], v[104:107], v[212:215]
    ds_read_b64_tr_b16 v[60:61], v11 offset:4096
    v_mfma_f32_16x16x32_bf16 v[212:215], v[28:31], v[108:111], v[212:215]
    ds_read_b64_tr_b16 v[62:63], v11 offset:4608
    v_mfma_f32_16x16x32_bf16 v[216:219], v[32:35], v[104:107], v[216:219]
    ds_read_b64_tr_b16 v[64:65], v10 offset:8192
    v_mfma_f32_16x16x32_bf16 v[216:219], v[36:39], v[108:111], v[216:219]
    ds_read_b64_tr_b16 v[66:67], v10 offset:8704
    v_mfma_f32_16x16x32_bf16 v[220:223], v[40:43], v[104:107], v[220:223]
    ds_read_b64_tr_b16 v[68:69], v10 offset:12288
    v_mfma_f32_16x16x32_bf16 v[220:223], v[44:47], v[108:111], v[220:223]
    ds_read_b64_tr_b16 v[70:71], v10 offset:12800
    v_mfma_f32_16x16x32_bf16 v[224:227], v[16:19], v[80:83], v[224:227]
    ds_read_b128 v[104:107], v8 offset:4096
    v_mfma_f32_16x16x32_bf16 v[224:227], v[20:23], v[84:87], v[224:227]
    ds_read_b128 v[108:111], v8 offset:5120
    v_mfma_f32_16x16x32_bf16 v[228:231], v[24:27], v[80:83], v[228:231]
    ds_read_b64_tr_b16 v[72:73], v11 offset:8192
    v_mfma_f32_16x16x32_bf16 v[228:231], v[28:31], v[84:87], v[228:231]
    ds_read_b64_tr_b16 v[74:75], v11 offset:8704
    v_mfma_f32_16x16x32_bf16 v[232:235], v[32:35], v[80:83], v[232:235]
    ds_read_b64_tr_b16 v[76:77], v11 offset:12288
    v_mfma_f32_16x16x32_bf16 v[232:235], v[36:39], v[84:87], v[232:235]
    ds_read_b64_tr_b16 v[78:79], v11 offset:12800
    v_mfma_f32_16x16x32_bf16 v[236:239], v[40:43], v[80:83], v[236:239]
    v_mfma_f32_16x16x32_bf16 v[236:239], v[44:47], v[84:87], v[236:239]
    s_waitcnt lgkmcnt(0)
    v_mfma_f32_16x16x32_bf16 v[128:131], v[48:51], v[88:91], v[128:131]
    ds_read_b128 v[80:83], v8 offset:6144
    v_mfma_f32_16x16x32_bf16 v[128:131], v[52:55], v[92:95], v[128:131]
    ds_read_b128 v[84:87], v8 offset:7168
    v_mfma_f32_16x16x32_bf16 v[132:135], v[56:59], v[88:91], v[132:135]
    v_mfma_f32_16x16x32_bf16 v[132:135], v[60:63], v[92:95], v[132:135]
    v_mfma_f32_16x16x32_bf16 v[136:139], v[64:67], v[88:91], v[136:139]
    v_mfma_f32_16x16x32_bf16 v[136:139], v[68:71], v[92:95], v[136:139]
    v_mfma_f32_16x16x32_bf16 v[140:143], v[72:75], v[88:91], v[140:143]
    v_mfma_f32_16x16x32_bf16 v[140:143], v[76:79], v[92:95], v[140:143]
    v_mfma_f32_16x16x32_bf16 v[144:147], v[48:51], v[96:99], v[144:147]
    ds_read_b128 v[88:91], v8 offset:8192
    v_mfma_f32_16x16x32_bf16 v[144:147], v[52:55], v[100:103], v[144:147]
    ds_read_b128 v[92:95], v8 offset:9216
    v_mfma_f32_16x16x32_bf16 v[148:151], v[56:59], v[96:99], v[148:151]
    v_mfma_f32_16x16x32_bf16 v[148:151], v[60:63], v[100:103], v[148:151]
    v_mfma_f32_16x16x32_bf16 v[152:155], v[64:67], v[96:99], v[152:155]
    v_mfma_f32_16x16x32_bf16 v[152:155], v[68:71], v[100:103], v[152:155]
    v_mfma_f32_16x16x32_bf16 v[156:159], v[72:75], v[96:99], v[156:159]
    v_mfma_f32_16x16x32_bf16 v[156:159], v[76:79], v[100:103], v[156:159]
    v_mfma_f32_16x16x32_bf16 v[160:163], v[48:51], v[104:107], v[160:163]
    ds_read_b128 v[96:99], v8 offset:10240
    v_mfma_f32_16x16x32_bf16 v[160:163], v[52:55], v[108:111], v[160:163]
    ds_read_b128 v[100:103], v8 offset:11264
    v_mfma_f32_16x16x32_bf16 v[164:167], v[56:59], v[104:107], v[164:167]
    v_mfma_f32_16x16x32_bf16 v[164:167], v[60:63], v[108:111], v[164:167]
    v_mfma_f32_16x16x32_bf16 v[168:171], v[64:67], v[104:107], v[168:171]
    v_mfma_f32_16x16x32_bf16 v[168:171], v[68:71], v[108:111], v[168:171]
    v_mfma_f32_16x16x32_bf16 v[172:175], v[72:75], v[104:107], v[172:175]
    v_mfma_f32_16x16x32_bf16 v[172:175], v[76:79], v[108:111], v[172:175]
    s_waitcnt lgkmcnt(4)
    v_mfma_f32_16x16x32_bf16 v[176:179], v[48:51], v[80:83], v[176:179]
    ds_read_b128 v[104:107], v8 offset:12288
    v_mfma_f32_16x16x32_bf16 v[176:179], v[52:55], v[84:87], v[176:179]
    ds_read_b128 v[108:111], v8 offset:13312
    v_mfma_f32_16x16x32_bf16 v[180:183], v[56:59], v[80:83], v[180:183]
    v_mfma_f32_16x16x32_bf16 v[180:183], v[60:63], v[84:87], v[180:183]
    v_add_u32 v8, 45056, v8
    v_mfma_f32_16x16x32_bf16 v[184:187], v[64:67], v[80:83], v[184:187]
    v_add_u32 v10, 45056, v10
    v_mfma_f32_16x16x32_bf16 v[184:187], v[68:71], v[84:87], v[184:187]
    v_add_u32 v11, 45056, v11
    v_mfma_f32_16x16x32_bf16 v[188:191], v[72:75], v[80:83], v[188:191]
    s_waitcnt lgkmcnt(0)
    v_mfma_f32_16x16x32_bf16 v[188:191], v[76:79], v[84:87], v[188:191]
    s_barrier
    v_mfma_f32_16x16x32_bf16 v[192:195], v[48:51], v[88:91], v[192:195]
    ds_read_b128 v[80:83], v8 offset:0
    v_mfma_f32_16x16x32_bf16 v[192:195], v[52:55], v[92:95], v[192:195]
    ds_read_b128 v[84:87], v8 offset:1024
    v_mfma_f32_16x16x32_bf16 v[196:199], v[56:59], v[88:91], v[196:199]
    ds_read_b64_tr_b16 v[16:17], v10 offset:0
    v_mfma_f32_16x16x32_bf16 v[196:199], v[60:63], v[92:95], v[196:199]
    ds_read_b64_tr_b16 v[18:19], v10 offset:512
    v_mfma_f32_16x16x32_bf16 v[200:203], v[64:67], v[88:91], v[200:203]
    ds_read_b64_tr_b16 v[20:21], v10 offset:4096
    v_mfma_f32_16x16x32_bf16 v[200:203], v[68:71], v[92:95], v[200:203]
    ds_read_b64_tr_b16 v[22:23], v10 offset:4608
    v_mfma_f32_16x16x32_bf16 v[204:207], v[72:75], v[88:91], v[204:207]
    ds_read_b64_tr_b16 v[24:25], v11 offset:0
    v_mfma_f32_16x16x32_bf16 v[204:207], v[76:79], v[92:95], v[204:207]
    ds_read_b64_tr_b16 v[26:27], v11 offset:512
    v_mfma_f32_16x16x32_bf16 v[208:211], v[48:51], v[96:99], v[208:211]
    ds_read_b128 v[88:91], v8 offset:2048
    v_mfma_f32_16x16x32_bf16 v[208:211], v[52:55], v[100:103], v[208:211]
    ds_read_b128 v[92:95], v8 offset:3072
    v_mfma_f32_16x16x32_bf16 v[212:215], v[56:59], v[96:99], v[212:215]
    ds_read_b64_tr_b16 v[28:29], v11 offset:4096
    v_mfma_f32_16x16x32_bf16 v[212:215], v[60:63], v[100:103], v[212:215]
    ds_read_b64_tr_b16 v[30:31], v11 offset:4608
    v_mfma_f32_16x16x32_bf16 v[216:219], v[64:67], v[96:99], v[216:219]
    ds_read_b64_tr_b16 v[32:33], v10 offset:8192
    v_mfma_f32_16x16x32_bf16 v[216:219], v[68:71], v[100:103], v[216:219]
    ds_read_b64_tr_b16 v[34:35], v10 offset:8704
    v_mfma_f32_16x16x32_bf16 v[220:223], v[72:75], v[96:99], v[220:223]
    ds_read_b64_tr_b16 v[36:37], v10 offset:12288
    v_mfma_f32_16x16x32_bf16 v[220:223], v[76:79], v[100:103], v[220:223]
    ds_read_b64_tr_b16 v[38:39], v10 offset:12800
    v_mfma_f32_16x16x32_bf16 v[224:227], v[48:51], v[104:107], v[224:227]
    ds_read_b128 v[96:99], v8 offset:4096
    v_mfma_f32_16x16x32_bf16 v[224:227], v[52:55], v[108:111], v[224:227]
    ds_read_b128 v[100:103], v8 offset:5120
    v_mfma_f32_16x16x32_bf16 v[228:231], v[56:59], v[104:107], v[228:231]
    ds_read_b64_tr_b16 v[40:41], v11 offset:8192
    v_mfma_f32_16x16x32_bf16 v[228:231], v[60:63], v[108:111], v[228:231]
    ds_read_b64_tr_b16 v[42:43], v11 offset:8704
    v_mfma_f32_16x16x32_bf16 v[232:235], v[64:67], v[104:107], v[232:235]
    ds_read_b64_tr_b16 v[44:45], v11 offset:12288
    v_mfma_f32_16x16x32_bf16 v[232:235], v[68:71], v[108:111], v[232:235]
    ds_read_b64_tr_b16 v[46:47], v11 offset:12800
    v_mfma_f32_16x16x32_bf16 v[236:239], v[72:75], v[104:107], v[236:239]
    v_mfma_f32_16x16x32_bf16 v[236:239], v[76:79], v[108:111], v[236:239]
    s_waitcnt lgkmcnt(0)
    v_mfma_f32_16x16x32_bf16 v[128:131], v[16:19], v[80:83], v[128:131]
    ds_read_b128 v[104:107], v8 offset:6144
    v_mfma_f32_16x16x32_bf16 v[128:131], v[20:23], v[84:87], v[128:131]
    ds_read_b128 v[108:111], v8 offset:7168
    v_mfma_f32_16x16x32_bf16 v[132:135], v[24:27], v[80:83], v[132:135]
    v_mfma_f32_16x16x32_bf16 v[132:135], v[28:31], v[84:87], v[132:135]
    v_mfma_f32_16x16x32_bf16 v[136:139], v[32:35], v[80:83], v[136:139]
    v_mfma_f32_16x16x32_bf16 v[136:139], v[36:39], v[84:87], v[136:139]
    v_mfma_f32_16x16x32_bf16 v[140:143], v[40:43], v[80:83], v[140:143]
    v_mfma_f32_16x16x32_bf16 v[140:143], v[44:47], v[84:87], v[140:143]
    v_mfma_f32_16x16x32_bf16 v[144:147], v[16:19], v[88:91], v[144:147]
    ds_read_b128 v[80:83], v8 offset:8192
    v_mfma_f32_16x16x32_bf16 v[144:147], v[20:23], v[92:95], v[144:147]
    ds_read_b128 v[84:87], v8 offset:9216
    v_mfma_f32_16x16x32_bf16 v[148:151], v[24:27], v[88:91], v[148:151]
    v_mfma_f32_16x16x32_bf16 v[148:151], v[28:31], v[92:95], v[148:151]
    v_mfma_f32_16x16x32_bf16 v[152:155], v[32:35], v[88:91], v[152:155]
    v_mfma_f32_16x16x32_bf16 v[152:155], v[36:39], v[92:95], v[152:155]
    v_mfma_f32_16x16x32_bf16 v[156:159], v[40:43], v[88:91], v[156:159]
    v_mfma_f32_16x16x32_bf16 v[156:159], v[44:47], v[92:95], v[156:159]
    v_mfma_f32_16x16x32_bf16 v[160:163], v[16:19], v[96:99], v[160:163]
    ds_read_b128 v[88:91], v8 offset:10240
    v_mfma_f32_16x16x32_bf16 v[160:163], v[20:23], v[100:103], v[160:163]
    ds_read_b128 v[92:95], v8 offset:11264
    v_mfma_f32_16x16x32_bf16 v[164:167], v[24:27], v[96:99], v[164:167]
    v_mfma_f32_16x16x32_bf16 v[164:167], v[28:31], v[100:103], v[164:167]
    v_mfma_f32_16x16x32_bf16 v[168:171], v[32:35], v[96:99], v[168:171]
    v_mfma_f32_16x16x32_bf16 v[168:171], v[36:39], v[100:103], v[168:171]
    v_mfma_f32_16x16x32_bf16 v[172:175], v[40:43], v[96:99], v[172:175]
    v_mfma_f32_16x16x32_bf16 v[172:175], v[44:47], v[100:103], v[172:175]
    s_waitcnt lgkmcnt(4)
    v_mfma_f32_16x16x32_bf16 v[176:179], v[16:19], v[104:107], v[176:179]
    ds_read_b128 v[96:99], v8 offset:12288
    v_mfma_f32_16x16x32_bf16 v[176:179], v[20:23], v[108:111], v[176:179]
    ds_read_b128 v[100:103], v8 offset:13312
    v_mfma_f32_16x16x32_bf16 v[180:183], v[24:27], v[104:107], v[180:183]
    v_mfma_f32_16x16x32_bf16 v[180:183], v[28:31], v[108:111], v[180:183]
    v_add_u32 v8, 4294877184, v8
    v_mfma_f32_16x16x32_bf16 v[184:187], v[32:35], v[104:107], v[184:187]
    v_add_u32 v10, 4294877184, v10
    v_mfma_f32_16x16x32_bf16 v[184:187], v[36:39], v[108:111], v[184:187]
    v_add_u32 v11, 4294877184, v11
    v_mfma_f32_16x16x32_bf16 v[188:191], v[40:43], v[104:107], v[188:191]
    s_waitcnt lgkmcnt(0)
    v_mfma_f32_16x16x32_bf16 v[188:191], v[44:47], v[108:111], v[188:191]
    s_barrier
    v_mfma_f32_16x16x32_bf16 v[192:195], v[16:19], v[80:83], v[192:195]
    ds_read_b128 v[104:107], v8 offset:0
    v_mfma_f32_16x16x32_bf16 v[192:195], v[20:23], v[84:87], v[192:195]
    ds_read_b128 v[108:111], v8 offset:1024
    v_mfma_f32_16x16x32_bf16 v[196:199], v[24:27], v[80:83], v[196:199]
    ds_read_b64_tr_b16 v[48:49], v10 offset:0
    v_mfma_f32_16x16x32_bf16 v[196:199], v[28:31], v[84:87], v[196:199]
    ds_read_b64_tr_b16 v[50:51], v10 offset:512
    v_mfma_f32_16x16x32_bf16 v[200:203], v[32:35], v[80:83], v[200:203]
    ds_read_b64_tr_b16 v[52:53], v10 offset:4096
    v_mfma_f32_16x16x32_bf16 v[200:203], v[36:39], v[84:87], v[200:203]
    ds_read_b64_tr_b16 v[54:55], v10 offset:4608
    v_mfma_f32_16x16x32_bf16 v[204:207], v[40:43], v[80:83], v[204:207]
    ds_read_b64_tr_b16 v[56:57], v11 offset:0
    v_mfma_f32_16x16x32_bf16 v[204:207], v[44:47], v[84:87], v[204:207]
    ds_read_b64_tr_b16 v[58:59], v11 offset:512
    v_mfma_f32_16x16x32_bf16 v[208:211], v[16:19], v[88:91], v[208:211]
    ds_read_b128 v[80:83], v8 offset:2048
    v_mfma_f32_16x16x32_bf16 v[208:211], v[20:23], v[92:95], v[208:211]
    ds_read_b128 v[84:87], v8 offset:3072
    v_mfma_f32_16x16x32_bf16 v[212:215], v[24:27], v[88:91], v[212:215]
    ds_read_b64_tr_b16 v[60:61], v11 offset:4096
    v_mfma_f32_16x16x32_bf16 v[212:215], v[28:31], v[92:95], v[212:215]
    ds_read_b64_tr_b16 v[62:63], v11 offset:4608
    v_mfma_f32_16x16x32_bf16 v[216:219], v[32:35], v[88:91], v[216:219]
    ds_read_b64_tr_b16 v[64:65], v10 offset:8192
    v_mfma_f32_16x16x32_bf16 v[216:219], v[36:39], v[92:95], v[216:219]
    ds_read_b64_tr_b16 v[66:67], v10 offset:8704
    v_mfma_f32_16x16x32_bf16 v[220:223], v[40:43], v[88:91], v[220:223]
    ds_read_b64_tr_b16 v[68:69], v10 offset:12288
    v_mfma_f32_16x16x32_bf16 v[220:223], v[44:47], v[92:95], v[220:223]
    ds_read_b64_tr_b16 v[70:71], v10 offset:12800
    v_mfma_f32_16x16x32_bf16 v[224:227], v[16:19], v[96:99], v[224:227]
    ds_read_b128 v[88:91], v8 offset:4096
    v_mfma_f32_16x16x32_bf16 v[224:227], v[20:23], v[100:103], v[224:227]
    ds_read_b128 v[92:95], v8 offset:5120
    v_mfma_f32_16x16x32_bf16 v[228:231], v[24:27], v[96:99], v[228:231]
    ds_read_b64_tr_b16 v[72:73], v11 offset:8192
    v_mfma_f32_16x16x32_bf16 v[228:231], v[28:31], v[100:103], v[228:231]
    ds_read_b64_tr_b16 v[74:75], v11 offset:8704
    v_mfma_f32_16x16x32_bf16 v[232:235], v[32:35], v[96:99], v[232:235]
    ds_read_b64_tr_b16 v[76:77], v11 offset:12288
    v_mfma_f32_16x16x32_bf16 v[232:235], v[36:39], v[100:103], v[232:235]
    ds_read_b64_tr_b16 v[78:79], v11 offset:12800
    v_mfma_f32_16x16x32_bf16 v[236:239], v[40:43], v[96:99], v[236:239]
    v_mfma_f32_16x16x32_bf16 v[236:239], v[44:47], v[100:103], v[236:239]
    s_waitcnt lgkmcnt(0)
    v_mfma_f32_16x16x32_bf16 v[128:131], v[48:51], v[104:107], v[128:131]
    ds_read_b128 v[96:99], v8 offset:6144
    v_mfma_f32_16x16x32_bf16 v[128:131], v[52:55], v[108:111], v[128:131]
    ds_read_b128 v[100:103], v8 offset:7168
    v_mfma_f32_16x16x32_bf16 v[132:135], v[56:59], v[104:107], v[132:135]
    v_mfma_f32_16x16x32_bf16 v[132:135], v[60:63], v[108:111], v[132:135]
    v_mfma_f32_16x16x32_bf16 v[136:139], v[64:67], v[104:107], v[136:139]
    v_mfma_f32_16x16x32_bf16 v[136:139], v[68:71], v[108:111], v[136:139]
    v_mfma_f32_16x16x32_bf16 v[140:143], v[72:75], v[104:107], v[140:143]
    v_mfma_f32_16x16x32_bf16 v[140:143], v[76:79], v[108:111], v[140:143]
    v_mfma_f32_16x16x32_bf16 v[144:147], v[48:51], v[80:83], v[144:147]
    ds_read_b128 v[104:107], v8 offset:8192
    v_mfma_f32_16x16x32_bf16 v[144:147], v[52:55], v[84:87], v[144:147]
    ds_read_b128 v[108:111], v8 offset:9216
    v_mfma_f32_16x16x32_bf16 v[148:151], v[56:59], v[80:83], v[148:151]
    v_mfma_f32_16x16x32_bf16 v[148:151], v[60:63], v[84:87], v[148:151]
    v_mfma_f32_16x16x32_bf16 v[152:155], v[64:67], v[80:83], v[152:155]
    v_mfma_f32_16x16x32_bf16 v[152:155], v[68:71], v[84:87], v[152:155]
    v_mfma_f32_16x16x32_bf16 v[156:159], v[72:75], v[80:83], v[156:159]
    v_mfma_f32_16x16x32_bf16 v[156:159], v[76:79], v[84:87], v[156:159]
    v_mfma_f32_16x16x32_bf16 v[160:163], v[48:51], v[88:91], v[160:163]
    ds_read_b128 v[80:83], v8 offset:10240
    v_mfma_f32_16x16x32_bf16 v[160:163], v[52:55], v[92:95], v[160:163]
    ds_read_b128 v[84:87], v8 offset:11264
    v_mfma_f32_16x16x32_bf16 v[164:167], v[56:59], v[88:91], v[164:167]
    v_mfma_f32_16x16x32_bf16 v[164:167], v[60:63], v[92:95], v[164:167]
    v_mfma_f32_16x16x32_bf16 v[168:171], v[64:67], v[88:91], v[168:171]
    v_mfma_f32_16x16x32_bf16 v[168:171], v[68:71], v[92:95], v[168:171]
    v_mfma_f32_16x16x32_bf16 v[172:175], v[72:75], v[88:91], v[172:175]
    v_mfma_f32_16x16x32_bf16 v[172:175], v[76:79], v[92:95], v[172:175]
    s_waitcnt lgkmcnt(4)
    v_mfma_f32_16x16x32_bf16 v[176:179], v[48:51], v[96:99], v[176:179]
    ds_read_b128 v[88:91], v8 offset:12288
    v_mfma_f32_16x16x32_bf16 v[176:179], v[52:55], v[100:103], v[176:179]
    ds_read_b128 v[92:95], v8 offset:13312
    v_mfma_f32_16x16x32_bf16 v[180:183], v[56:59], v[96:99], v[180:183]
    v_mfma_f32_16x16x32_bf16 v[180:183], v[60:63], v[100:103], v[180:183]
    v_mfma_f32_16x16x32_bf16 v[184:187], v[64:67], v[96:99], v[184:187]
    v_mfma_f32_16x16x32_bf16 v[184:187], v[68:71], v[100:103], v[184:187]
    v_mfma_f32_16x16x32_bf16 v[188:191], v[72:75], v[96:99], v[188:191]
    s_waitcnt lgkmcnt(0)
    v_mfma_f32_16x16x32_bf16 v[188:191], v[76:79], v[100:103], v[188:191]
    s_barrier
    v_mfma_f32_16x16x32_bf16 v[192:195], v[48:51], v[104:107], v[192:195]
    ds_read_b128 v[112:115], v5 offset:0
    v_mfma_f32_16x16x32_bf16 v[192:195], v[52:55], v[108:111], v[192:195]
    ds_read_b128 v[116:119], v5 offset:64
    v_mfma_f32_16x16x32_bf16 v[196:199], v[56:59], v[104:107], v[196:199]
    ds_read_b128 v[120:123], v5 offset:256
    v_mfma_f32_16x16x32_bf16 v[196:199], v[60:63], v[108:111], v[196:199]
    ds_read_b128 v[124:127], v5 offset:320
    v_mfma_f32_16x16x32_bf16 v[200:203], v[64:67], v[104:107], v[200:203]
    ds_read_b128 v[16:19], v4 offset:0
    v_mfma_f32_16x16x32_bf16 v[200:203], v[68:71], v[108:111], v[200:203]
    ds_read_b128 v[20:23], v4 offset:256
    v_mfma_f32_16x16x32_bf16 v[204:207], v[72:75], v[104:107], v[204:207]
    ds_read_b128 v[24:27], v4 offset:512
    v_mfma_f32_16x16x32_bf16 v[204:207], v[76:79], v[108:111], v[204:207]
    ds_read_b128 v[28:31], v4 offset:768
    v_mfma_f32_16x16x32_bf16 v[208:211], v[48:51], v[80:83], v[208:211]
    ds_read_b128 v[32:35], v4 offset:1024
    v_mfma_f32_16x16x32_bf16 v[208:211], v[52:55], v[84:87], v[208:211]
    ds_read_b128 v[36:39], v4 offset:1280
    v_mfma_f32_16x16x32_bf16 v[212:215], v[56:59], v[80:83], v[212:215]
    ds_read_b128 v[40:43], v4 offset:1536
    v_mfma_f32_16x16x32_bf16 v[212:215], v[60:63], v[84:87], v[212:215]
    v_mfma_f32_16x16x32_bf16 v[216:219], v[64:67], v[80:83], v[216:219]
    v_mfma_f32_16x16x32_bf16 v[216:219], v[68:71], v[84:87], v[216:219]
    v_mfma_f32_16x16x32_bf16 v[220:223], v[72:75], v[80:83], v[220:223]
    v_mfma_f32_16x16x32_bf16 v[220:223], v[76:79], v[84:87], v[220:223]
    v_mfma_f32_16x16x32_bf16 v[224:227], v[48:51], v[88:91], v[224:227]
    v_mfma_f32_16x16x32_bf16 v[224:227], v[52:55], v[92:95], v[224:227]
    v_mfma_f32_16x16x32_bf16 v[228:231], v[56:59], v[88:91], v[228:231]
    v_mfma_f32_16x16x32_bf16 v[228:231], v[60:63], v[92:95], v[228:231]
    v_mfma_f32_16x16x32_bf16 v[232:235], v[64:67], v[88:91], v[232:235]
    v_mfma_f32_16x16x32_bf16 v[232:235], v[68:71], v[92:95], v[232:235]
    v_mfma_f32_16x16x32_bf16 v[236:239], v[72:75], v[88:91], v[236:239]
    v_mfma_f32_16x16x32_bf16 v[236:239], v[76:79], v[92:95], v[236:239]
    s_waitcnt lgkmcnt(0)
    .p2align 3
    v_pk_fma_f32 v[128:129], v[112:113], v[16:17], v[128:129] op_sel_hi:[1,0,1] neg_lo:[0,1,0] neg_hi:[0,1,0]
    v_pk_fma_f32 v[130:131], v[114:115], v[16:17], v[130:131] op_sel_hi:[1,0,1] neg_lo:[0,1,0] neg_hi:[0,1,0]
    v_pk_fma_f32 v[132:133], v[116:117], v[16:17], v[132:133] op_sel_hi:[1,0,1] neg_lo:[0,1,0] neg_hi:[0,1,0]
    v_pk_fma_f32 v[134:135], v[118:119], v[16:17], v[134:135] op_sel_hi:[1,0,1] neg_lo:[0,1,0] neg_hi:[0,1,0]
    v_pk_mul_f32 v[128:129], v[128:129], v[16:17] op_sel:[0,1] op_sel_hi:[1,1]
    v_pk_mul_f32 v[130:131], v[130:131], v[16:17] op_sel:[0,1] op_sel_hi:[1,1]
    v_pk_mul_f32 v[132:133], v[132:133], v[16:17] op_sel:[0,1] op_sel_hi:[1,1]
    v_pk_mul_f32 v[134:135], v[134:135], v[16:17] op_sel:[0,1] op_sel_hi:[1,1]
    v_exp_f32 v128, v128
    v_exp_f32 v129, v129
    v_exp_f32 v130, v130
    v_exp_f32 v131, v131
    v_exp_f32 v132, v132
    v_exp_f32 v133, v133
    v_exp_f32 v134, v134
    v_exp_f32 v135, v135
    v_pk_fma_f32 v[136:137], v[120:121], v[16:17], v[136:137] op_sel_hi:[1,0,1] neg_lo:[0,1,0] neg_hi:[0,1,0]
    v_pk_fma_f32 v[138:139], v[122:123], v[16:17], v[138:139] op_sel_hi:[1,0,1] neg_lo:[0,1,0] neg_hi:[0,1,0]
    v_pk_fma_f32 v[140:141], v[124:125], v[16:17], v[140:141] op_sel_hi:[1,0,1] neg_lo:[0,1,0] neg_hi:[0,1,0]
    v_pk_fma_f32 v[142:143], v[126:127], v[16:17], v[142:143] op_sel_hi:[1,0,1] neg_lo:[0,1,0] neg_hi:[0,1,0]
    v_pk_fma_f32 v[128:129], v[128:129], v[18:19], v[18:19] op_sel_hi:[1,0,0]
    v_pk_fma_f32 v[130:131], v[130:131], v[18:19], v[18:19] op_sel_hi:[1,0,0]
    v_pk_fma_f32 v[132:133], v[132:133], v[18:19], v[18:19] op_sel_hi:[1,0,0]
    v_pk_fma_f32 v[134:135], v[134:135], v[18:19], v[18:19] op_sel_hi:[1,0,0]
    v_rcp_f32 v128, v128
    v_rcp_f32 v129, v129
    v_rcp_f32 v130, v130
    v_rcp_f32 v131, v131
    v_rcp_f32 v132, v132
    v_rcp_f32 v133, v133
    v_rcp_f32 v134, v134
    v_rcp_f32 v135, v135
    v_pk_fma_f32 v[144:145], v[112:113], v[20:21], v[144:145] op_sel_hi:[1,0,1] neg_lo:[0,1,0] neg_hi:[0,1,0]
    v_pk_fma_f32 v[146:147], v[114:115], v[20:21], v[146:147] op_sel_hi:[1,0,1] neg_lo:[0,1,0] neg_hi:[0,1,0]
    v_pk_fma_f32 v[148:149], v[116:117], v[20:21], v[148:149] op_sel_hi:[1,0,1] neg_lo:[0,1,0] neg_hi:[0,1,0]
    v_pk_fma_f32 v[150:151], v[118:119], v[20:21], v[150:151] op_sel_hi:[1,0,1] neg_lo:[0,1,0] neg_hi:[0,1,0]
    v_pk_mul_f32 v[128:129], v[128:129], v[136:137]
    v_pk_mul_f32 v[130:131], v[130:131], v[138:139]
    v_pk_mul_f32 v[132:133], v[132:133], v[140:141]
    v_pk_mul_f32 v[134:135], v[134:135], v[142:143]
    v_cvt_pk_bf16_f32 v48, v128, v129
    v_cvt_pk_bf16_f32 v50, v132, v133
    v_cvt_pk_bf16_f32 v49, v130, v131
    v_cvt_pk_bf16_f32 v51, v134, v135
    v_pk_mul_f32 v[144:145], v[144:145], v[20:21] op_sel:[0,1] op_sel_hi:[1,1]
    v_pk_mul_f32 v[146:147], v[146:147], v[20:21] op_sel:[0,1] op_sel_hi:[1,1]
    v_pk_mul_f32 v[148:149], v[148:149], v[20:21] op_sel:[0,1] op_sel_hi:[1,1]
    v_pk_mul_f32 v[150:151], v[150:151], v[20:21] op_sel:[0,1] op_sel_hi:[1,1]
    v_permlane16_swap_b32 v48, v50
    v_permlane16_swap_b32 v49, v51
    buffer_store_dwordx4 v[48:51], v6, s[4:7], s50 offen sc1
    s_add_u32 s50, s50, 55296
    v_exp_f32 v144, v144
    v_exp_f32 v145, v145
    v_exp_f32 v146, v146
    v_exp_f32 v147, v147
    v_exp_f32 v148, v148
    v_exp_f32 v149, v149
    v_exp_f32 v150, v150
    v_exp_f32 v151, v151
    v_pk_fma_f32 v[152:153], v[120:121], v[20:21], v[152:153] op_sel_hi:[1,0,1] neg_lo:[0,1,0] neg_hi:[0,1,0]
    v_pk_fma_f32 v[154:155], v[122:123], v[20:21], v[154:155] op_sel_hi:[1,0,1] neg_lo:[0,1,0] neg_hi:[0,1,0]
    v_pk_fma_f32 v[156:157], v[124:125], v[20:21], v[156:157] op_sel_hi:[1,0,1] neg_lo:[0,1,0] neg_hi:[0,1,0]
    v_pk_fma_f32 v[158:159], v[126:127], v[20:21], v[158:159] op_sel_hi:[1,0,1] neg_lo:[0,1,0] neg_hi:[0,1,0]
    v_pk_fma_f32 v[144:145], v[144:145], v[22:23], v[22:23] op_sel_hi:[1,0,0]
    v_pk_fma_f32 v[146:147], v[146:147], v[22:23], v[22:23] op_sel_hi:[1,0,0]
    v_pk_fma_f32 v[148:149], v[148:149], v[22:23], v[22:23] op_sel_hi:[1,0,0]
    v_pk_fma_f32 v[150:151], v[150:151], v[22:23], v[22:23] op_sel_hi:[1,0,0]
    v_rcp_f32 v144, v144
    v_rcp_f32 v145, v145
    v_rcp_f32 v146, v146
    v_rcp_f32 v147, v147
    v_rcp_f32 v148, v148
    v_rcp_f32 v149, v149
    v_rcp_f32 v150, v150
    v_rcp_f32 v151, v151
    v_pk_fma_f32 v[160:161], v[112:113], v[24:25], v[160:161] op_sel_hi:[1,0,1] neg_lo:[0,1,0] neg_hi:[0,1,0]
    v_pk_fma_f32 v[162:163], v[114:115], v[24:25], v[162:163] op_sel_hi:[1,0,1] neg_lo:[0,1,0] neg_hi:[0,1,0]
    v_pk_fma_f32 v[164:165], v[116:117], v[24:25], v[164:165] op_sel_hi:[1,0,1] neg_lo:[0,1,0] neg_hi:[0,1,0]
    v_pk_fma_f32 v[166:167], v[118:119], v[24:25], v[166:167] op_sel_hi:[1,0,1] neg_lo:[0,1,0] neg_hi:[0,1,0]
    v_pk_mul_f32 v[144:145], v[144:145], v[152:153]
    v_pk_mul_f32 v[146:147], v[146:147], v[154:155]
    v_pk_mul_f32 v[148:149], v[148:149], v[156:157]
    v_pk_mul_f32 v[150:151], v[150:151], v[158:159]
    v_cvt_pk_bf16_f32 v52, v144, v145
    v_cvt_pk_bf16_f32 v54, v148, v149
    v_cvt_pk_bf16_f32 v53, v146, v147
    v_cvt_pk_bf16_f32 v55, v150, v151
    v_pk_mul_f32 v[160:161], v[160:161], v[24:25] op_sel:[0,1] op_sel_hi:[1,1]
    v_pk_mul_f32 v[162:163], v[162:163], v[24:25] op_sel:[0,1] op_sel_hi:[1,1]
    v_pk_mul_f32 v[164:165], v[164:165], v[24:25] op_sel:[0,1] op_sel_hi:[1,1]
    v_pk_mul_f32 v[166:167], v[166:167], v[24:25] op_sel:[0,1] op_sel_hi:[1,1]
    v_permlane16_swap_b32 v52, v54
    v_permlane16_swap_b32 v53, v55
    buffer_store_dwordx4 v[52:55], v6, s[4:7], s50 offen sc1
    s_add_u32 s50, s50, 55296
    v_exp_f32 v160, v160
    v_exp_f32 v161, v161
    v_exp_f32 v162, v162
    v_exp_f32 v163, v163
    v_exp_f32 v164, v164
    v_exp_f32 v165, v165
    v_exp_f32 v166, v166
    v_exp_f32 v167, v167
    v_pk_fma_f32 v[168:169], v[120:121], v[24:25], v[168:169] op_sel_hi:[1,0,1] neg_lo:[0,1,0] neg_hi:[0,1,0]
    v_pk_fma_f32 v[170:171], v[122:123], v[24:25], v[170:171] op_sel_hi:[1,0,1] neg_lo:[0,1,0] neg_hi:[0,1,0]
    v_pk_fma_f32 v[172:173], v[124:125], v[24:25], v[172:173] op_sel_hi:[1,0,1] neg_lo:[0,1,0] neg_hi:[0,1,0]
    v_pk_fma_f32 v[174:175], v[126:127], v[24:25], v[174:175] op_sel_hi:[1,0,1] neg_lo:[0,1,0] neg_hi:[0,1,0]
    v_pk_fma_f32 v[160:161], v[160:161], v[26:27], v[26:27] op_sel_hi:[1,0,0]
    v_pk_fma_f32 v[162:163], v[162:163], v[26:27], v[26:27] op_sel_hi:[1,0,0]
    v_pk_fma_f32 v[164:165], v[164:165], v[26:27], v[26:27] op_sel_hi:[1,0,0]
    v_pk_fma_f32 v[166:167], v[166:167], v[26:27], v[26:27] op_sel_hi:[1,0,0]
    v_rcp_f32 v160, v160
    v_rcp_f32 v161, v161
    v_rcp_f32 v162, v162
    v_rcp_f32 v163, v163
    v_rcp_f32 v164, v164
    v_rcp_f32 v165, v165
    v_rcp_f32 v166, v166
    v_rcp_f32 v167, v167
    v_pk_fma_f32 v[176:177], v[112:113], v[28:29], v[176:177] op_sel_hi:[1,0,1] neg_lo:[0,1,0] neg_hi:[0,1,0]
    v_pk_fma_f32 v[178:179], v[114:115], v[28:29], v[178:179] op_sel_hi:[1,0,1] neg_lo:[0,1,0] neg_hi:[0,1,0]
    v_pk_fma_f32 v[180:181], v[116:117], v[28:29], v[180:181] op_sel_hi:[1,0,1] neg_lo:[0,1,0] neg_hi:[0,1,0]
    v_pk_fma_f32 v[182:183], v[118:119], v[28:29], v[182:183] op_sel_hi:[1,0,1] neg_lo:[0,1,0] neg_hi:[0,1,0]
    v_pk_mul_f32 v[160:161], v[160:161], v[168:169]
    v_pk_mul_f32 v[162:163], v[162:163], v[170:171]
    v_pk_mul_f32 v[164:165], v[164:165], v[172:173]
    v_pk_mul_f32 v[166:167], v[166:167], v[174:175]
    v_cvt_pk_bf16_f32 v56, v160, v161
    v_cvt_pk_bf16_f32 v58, v164, v165
    v_cvt_pk_bf16_f32 v57, v162, v163
    v_cvt_pk_bf16_f32 v59, v166, v167
    v_pk_mul_f32 v[176:177], v[176:177], v[28:29] op_sel:[0,1] op_sel_hi:[1,1]
    v_pk_mul_f32 v[178:179], v[178:179], v[28:29] op_sel:[0,1] op_sel_hi:[1,1]
    v_pk_mul_f32 v[180:181], v[180:181], v[28:29] op_sel:[0,1] op_sel_hi:[1,1]
    v_pk_mul_f32 v[182:183], v[182:183], v[28:29] op_sel:[0,1] op_sel_hi:[1,1]
    v_permlane16_swap_b32 v56, v58
    v_permlane16_swap_b32 v57, v59
    buffer_store_dwordx4 v[56:59], v6, s[4:7], s50 offen sc1
    s_add_u32 s50, s50, 55296
    v_exp_f32 v176, v176
    v_exp_f32 v177, v177
    v_exp_f32 v178, v178
    v_exp_f32 v179, v179
    v_exp_f32 v180, v180
    v_exp_f32 v181, v181
    v_exp_f32 v182, v182
    v_exp_f32 v183, v183
    v_pk_fma_f32 v[184:185], v[120:121], v[28:29], v[184:185] op_sel_hi:[1,0,1] neg_lo:[0,1,0] neg_hi:[0,1,0]
    v_pk_fma_f32 v[186:187], v[122:123], v[28:29], v[186:187] op_sel_hi:[1,0,1] neg_lo:[0,1,0] neg_hi:[0,1,0]
    v_pk_fma_f32 v[188:189], v[124:125], v[28:29], v[188:189] op_sel_hi:[1,0,1] neg_lo:[0,1,0] neg_hi:[0,1,0]
    v_pk_fma_f32 v[190:191], v[126:127], v[28:29], v[190:191] op_sel_hi:[1,0,1] neg_lo:[0,1,0] neg_hi:[0,1,0]
    v_pk_fma_f32 v[176:177], v[176:177], v[30:31], v[30:31] op_sel_hi:[1,0,0]
    v_pk_fma_f32 v[178:179], v[178:179], v[30:31], v[30:31] op_sel_hi:[1,0,0]
    v_pk_fma_f32 v[180:181], v[180:181], v[30:31], v[30:31] op_sel_hi:[1,0,0]
    v_pk_fma_f32 v[182:183], v[182:183], v[30:31], v[30:31] op_sel_hi:[1,0,0]
    v_rcp_f32 v176, v176
    v_rcp_f32 v177, v177
    v_rcp_f32 v178, v178
    v_rcp_f32 v179, v179
    v_rcp_f32 v180, v180
    v_rcp_f32 v181, v181
    v_rcp_f32 v182, v182
    v_rcp_f32 v183, v183
    v_pk_fma_f32 v[192:193], v[112:113], v[32:33], v[192:193] op_sel_hi:[1,0,1] neg_lo:[0,1,0] neg_hi:[0,1,0]
    v_pk_fma_f32 v[194:195], v[114:115], v[32:33], v[194:195] op_sel_hi:[1,0,1] neg_lo:[0,1,0] neg_hi:[0,1,0]
    v_pk_fma_f32 v[196:197], v[116:117], v[32:33], v[196:197] op_sel_hi:[1,0,1] neg_lo:[0,1,0] neg_hi:[0,1,0]
    v_pk_fma_f32 v[198:199], v[118:119], v[32:33], v[198:199] op_sel_hi:[1,0,1] neg_lo:[0,1,0] neg_hi:[0,1,0]
    v_pk_mul_f32 v[176:177], v[176:177], v[184:185]
    v_pk_mul_f32 v[178:179], v[178:179], v[186:187]
    v_pk_mul_f32 v[180:181], v[180:181], v[188:189]
    v_pk_mul_f32 v[182:183], v[182:183], v[190:191]
    v_cvt_pk_bf16_f32 v60, v176, v177
    v_cvt_pk_bf16_f32 v62, v180, v181
    v_cvt_pk_bf16_f32 v61, v178, v179
    v_cvt_pk_bf16_f32 v63, v182, v183
    v_pk_mul_f32 v[192:193], v[192:193], v[32:33] op_sel:[0,1] op_sel_hi:[1,1]
    v_pk_mul_f32 v[194:195], v[194:195], v[32:33] op_sel:[0,1] op_sel_hi:[1,1]
    v_pk_mul_f32 v[196:197], v[196:197], v[32:33] op_sel:[0,1] op_sel_hi:[1,1]
    v_pk_mul_f32 v[198:199], v[198:199], v[32:33] op_sel:[0,1] op_sel_hi:[1,1]
    v_permlane16_swap_b32 v60, v62
    v_permlane16_swap_b32 v61, v63
    buffer_store_dwordx4 v[60:63], v6, s[4:7], s50 offen sc1
    s_add_u32 s50, s50, 55296
    v_exp_f32 v192, v192
    v_exp_f32 v193, v193
    v_exp_f32 v194, v194
    v_exp_f32 v195, v195
    v_exp_f32 v196, v196
    v_exp_f32 v197, v197
    v_exp_f32 v198, v198
    v_exp_f32 v199, v199
    v_pk_fma_f32 v[200:201], v[120:121], v[32:33], v[200:201] op_sel_hi:[1,0,1] neg_lo:[0,1,0] neg_hi:[0,1,0]
    v_pk_fma_f32 v[202:203], v[122:123], v[32:33], v[202:203] op_sel_hi:[1,0,1] neg_lo:[0,1,0] neg_hi:[0,1,0]
    v_pk_fma_f32 v[204:205], v[124:125], v[32:33], v[204:205] op_sel_hi:[1,0,1] neg_lo:[0,1,0] neg_hi:[0,1,0]
    v_pk_fma_f32 v[206:207], v[126:127], v[32:33], v[206:207] op_sel_hi:[1,0,1] neg_lo:[0,1,0] neg_hi:[0,1,0]
    v_pk_fma_f32 v[192:193], v[192:193], v[34:35], v[34:35] op_sel_hi:[1,0,0]
    v_pk_fma_f32 v[194:195], v[194:195], v[34:35], v[34:35] op_sel_hi:[1,0,0]
    v_pk_fma_f32 v[196:197], v[196:197], v[34:35], v[34:35] op_sel_hi:[1,0,0]
    v_pk_fma_f32 v[198:199], v[198:199], v[34:35], v[34:35] op_sel_hi:[1,0,0]
    v_rcp_f32 v192, v192
    v_rcp_f32 v193, v193
    v_rcp_f32 v194, v194
    v_rcp_f32 v195, v195
    v_rcp_f32 v196, v196
    v_rcp_f32 v197, v197
    v_rcp_f32 v198, v198
    v_rcp_f32 v199, v199
    v_pk_fma_f32 v[208:209], v[112:113], v[36:37], v[208:209] op_sel_hi:[1,0,1] neg_lo:[0,1,0] neg_hi:[0,1,0]
    v_pk_fma_f32 v[210:211], v[114:115], v[36:37], v[210:211] op_sel_hi:[1,0,1] neg_lo:[0,1,0] neg_hi:[0,1,0]
    v_pk_fma_f32 v[212:213], v[116:117], v[36:37], v[212:213] op_sel_hi:[1,0,1] neg_lo:[0,1,0] neg_hi:[0,1,0]
    v_pk_fma_f32 v[214:215], v[118:119], v[36:37], v[214:215] op_sel_hi:[1,0,1] neg_lo:[0,1,0] neg_hi:[0,1,0]
    v_pk_mul_f32 v[192:193], v[192:193], v[200:201]
    v_pk_mul_f32 v[194:195], v[194:195], v[202:203]
    v_pk_mul_f32 v[196:197], v[196:197], v[204:205]
    v_pk_mul_f32 v[198:199], v[198:199], v[206:207]
    v_cvt_pk_bf16_f32 v48, v192, v193
    v_cvt_pk_bf16_f32 v50, v196, v197
    v_cvt_pk_bf16_f32 v49, v194, v195
    v_cvt_pk_bf16_f32 v51, v198, v199
    v_pk_mul_f32 v[208:209], v[208:209], v[36:37] op_sel:[0,1] op_sel_hi:[1,1]
    v_pk_mul_f32 v[210:211], v[210:211], v[36:37] op_sel:[0,1] op_sel_hi:[1,1]
    v_pk_mul_f32 v[212:213], v[212:213], v[36:37] op_sel:[0,1] op_sel_hi:[1,1]
    v_pk_mul_f32 v[214:215], v[214:215], v[36:37] op_sel:[0,1] op_sel_hi:[1,1]
    v_permlane16_swap_b32 v48, v50
    v_permlane16_swap_b32 v49, v51
    buffer_store_dwordx4 v[48:51], v6, s[4:7], s50 offen sc1
    s_add_u32 s50, s50, 55296
    v_exp_f32 v208, v208
    v_exp_f32 v209, v209
    v_exp_f32 v210, v210
    v_exp_f32 v211, v211
    v_exp_f32 v212, v212
    v_exp_f32 v213, v213
    v_exp_f32 v214, v214
    v_exp_f32 v215, v215
    v_pk_fma_f32 v[216:217], v[120:121], v[36:37], v[216:217] op_sel_hi:[1,0,1] neg_lo:[0,1,0] neg_hi:[0,1,0]
    v_pk_fma_f32 v[218:219], v[122:123], v[36:37], v[218:219] op_sel_hi:[1,0,1] neg_lo:[0,1,0] neg_hi:[0,1,0]
    v_pk_fma_f32 v[220:221], v[124:125], v[36:37], v[220:221] op_sel_hi:[1,0,1] neg_lo:[0,1,0] neg_hi:[0,1,0]
    v_pk_fma_f32 v[222:223], v[126:127], v[36:37], v[222:223] op_sel_hi:[1,0,1] neg_lo:[0,1,0] neg_hi:[0,1,0]
    v_pk_fma_f32 v[208:209], v[208:209], v[38:39], v[38:39] op_sel_hi:[1,0,0]
    v_pk_fma_f32 v[210:211], v[210:211], v[38:39], v[38:39] op_sel_hi:[1,0,0]
    v_pk_fma_f32 v[212:213], v[212:213], v[38:39], v[38:39] op_sel_hi:[1,0,0]
    v_pk_fma_f32 v[214:215], v[214:215], v[38:39], v[38:39] op_sel_hi:[1,0,0]
    v_rcp_f32 v208, v208
    v_rcp_f32 v209, v209
    v_rcp_f32 v210, v210
    v_rcp_f32 v211, v211
    v_rcp_f32 v212, v212
    v_rcp_f32 v213, v213
    v_rcp_f32 v214, v214
    v_rcp_f32 v215, v215
    v_pk_fma_f32 v[224:225], v[112:113], v[40:41], v[224:225] op_sel_hi:[1,0,1] neg_lo:[0,1,0] neg_hi:[0,1,0]
    v_pk_fma_f32 v[226:227], v[114:115], v[40:41], v[226:227] op_sel_hi:[1,0,1] neg_lo:[0,1,0] neg_hi:[0,1,0]
    v_pk_fma_f32 v[228:229], v[116:117], v[40:41], v[228:229] op_sel_hi:[1,0,1] neg_lo:[0,1,0] neg_hi:[0,1,0]
    v_pk_fma_f32 v[230:231], v[118:119], v[40:41], v[230:231] op_sel_hi:[1,0,1] neg_lo:[0,1,0] neg_hi:[0,1,0]
    v_pk_mul_f32 v[208:209], v[208:209], v[216:217]
    v_pk_mul_f32 v[210:211], v[210:211], v[218:219]
    v_pk_mul_f32 v[212:213], v[212:213], v[220:221]
    v_pk_mul_f32 v[214:215], v[214:215], v[222:223]
    v_cvt_pk_bf16_f32 v52, v208, v209
    v_cvt_pk_bf16_f32 v54, v212, v213
    v_cvt_pk_bf16_f32 v53, v210, v211
    v_cvt_pk_bf16_f32 v55, v214, v215
    v_pk_mul_f32 v[224:225], v[224:225], v[40:41] op_sel:[0,1] op_sel_hi:[1,1]
    v_pk_mul_f32 v[226:227], v[226:227], v[40:41] op_sel:[0,1] op_sel_hi:[1,1]
    v_pk_mul_f32 v[228:229], v[228:229], v[40:41] op_sel:[0,1] op_sel_hi:[1,1]
    v_pk_mul_f32 v[230:231], v[230:231], v[40:41] op_sel:[0,1] op_sel_hi:[1,1]
    v_permlane16_swap_b32 v52, v54
    v_permlane16_swap_b32 v53, v55
    buffer_store_dwordx4 v[52:55], v6, s[4:7], s50 offen sc1
    s_add_u32 s50, s50, 55296
    v_exp_f32 v224, v224
    v_exp_f32 v225, v225
    v_exp_f32 v226, v226
    v_exp_f32 v227, v227
    v_exp_f32 v228, v228
    v_exp_f32 v229, v229
    v_exp_f32 v230, v230
    v_exp_f32 v231, v231
    v_pk_fma_f32 v[232:233], v[120:121], v[40:41], v[232:233] op_sel_hi:[1,0,1] neg_lo:[0,1,0] neg_hi:[0,1,0]
    v_pk_fma_f32 v[234:235], v[122:123], v[40:41], v[234:235] op_sel_hi:[1,0,1] neg_lo:[0,1,0] neg_hi:[0,1,0]
    v_pk_fma_f32 v[236:237], v[124:125], v[40:41], v[236:237] op_sel_hi:[1,0,1] neg_lo:[0,1,0] neg_hi:[0,1,0]
    v_pk_fma_f32 v[238:239], v[126:127], v[40:41], v[238:239] op_sel_hi:[1,0,1] neg_lo:[0,1,0] neg_hi:[0,1,0]
    v_pk_fma_f32 v[224:225], v[224:225], v[42:43], v[42:43] op_sel_hi:[1,0,0]
    v_pk_fma_f32 v[226:227], v[226:227], v[42:43], v[42:43] op_sel_hi:[1,0,0]
    v_pk_fma_f32 v[228:229], v[228:229], v[42:43], v[42:43] op_sel_hi:[1,0,0]
    v_pk_fma_f32 v[230:231], v[230:231], v[42:43], v[42:43] op_sel_hi:[1,0,0]
    v_rcp_f32 v224, v224
    v_rcp_f32 v225, v225
    v_rcp_f32 v226, v226
    v_rcp_f32 v227, v227
    v_rcp_f32 v228, v228
    v_rcp_f32 v229, v229
    v_rcp_f32 v230, v230
    v_rcp_f32 v231, v231
    v_pk_mul_f32 v[224:225], v[224:225], v[232:233]
    v_pk_mul_f32 v[226:227], v[226:227], v[234:235]
    v_pk_mul_f32 v[228:229], v[228:229], v[236:237]
    v_pk_mul_f32 v[230:231], v[230:231], v[238:239]
    v_cvt_pk_bf16_f32 v56, v224, v225
    v_cvt_pk_bf16_f32 v58, v228, v229
    v_cvt_pk_bf16_f32 v57, v226, v227
    v_cvt_pk_bf16_f32 v59, v230, v231
    v_permlane16_swap_b32 v56, v58
    s_nop 0
    v_permlane16_swap_b32 v57, v59
    buffer_store_dwordx4 v[56:59], v6, s[4:7], s50 offen sc1
    s_add_u32 s50, s50, 55296
L_p5_c_pre:
    s_bfe_u32 s40, s2, 0x20001
    s_add_u32 s43, s40, 108
    s_mul_i32 s40, s40, 27
    s_lshr_b32 s41, s2, 3
    s_add_u32 s42, s40, s41
    s_cmp_ge_u32 s2, 216
    s_cselect_b32 s42, s43, s42
    s_mul_i32 s40, s42, 13108
    s_lshr_b32 s40, s40, 16
    s_mul_i32 s41, s40, 5
    s_sub_u32 s43, s42, s41
    s_and_b32 s41, s2, 1
    s_mul_i32 s41, s41, 5
    s_add_u32 s41, s41, s43
    s_lshl_b32 s51, s49, 12
    s_add_u32 s51, s51, 147456
    v_add_u32 v10, s51, v14
    v_xor_b32 v11, 32, v10
    v_xor_b32 v12, 64, v10
    v_xor_b32 v13, 96, v10
    s_mul_i32 s50, s3, 6144
    s_add_u32 s50, s50, 90112
    v_lshl_add_u32 v8, v1, 4, s50
    s_xor_b32 s50, s3, 2
    s_mul_i32 s50, s50, 6144
    s_add_u32 s50, s50, 90112
    v_lshl_add_u32 v15, v1, 4, s50
    v_lshrrev_b32 v7, 1, v3
    v_lshlrev_b32 v4, 8, v7
    v_lshl_add_u32 v4, v2, 4, v4
    v_and_b32 v5, 1, v3
    v_lshl_add_u32 v4, v5, 3, v4
    s_lshl_b32 s55, s40, 1
    s_add_u32 s55, s55, s48
    s_mul_i32 s55, s55, 3
    s_mul_i32 s50, s55, 20480
    s_lshl_b32 s52, s41, 1
    s_add_u32 s52, s52, s49
    s_lshl_b32 s53, s52, 10
    s_add_u32 s51, s50, s53
    s_add_u32 s51, s51, 12582912
    v_mul_u32_u24 v9, 1280, v2
    v_lshl_add_u32 v9, v5, 5, v9
    v_lshl_add_u32 v9, v7, 4, v9
    s_lshl_b32 s54, s52, 6
    s_add_u32 s53, s50, s54
    v_add_u32 v9, s53, v9
    s_add_u32 s56, s55, 0
    s_cmp_ge_u32 s56, 128
    s_mov_b32 s57, 0
    s_cselect_b32 s56, 1073741816, s57
    v_lshl_add_u32 v5, v1, 4, s56
    s_add_u32 s56, s55, 1
    s_cmp_ge_u32 s56, 128
    s_mov_b32 s57, 55296
    s_cselect_b32 s56, 1073741816, s57
    v_lshl_add_u32 v6, v1, 4, s56
    s_add_u32 s56, s55, 2
    s_cmp_ge_u32 s56, 128
    s_mov_b32 s57, 110592
    s_cselect_b32 s56, 1073741816, s57
    v_lshl_add_u32 v7, v1, 4, s56
    s_mul_i32 s56, s55, 55296
    s_lshl_b32 s57, s49, 10
    s_add_u32 s56, s56, s57
    s_add_u32 s56, s56, 16777216
    s_mul_i32 s57, s40, 10
    s_add_u32 s57, s57, s41
    s_lshl_b32 s57, s57, 7
    s_add_u32 s57, s57, 16
    s_nop 0
    s_mul_i32 s58, s40, 28089
    s_add_u32 s59, s58, 18726
    s_lshr_b32 s58, s58, 16
    s_lshr_b32 s59, s59, 16
    s_cmp_eq_u32 s58, s59
    s_cselect_b32 s58, 27, 54
    s_waitcnt vmcnt(0)
    s_barrier
    s_cmp_eq_u64 s[62:63], 0
    s_cbranch_scc1 Lfin_12
    v_mov_b32 v246, 1
    s_mov_b64 exec, s[62:63]
    buffer_atomic_add v246, v247, s[4:7], 0 offen offset:16 sc1
    s_mov_b64 exec, -1
Lfin_12:
    s_cmp_ge_i32 s1, 0
    s_cbranch_scc1 L_end
    buffer_load_dwordx2 v[236:237], v4, s[4:7], s51 offen offset:0 sc1
    buffer_load_dwordx2 v[238:239], v4, s[4:7], s51 offen offset:512 sc1
    s_add_u32 s51, s51, 20480
    buffer_load_dwordx2 v[240:241], v4, s[4:7], s51 offen offset:0 sc1
    buffer_load_dwordx2 v[242:243], v4, s[4:7], s51 offen offset:512 sc1
    s_add_u32 s51, s51, 20480
    buffer_load_dwordx2 v[244:245], v4, s[4:7], s51 offen offset:0 sc1
    buffer_load_dwordx2 v[246:247], v4, s[4:7], s51 offen offset:512 sc1
    ds_read_b64_tr_b16 v[64:65], v10 offset:0
    ds_read_b64_tr_b16 v[66:67], v10 offset:512
    ds_read_b64_tr_b16 v[68:69], v11 offset:0
    ds_read_b64_tr_b16 v[70:71], v11 offset:512
    ds_read_b64_tr_b16 v[72:73], v12 offset:0
    ds_read_b64_tr_b16 v[74:75], v12 offset:512
    ds_read_b64_tr_b16 v[76:77], v13 offset:0
    ds_read_b64_tr_b16 v[78:79], v13 offset:512
    ds_read_b64_tr_b16 v[80:81], v10 offset:8192
    ds_read_b64_tr_b16 v[82:83], v10 offset:8704
    ds_read_b64_tr_b16 v[84:85], v11 offset:8192
    ds_read_b64_tr_b16 v[86:87], v11 offset:8704
    ds_read_b64_tr_b16 v[88:89], v12 offset:8192
    ds_read_b64_tr_b16 v[90:91], v12 offset:8704
    ds_read_b64_tr_b16 v[92:93], v13 offset:8192
    ds_read_b64_tr_b16 v[94:95], v13 offset:8704
    s_waitcnt lgkmcnt(8)
    v_add_u32 v10, 4294868992, v10
    v_add_u32 v11, 4294868992, v11
    v_add_u32 v12, 4294868992, v12
    v_add_u32 v13, 4294868992, v13
    ds_read_b64_tr_b16 v[96:97], v10 offset:0
    ds_read_b64_tr_b16 v[98:99], v10 offset:512
    ds_read_b64_tr_b16 v[100:101], v11 offset:0
    ds_read_b64_tr_b16 v[102:103], v11 offset:512
    ds_read_b64_tr_b16 v[104:105], v12 offset:0
    ds_read_b64_tr_b16 v[106:107], v12 offset:512
    ds_read_b64_tr_b16 v[108:109], v13 offset:0
    ds_read_b64_tr_b16 v[110:111], v13 offset:512
    s_waitcnt lgkmcnt(8)
    ds_read_b64_tr_b16 v[112:113], v10 offset:8192
    ds_read_b64_tr_b16 v[114:115], v10 offset:8704
    ds_read_b64_tr_b16 v[116:117], v11 offset:8192
    ds_read_b64_tr_b16 v[118:119], v11 offset:8704
    ds_read_b64_tr_b16 v[120:121], v12 offset:8192
    ds_read_b64_tr_b16 v[122:123], v12 offset:8704
    ds_read_b64_tr_b16 v[124:125], v13 offset:8192
    ds_read_b64_tr_b16 v[126:127], v13 offset:8704
    s_waitcnt lgkmcnt(8)
    ds_read_b64_tr_b16 v[128:129], v10 offset:16384
    ds_read_b64_tr_b16 v[130:131], v10 offset:16896
    ds_read_b64_tr_b16 v[132:133], v11 offset:16384
    ds_read_b64_tr_b16 v[134:135], v11 offset:16896
    ds_read_b64_tr_b16 v[136:137], v12 offset:16384
    ds_read_b64_tr_b16 v[138:139], v12 offset:16896
    ds_read_b64_tr_b16 v[140:141], v13 offset:16384
    ds_read_b64_tr_b16 v[142:143], v13 offset:16896
    s_waitcnt lgkmcnt(8)
    ds_read_b64_tr_b16 v[144:145], v10 offset:24576
    ds_read_b64_tr_b16 v[146:147], v10 offset:25088
    ds_read_b64_tr_b16 v[148:149], v11 offset:24576
    ds_read_b64_tr_b16 v[150:151], v11 offset:25088
    ds_read_b64_tr_b16 v[152:153], v12 offset:24576
    ds_read_b64_tr_b16 v[154:155], v12 offset:25088
    ds_read_b64_tr_b16 v[156:157], v13 offset:24576
    ds_read_b64_tr_b16 v[158:159], v13 offset:25088
    s_waitcnt lgkmcnt(8)
    ds_read_b64_tr_b16 v[160:161], v10 offset:32768
    ds_read_b64_tr_b16 v[162:163], v10 offset:33280
    ds_read_b64_tr_b16 v[164:165], v11 offset:32768
    ds_read_b64_tr_b16 v[166:167], v11 offset:33280
    ds_read_b64_tr_b16 v[168:169], v12 offset:32768
    ds_read_b64_tr_b16 v[170:171], v12 offset:33280
    ds_read_b64_tr_b16 v[172:173], v13 offset:32768
    ds_read_b64_tr_b16 v[174:175], v13 offset:33280
    s_waitcnt lgkmcnt(8)
    s_waitcnt lgkmcnt(0)
    s_barrier
    s_cmp_lg_u32 s3, 1
    s_cbranch_scc1 Lp1_13
    v_mov_b32 v4, 0
    s_mov_b64 exec, 1
    v_mov_b32 v248, 0
    buffer_atomic_add v248, v4, s[4:7], s57 offen sc0 sc1
    s_sleep 3
    v_mov_b32 v249, 0
    buffer_atomic_add v249, v4, s[4:7], s57 offen sc0 sc1
    s_sleep 3
Lpoll_14:
    v_mov_b32 v250, 0
    buffer_atomic_add v250, v4, s[4:7], s57 offen sc0 sc1
    s_waitcnt vmcnt(2)
    v_cmp_ne_u32 vcc, s58, v248
    s_cbranch_vccz Lpoll_14d
    v_mov_b32 v248, 0
    buffer_atomic_add v248, v4, s[4:7], s57 offen sc0 sc1
    s_waitcnt vmcnt(2)
    v_cmp_ne_u32 vcc, s58, v249
    s_cbranch_vccz Lpoll_14d
    v_mov_b32 v249, 0
    buffer_atomic_add v249, v4, s[4:7], s57 offen sc0 sc1
    s_waitcnt vmcnt(2)
    v_cmp_ne_u32 vcc, s58, v250
    s_cbranch_vccz Lpoll_14d
    s_sub_u32 s96, s96, 1
    s_cbranch_scc0 Lpoll_14
    s_mov_b32 s96, 0
Lpoll_14d:
    s_mov_b64 exec, -1
Lp1_13:
    s_barrier
    buffer_load_dwordx4 v[176:179], v5, s[4:7], s56 offen offset:0 sc1
    buffer_load_dwordx4 v[180:183], v6, s[4:7], s56 offen offset:0 sc1
    buffer_load_dwordx4 v[184:187], v7, s[4:7], s56 offen offset:0 sc1
    buffer_load_dwordx4 v[188:191], v5, s[4:7], s56 offen offset:2048 sc1
    buffer_load_dwordx4 v[192:195], v6, s[4:7], s56 offen offset:2048 sc1
    buffer_load_dwordx4 v[196:199], v7, s[4:7], s56 offen offset:2048 sc1
    s_add_u32 s56, s56, 4096
    buffer_load_dwordx4 v[200:203], v5, s[4:7], s56 offen offset:0 sc1
    buffer_load_dwordx4 v[204:207], v6, s[4:7], s56 offen offset:0 sc1
    buffer_load_dwordx4 v[208:211], v7, s[4:7], s56 offen offset:0 sc1
    buffer_load_dwordx4 v[212:215], v5, s[4:7], s56 offen offset:2048 sc1
    buffer_load_dwordx4 v[216:219], v6, s[4:7], s56 offen offset:2048 sc1
    buffer_load_dwordx4 v[220:223], v7, s[4:7], s56 offen offset:2048 sc1
    s_add_u32 s56, s56, 4096
    buffer_load_dwordx4 v[224:227], v5, s[4:7], s56 offen offset:0 sc1
    buffer_load_dwordx4 v[228:231], v6, s[4:7], s56 offen offset:0 sc1
    buffer_load_dwordx4 v[232:235], v7, s[4:7], s56 offen offset:0 sc1
    s_waitcnt vmcnt(12)
    v_mfma_f32_16x16x32_bf16 v[16:19], v[64:67], v[176:179], 0
    v_mfma_f32_16x16x32_bf16 v[20:23], v[68:71], v[176:179], 0
    v_mfma_f32_16x16x32_bf16 v[24:27], v[72:75], v[176:179], 0
    v_mfma_f32_16x16x32_bf16 v[28:31], v[76:79], v[176:179], 0
    v_mfma_f32_16x16x32_bf16 v[32:35], v[64:67], v[180:183], 0
    v_mfma_f32_16x16x32_bf16 v[36:39], v[68:71], v[180:183], 0
    v_mfma_f32_16x16x32_bf16 v[40:43], v[72:75], v[180:183], 0
    v_mfma_f32_16x16x32_bf16 v[44:47], v[76:79], v[180:183], 0
    v_mfma_f32_16x16x32_bf16 v[48:51], v[64:67], v[184:187], 0
    v_mfma_f32_16x16x32_bf16 v[52:55], v[68:71], v[184:187], 0
    v_mfma_f32_16x16x32_bf16 v[56:59], v[72:75], v[184:187], 0
    v_mfma_f32_16x16x32_bf16 v[60:63], v[76:79], v[184:187], 0
    s_waitcnt vmcnt(9)
    v_mfma_f32_16x16x32_bf16 v[16:19], v[80:83], v[188:191], v[16:19]
    buffer_load_dwordx4 v[176:179], v5, s[4:7], s56 offen offset:2048 sc1
    v_mfma_f32_16x16x32_bf16 v[20:23], v[84:87], v[188:191], v[20:23]
    buffer_load_dwordx4 v[180:183], v6, s[4:7], s56 offen offset:2048 sc1
    v_mfma_f32_16x16x32_bf16 v[24:27], v[88:91], v[188:191], v[24:27]
    buffer_load_dwordx4 v[184:187], v7, s[4:7], s56 offen offset:2048 sc1
    s_add_u32 s56, s56, 4096
    v_mfma_f32_16x16x32_bf16 v[28:31], v[92:95], v[188:191], v[28:31]
    ds_read_b64_tr_b16 v[64:65], v10 offset:40960
    v_mfma_f32_16x16x32_bf16 v[32:35], v[80:83], v[192:195], v[32:35]
    ds_read_b64_tr_b16 v[66:67], v10 offset:41472
    v_mfma_f32_16x16x32_bf16 v[36:39], v[84:87], v[192:195], v[36:39]
    ds_read_b64_tr_b16 v[68:69], v11 offset:40960
    v_mfma_f32_16x16x32_bf16 v[40:43], v[88:91], v[192:195], v[40:43]
    ds_read_b64_tr_b16 v[70:71], v11 offset:41472
    v_mfma_f32_16x16x32_bf16 v[44:47], v[92:95], v[192:195], v[44:47]
    ds_read_b64_tr_b16 v[72:73], v12 offset:40960
    v_mfma_f32_16x16x32_bf16 v[48:51], v[80:83], v[196:199], v[48:51]
    ds_read_b64_tr_b16 v[74:75], v12 offset:41472
    v_mfma_f32_16x16x32_bf16 v[52:55], v[84:87], v[196:199], v[52:55]
    ds_read_b64_tr_b16 v[76:77], v13 offset:40960
    v_mfma_f32_16x16x32_bf16 v[56:59], v[88:91], v[196:199], v[56:59]
    ds_read_b64_tr_b16 v[78:79], v13 offset:41472
    v_mfma_f32_16x16x32_bf16 v[60:63], v[92:95], v[196:199], v[60:63]
    s_waitcnt vmcnt(9)
    v_mfma_f32_16x16x32_bf16 v[16:19], v[96:99], v[200:203], v[16:19]
    buffer_load_dwordx4 v[188:191], v5, s[4:7], s56 offen offset:0 sc1
    v_mfma_f32_16x16x32_bf16 v[20:23], v[100:103], v[200:203], v[20:23]
    buffer_load_dwordx4 v[192:195], v6, s[4:7], s56 offen offset:0 sc1
    v_mfma_f32_16x16x32_bf16 v[24:27], v[104:107], v[200:203], v[24:27]
    buffer_load_dwordx4 v[196:199], v7, s[4:7], s56 offen offset:0 sc1
    v_mfma_f32_16x16x32_bf16 v[28:31], v[108:111], v[200:203], v[28:31]
    ds_read_b64_tr_b16 v[80:81], v10 offset:49152
    v_mfma_f32_16x16x32_bf16 v[32:35], v[96:99], v[204:207], v[32:35]
    ds_read_b64_tr_b16 v[82:83], v10 offset:49664
    v_mfma_f32_16x16x32_bf16 v[36:39], v[100:103], v[204:207], v[36:39]
    ds_read_b64_tr_b16 v[84:85], v11 offset:49152
    v_mfma_f32_16x16x32_bf16 v[40:43], v[104:107], v[204:207], v[40:43]
    ds_read_b64_tr_b16 v[86:87], v11 offset:49664
    v_mfma_f32_16x16x32_bf16 v[44:47], v[108:111], v[204:207], v[44:47]
    ds_read_b64_tr_b16 v[88:89], v12 offset:49152
    v_mfma_f32_16x16x32_bf16 v[48:51], v[96:99], v[208:211], v[48:51]
    ds_read_b64_tr_b16 v[90:91], v12 offset:49664
    v_mfma_f32_16x16x32_bf16 v[52:55], v[100:103], v[208:211], v[52:55]
    ds_read_b64_tr_b16 v[92:93], v13 offset:49152
    v_mfma_f32_16x16x32_bf16 v[56:59], v[104:107], v[208:211], v[56:59]
    ds_read_b64_tr_b16 v[94:95], v13 offset:49664
    v_mfma_f32_16x16x32_bf16 v[60:63], v[108:111], v[208:211], v[60:63]
    s_waitcnt vmcnt(9)
    v_mfma_f32_16x16x32_bf16 v[16:19], v[112:115], v[212:215], v[16:19]
    buffer_load_dwordx4 v[200:203], v5, s[4:7], s56 offen offset:2048 sc1
    v_mfma_f32_16x16x32_bf16 v[20:23], v[116:119], v[212:215], v[20:23]
    buffer_load_dwordx4 v[204:207], v6, s[4:7], s56 offen offset:2048 sc1
    v_mfma_f32_16x16x32_bf16 v[24:27], v[120:123], v[212:215], v[24:27]
    buffer_load_dwordx4 v[208:211], v7, s[4:7], s56 offen offset:2048 sc1
    s_add_u32 s56, s56, 4096
    v_mfma_f32_16x16x32_bf16 v[28:31], v[124:127], v[212:215], v[28:31]
    v_add_u32 v10, 57344, v10
    v_add_u32 v11, 57344, v11
    v_add_u32 v12, 57344, v12
    v_add_u32 v13, 57344, v13
    v_mfma_f32_16x16x32_bf16 v[32:35], v[112:115], v[216:219], v[32:35]
    ds_read_b64_tr_b16 v[96:97], v10 offset:0
    v_mfma_f32_16x16x32_bf16 v[36:39], v[116:119], v[216:219], v[36:39]
    ds_read_b64_tr_b16 v[98:99], v10 offset:512
    v_mfma_f32_16x16x32_bf16 v[40:43], v[120:123], v[216:219], v[40:43]
    ds_read_b64_tr_b16 v[100:101], v11 offset:0
    v_mfma_f32_16x16x32_bf16 v[44:47], v[124:127], v[216:219], v[44:47]
    ds_read_b64_tr_b16 v[102:103], v11 offset:512
    v_mfma_f32_16x16x32_bf16 v[48:51], v[112:115], v[220:223], v[48:51]
    ds_read_b64_tr_b16 v[104:105], v12 offset:0
    v_mfma_f32_16x16x32_bf16 v[52:55], v[116:119], v[220:223], v[52:55]
    ds_read_b64_tr_b16 v[106:107], v12 offset:512
    v_mfma_f32_16x16x32_bf16 v[56:59], v[120:123], v[220:223], v[56:59]
    ds_read_b64_tr_b16 v[108:109], v13 offset:0
    v_mfma_f32_16x16x32_bf16 v[60:63], v[124:127], v[220:223], v[60:63]
    ds_read_b64_tr_b16 v[110:111], v13 offset:512
    s_waitcnt vmcnt(9)
    v_mfma_f32_16x16x32_bf16 v[16:19], v[128:131], v[224:227], v[16:19]
    buffer_load_dwordx4 v[212:215], v5, s[4:7], s56 offen offset:0 sc1
    v_mfma_f32_16x16x32_bf16 v[20:23], v[132:135], v[224:227], v[20:23]
    buffer_load_dwordx4 v[216:219], v6, s[4:7], s56 offen offset:0 sc1
    v_mfma_f32_16x16x32_bf16 v[24:27], v[136:139], v[224:227], v[24:27]
    buffer_load_dwordx4 v[220:223], v7, s[4:7], s56 offen offset:0 sc1
    v_mfma_f32_16x16x32_bf16 v[28:31], v[140:143], v[224:227], v[28:31]
    ds_read_b64_tr_b16 v[112:113], v10 offset:8192
    v_mfma_f32_16x16x32_bf16 v[32:35], v[128:131], v[228:231], v[32:35]
    ds_read_b64_tr_b16 v[114:115], v10 offset:8704
    v_mfma_f32_16x16x32_bf16 v[36:39], v[132:135], v[228:231], v[36:39]
    ds_read_b64_tr_b16 v[116:117], v11 offset:8192
    v_mfma_f32_16x16x32_bf16 v[40:43], v[136:139], v[228:231], v[40:43]
    ds_read_b64_tr_b16 v[118:119], v11 offset:8704
    v_mfma_f32_16x16x32_bf16 v[44:47], v[140:143], v[228:231], v[44:47]
    ds_read_b64_tr_b16 v[120:121], v12 offset:8192
    v_mfma_f32_16x16x32_bf16 v[48:51], v[128:131], v[232:235], v[48:51]
    ds_read_b64_tr_b16 v[122:123], v12 offset:8704
    v_mfma_f32_16x16x32_bf16 v[52:55], v[132:135], v[232:235], v[52:55]
    ds_read_b64_tr_b16 v[124:125], v13 offset:8192
    v_mfma_f32_16x16x32_bf16 v[56:59], v[136:139], v[232:235], v[56:59]
    ds_read_b64_tr_b16 v[126:127], v13 offset:8704
    v_mfma_f32_16x16x32_bf16 v[60:63], v[140:143], v[232:235], v[60:63]
    s_waitcnt vmcnt(9)
    v_mfma_f32_16x16x32_bf16 v[16:19], v[144:147], v[176:179], v[16:19]
    buffer_load_dwordx4 v[224:227], v5, s[4:7], s56 offen offset:2048 sc1
    v_mfma_f32_16x16x32_bf16 v[20:23], v[148:151], v[176:179], v[20:23]
    buffer_load_dwordx4 v[228:231], v6, s[4:7], s56 offen offset:2048 sc1
    v_mfma_f32_16x16x32_bf16 v[24:27], v[152:155], v[176:179], v[24:27]
    buffer_load_dwordx4 v[232:235], v7, s[4:7], s56 offen offset:2048 sc1
    s_add_u32 s56, s56, 4096
    v_mfma_f32_16x16x32_bf16 v[28:31], v[156:159], v[176:179], v[28:31]
    ds_read_b64_tr_b16 v[128:129], v10 offset:16384
    v_mfma_f32_16x16x32_bf16 v[32:35], v[144:147], v[180:183], v[32:35]
    ds_read_b64_tr_b16 v[130:131], v10 offset:16896
    v_mfma_f32_16x16x32_bf16 v[36:39], v[148:151], v[180:183], v[36:39]
    ds_read_b64_tr_b16 v[132:133], v11 offset:16384
    v_mfma_f32_16x16x32_bf16 v[40:43], v[152:155], v[180:183], v[40:43]
    ds_read_b64_tr_b16 v[134:135], v11 offset:16896
    v_mfma_f32_16x16x32_bf16 v[44:47], v[156:159], v[180:183], v[44:47]
    ds_read_b64_tr_b16 v[136:137], v12 offset:16384
    v_mfma_f32_16x16x32_bf16 v[48:51], v[144:147], v[184:187], v[48:51]
    ds_read_b64_tr_b16 v[138:139], v12 offset:16896
    v_mfma_f32_16x16x32_bf16 v[52:55], v[148:151], v[184:187], v[52:55]
    ds_read_b64_tr_b16 v[140:141], v13 offset:16384
    v_mfma_f32_16x16x32_bf16 v[56:59], v[152:155], v[184:187], v[56:59]
    ds_read_b64_tr_b16 v[142:143], v13 offset:16896
    v_mfma_f32_16x16x32_bf16 v[60:63], v[156:159], v[184:187], v[60:63]
    s_waitcnt vmcnt(9)
    v_mfma_f32_16x16x32_bf16 v[16:19], v[160:163], v[188:191], v[16:19]
    buffer_load_dwordx4 v[176:179], v5, s[4:7], s56 offen offset:0 sc1
    v_mfma_f32_16x16x32_bf16 v[20:23], v[164:167], v[188:191], v[20:23]
    buffer_load_dwordx4 v[180:183], v6, s[4:7], s56 offen offset:0 sc1
    v_mfma_f32_16x16x32_bf16 v[24:27], v[168:171], v[188:191], v[24:27]
    buffer_load_dwordx4 v[184:187], v7, s[4:7], s56 offen offset:0 sc1
    v_mfma_f32_16x16x32_bf16 v[28:31], v[172:175], v[188:191], v[28:31]
    v_add_u32 v10, 4294860800, v10
    v_add_u32 v11, 4294860800, v11
    v_add_u32 v12, 4294860800, v12
    v_add_u32 v13, 4294860800, v13
    v_mfma_f32_16x16x32_bf16 v[32:35], v[160:163], v[192:195], v[32:35]
    ds_read_b64_tr_b16 v[144:145], v10 offset:0
    v_mfma_f32_16x16x32_bf16 v[36:39], v[164:167], v[192:195], v[36:39]
    ds_read_b64_tr_b16 v[146:147], v10 offset:512
    v_mfma_f32_16x16x32_bf16 v[40:43], v[168:171], v[192:195], v[40:43]
    ds_read_b64_tr_b16 v[148:149], v11 offset:0
    v_mfma_f32_16x16x32_bf16 v[44:47], v[172:175], v[192:195], v[44:47]
    ds_read_b64_tr_b16 v[150:151], v11 offset:512
    v_mfma_f32_16x16x32_bf16 v[48:51], v[160:163], v[196:199], v[48:51]
    ds_read_b64_tr_b16 v[152:153], v12 offset:0
    v_mfma_f32_16x16x32_bf16 v[52:55], v[164:167], v[196:199], v[52:55]
    ds_read_b64_tr_b16 v[154:155], v12 offset:512
    v_mfma_f32_16x16x32_bf16 v[56:59], v[168:171], v[196:199], v[56:59]
    ds_read_b64_tr_b16 v[156:157], v13 offset:0
    v_mfma_f32_16x16x32_bf16 v[60:63], v[172:175], v[196:199], v[60:63]
    ds_read_b64_tr_b16 v[158:159], v13 offset:512
    s_barrier
    s_waitcnt vmcnt(9)
    s_waitcnt lgkmcnt(15)
    v_mfma_f32_16x16x32_bf16 v[16:19], v[64:67], v[200:203], v[16:19]
    buffer_load_dwordx4 v[188:191], v5, s[4:7], s56 offen offset:2048 sc1
    v_mfma_f32_16x16x32_bf16 v[20:23], v[68:71], v[200:203], v[20:23]
    buffer_load_dwordx4 v[192:195], v6, s[4:7], s56 offen offset:2048 sc1
    v_mfma_f32_16x16x32_bf16 v[24:27], v[72:75], v[200:203], v[24:27]
    buffer_load_dwordx4 v[196:199], v7, s[4:7], s56 offen offset:2048 sc1
    s_add_u32 s56, s56, 4096
    v_mfma_f32_16x16x32_bf16 v[28:31], v[76:79], v[200:203], v[28:31]
    ds_read_b64_tr_b16 v[160:161], v10 offset:8192
    v_mfma_f32_16x16x32_bf16 v[32:35], v[64:67], v[204:207], v[32:35]
    ds_read_b64_tr_b16 v[162:163], v10 offset:8704
    v_mfma_f32_16x16x32_bf16 v[36:39], v[68:71], v[204:207], v[36:39]
    ds_read_b64_tr_b16 v[164:165], v11 offset:8192
    v_mfma_f32_16x16x32_bf16 v[40:43], v[72:75], v[204:207], v[40:43]
    ds_read_b64_tr_b16 v[166:167], v11 offset:8704
    v_mfma_f32_16x16x32_bf16 v[44:47], v[76:79], v[204:207], v[44:47]
    ds_read_b64_tr_b16 v[168:169], v12 offset:8192
    v_mfma_f32_16x16x32_bf16 v[48:51], v[64:67], v[208:211], v[48:51]
    ds_read_b64_tr_b16 v[170:171], v12 offset:8704
    v_mfma_f32_16x16x32_bf16 v[52:55], v[68:71], v[208:211], v[52:55]
    ds_read_b64_tr_b16 v[172:173], v13 offset:8192
    v_mfma_f32_16x16x32_bf16 v[56:59], v[72:75], v[208:211], v[56:59]
    ds_read_b64_tr_b16 v[174:175], v13 offset:8704
    v_mfma_f32_16x16x32_bf16 v[60:63], v[76:79], v[208:211], v[60:63]
    s_waitcnt vmcnt(9)
    v_mfma_f32_16x16x32_bf16 v[16:19], v[80:83], v[212:215], v[16:19]
    buffer_load_dwordx4 v[200:203], v5, s[4:7], s56 offen offset:0 sc1
    v_mfma_f32_16x16x32_bf16 v[20:23], v[84:87], v[212:215], v[20:23]
    buffer_load_dwordx4 v[204:207], v6, s[4:7], s56 offen offset:0 sc1
    v_mfma_f32_16x16x32_bf16 v[24:27], v[88:91], v[212:215], v[24:27]
    buffer_load_dwordx4 v[208:211], v7, s[4:7], s56 offen offset:0 sc1
    v_mfma_f32_16x16x32_bf16 v[28:31], v[92:95], v[212:215], v[28:31]
    ds_read_b64_tr_b16 v[64:65], v10 offset:16384
    v_mfma_f32_16x16x32_bf16 v[32:35], v[80:83], v[216:219], v[32:35]
    ds_read_b64_tr_b16 v[66:67], v10 offset:16896
    v_mfma_f32_16x16x32_bf16 v[36:39], v[84:87], v[216:219], v[36:39]
    ds_read_b64_tr_b16 v[68:69], v11 offset:16384
    v_mfma_f32_16x16x32_bf16 v[40:43], v[88:91], v[216:219], v[40:43]
    ds_read_b64_tr_b16 v[70:71], v11 offset:16896
    v_mfma_f32_16x16x32_bf16 v[44:47], v[92:95], v[216:219], v[44:47]
    ds_read_b64_tr_b16 v[72:73], v12 offset:16384
    v_mfma_f32_16x16x32_bf16 v[48:51], v[80:83], v[220:223], v[48:51]
    ds_read_b64_tr_b16 v[74:75], v12 offset:16896
    v_mfma_f32_16x16x32_bf16 v[52:55], v[84:87], v[220:223], v[52:55]
    ds_read_b64_tr_b16 v[76:77], v13 offset:16384
    v_mfma_f32_16x16x32_bf16 v[56:59], v[88:91], v[220:223], v[56:59]
    ds_read_b64_tr_b16 v[78:79], v13 offset:16896
    v_mfma_f32_16x16x32_bf16 v[60:63], v[92:95], v[220:223], v[60:63]
    s_waitcnt vmcnt(9)
    v_mfma_f32_16x16x32_bf16 v[16:19], v[96:99], v[224:227], v[16:19]
    buffer_load_dwordx4 v[212:215], v5, s[4:7], s56 offen offset:2048 sc1
    v_mfma_f32_16x16x32_bf16 v[20:23], v[100:103], v[224:227], v[20:23]
    buffer_load_dwordx4 v[216:219], v6, s[4:7], s56 offen offset:2048 sc1
    v_mfma_f32_16x16x32_bf16 v[24:27], v[104:107], v[224:227], v[24:27]
    buffer_load_dwordx4 v[220:223], v7, s[4:7], s56 offen offset:2048 sc1
    s_add_u32 s56, s56, 4096
    v_mfma_f32_16x16x32_bf16 v[28:31], v[108:111], v[224:227], v[28:31]
    ds_read_b64_tr_b16 v[80:81], v10 offset:24576
    v_mfma_f32_16x16x32_bf16 v[32:35], v[96:99], v[228:231], v[32:35]
    ds_read_b64_tr_b16 v[82:83], v10 offset:25088
    v_mfma_f32_16x16x32_bf16 v[36:39], v[100:103], v[228:231], v[36:39]
    ds_read_b64_tr_b16 v[84:85], v11 offset:24576
    v_mfma_f32_16x16x32_bf16 v[40:43], v[104:107], v[228:231], v[40:43]
    ds_read_b64_tr_b16 v[86:87], v11 offset:25088
    v_mfma_f32_16x16x32_bf16 v[44:47], v[108:111], v[228:231], v[44:47]
    ds_read_b64_tr_b16 v[88:89], v12 offset:24576
    v_mfma_f32_16x16x32_bf16 v[48:51], v[96:99], v[232:235], v[48:51]
    ds_read_b64_tr_b16 v[90:91], v12 offset:25088
    v_mfma_f32_16x16x32_bf16 v[52:55], v[100:103], v[232:235], v[52:55]
    ds_read_b64_tr_b16 v[92:93], v13 offset:24576
    v_mfma_f32_16x16x32_bf16 v[56:59], v[104:107], v[232:235], v[56:59]
    ds_read_b64_tr_b16 v[94:95], v13 offset:25088
    v_mfma_f32_16x16x32_bf16 v[60:63], v[108:111], v[232:235], v[60:63]
    s_waitcnt vmcnt(9)
    v_mfma_f32_16x16x32_bf16 v[16:19], v[112:115], v[176:179], v[16:19]
    buffer_load_dwordx4 v[224:227], v5, s[4:7], s56 offen offset:0 sc1
    v_mfma_f32_16x16x32_bf16 v[20:23], v[116:119], v[176:179], v[20:23]
    buffer_load_dwordx4 v[228:231], v6, s[4:7], s56 offen offset:0 sc1
    v_mfma_f32_16x16x32_bf16 v[24:27], v[120:123], v[176:179], v[24:27]
    buffer_load_dwordx4 v[232:235], v7, s[4:7], s56 offen offset:0 sc1
    v_mfma_f32_16x16x32_bf16 v[28:31], v[124:127], v[176:179], v[28:31]
    ds_read_b64_tr_b16 v[96:97], v10 offset:32768
    v_mfma_f32_16x16x32_bf16 v[32:35], v[112:115], v[180:183], v[32:35]
    ds_read_b64_tr_b16 v[98:99], v10 offset:33280
    v_mfma_f32_16x16x32_bf16 v[36:39], v[116:119], v[180:183], v[36:39]
    ds_read_b64_tr_b16 v[100:101], v11 offset:32768
    v_mfma_f32_16x16x32_bf16 v[40:43], v[120:123], v[180:183], v[40:43]
    ds_read_b64_tr_b16 v[102:103], v11 offset:33280
    v_mfma_f32_16x16x32_bf16 v[44:47], v[124:127], v[180:183], v[44:47]
    ds_read_b64_tr_b16 v[104:105], v12 offset:32768
    v_mfma_f32_16x16x32_bf16 v[48:51], v[112:115], v[184:187], v[48:51]
    ds_read_b64_tr_b16 v[106:107], v12 offset:33280
    v_mfma_f32_16x16x32_bf16 v[52:55], v[116:119], v[184:187], v[52:55]
    ds_read_b64_tr_b16 v[108:109], v13 offset:32768
    v_mfma_f32_16x16x32_bf16 v[56:59], v[120:123], v[184:187], v[56:59]
    ds_read_b64_tr_b16 v[110:111], v13 offset:33280
    v_mfma_f32_16x16x32_bf16 v[60:63], v[124:127], v[184:187], v[60:63]
    s_waitcnt vmcnt(9)
    s_waitcnt lgkmcnt(15)
    v_mfma_f32_16x16x32_bf16 v[16:19], v[128:131], v[188:191], v[16:19]
    buffer_load_dwordx4 v[176:179], v5, s[4:7], s56 offen offset:2048 sc1
    v_mfma_f32_16x16x32_bf16 v[20:23], v[132:135], v[188:191], v[20:23]
    buffer_load_dwordx4 v[180:183], v6, s[4:7], s56 offen offset:2048 sc1
    v_mfma_f32_16x16x32_bf16 v[24:27], v[136:139], v[188:191], v[24:27]
    buffer_load_dwordx4 v[184:187], v7, s[4:7], s56 offen offset:2048 sc1
    s_add_u32 s56, s56, 4096
    v_mfma_f32_16x16x32_bf16 v[28:31], v[140:143], v[188:191], v[28:31]
    ds_read_b64_tr_b16 v[112:113], v10 offset:40960
    v_mfma_f32_16x16x32_bf16 v[32:35], v[128:131], v[192:195], v[32:35]
    ds_read_b64_tr_b16 v[114:115], v10 offset:41472
    v_mfma_f32_16x16x32_bf16 v[36:39], v[132:135], v[192:195], v[36:39]
    ds_read_b64_tr_b16 v[116:117], v11 offset:40960
    v_mfma_f32_16x16x32_bf16 v[40:43], v[136:139], v[192:195], v[40:43]
    ds_read_b64_tr_b16 v[118:119], v11 offset:41472
    v_mfma_f32_16x16x32_bf16 v[44:47], v[140:143], v[192:195], v[44:47]
    ds_read_b64_tr_b16 v[120:121], v12 offset:40960
    v_mfma_f32_16x16x32_bf16 v[48:51], v[128:131], v[196:199], v[48:51]
    ds_read_b64_tr_b16 v[122:123], v12 offset:41472
    v_mfma_f32_16x16x32_bf16 v[52:55], v[132:135], v[196:199], v[52:55]
    ds_read_b64_tr_b16 v[124:125], v13 offset:40960
    v_mfma_f32_16x16x32_bf16 v[56:59], v[136:139], v[196:199], v[56:59]
    ds_read_b64_tr_b16 v[126:127], v13 offset:41472
    v_mfma_f32_16x16x32_bf16 v[60:63], v[140:143], v[196:199], v[60:63]
    s_waitcnt vmcnt(9)
    v_mfma_f32_16x16x32_bf16 v[16:19], v[144:147], v[200:203], v[16:19]
    buffer_load_dwordx4 v[188:191], v5, s[4:7], s56 offen offset:0 sc1
    v_mfma_f32_16x16x32_bf16 v[20:23], v[148:151], v[200:203], v[20:23]
    buffer_load_dwordx4 v[192:195], v6, s[4:7], s56 offen offset:0 sc1
    v_mfma_f32_16x16x32_bf16 v[24:27], v[152:155], v[200:203], v[24:27]
    buffer_load_dwordx4 v[196:199], v7, s[4:7], s56 offen offset:0 sc1
    v_mfma_f32_16x16x32_bf16 v[28:31], v[156:159], v[200:203], v[28:31]
    v_add_u32 v10, 131072, v10
    v_add_u32 v11, 131072, v11
    v_add_u32 v12, 131072, v12
    v_add_u32 v13, 131072, v13
    v_mfma_f32_16x16x32_bf16 v[32:35], v[144:147], v[204:207], v[32:35]
    ds_read_b64_tr_b16 v[128:129], v10 offset:0
    v_mfma_f32_16x16x32_bf16 v[36:39], v[148:151], v[204:207], v[36:39]
    ds_read_b64_tr_b16 v[130:131], v10 offset:512
    v_mfma_f32_16x16x32_bf16 v[40:43], v[152:155], v[204:207], v[40:43]
    ds_read_b64_tr_b16 v[132:133], v11 offset:0
    v_mfma_f32_16x16x32_bf16 v[44:47], v[156:159], v[204:207], v[44:47]
    ds_read_b64_tr_b16 v[134:135], v11 offset:512
    v_mfma_f32_16x16x32_bf16 v[48:51], v[144:147], v[208:211], v[48:51]
    ds_read_b64_tr_b16 v[136:137], v12 offset:0
    v_mfma_f32_16x16x32_bf16 v[52:55], v[148:151], v[208:211], v[52:55]
    ds_read_b64_tr_b16 v[138:139], v12 offset:512
    v_mfma_f32_16x16x32_bf16 v[56:59], v[152:155], v[208:211], v[56:59]
    ds_read_b64_tr_b16 v[140:141], v13 offset:0
    v_mfma_f32_16x16x32_bf16 v[60:63], v[156:159], v[208:211], v[60:63]
    ds_read_b64_tr_b16 v[142:143], v13 offset:512
    s_waitcnt vmcnt(9)
    v_mfma_f32_16x16x32_bf16 v[16:19], v[160:163], v[212:215], v[16:19]
    buffer_load_dwordx4 v[200:203], v5, s[4:7], s56 offen offset:2048 sc1
    v_mfma_f32_16x16x32_bf16 v[20:23], v[164:167], v[212:215], v[20:23]
    buffer_load_dwordx4 v[204:207], v6, s[4:7], s56 offen offset:2048 sc1
    v_mfma_f32_16x16x32_bf16 v[24:27], v[168:171], v[212:215], v[24:27]
    buffer_load_dwordx4 v[208:211], v7, s[4:7], s56 offen offset:2048 sc1
    s_add_u32 s56, s56, 4096
    v_mfma_f32_16x16x32_bf16 v[28:31], v[172:175], v[212:215], v[28:31]
    ds_read_b64_tr_b16 v[144:145], v10 offset:8192
    v_mfma_f32_16x16x32_bf16 v[32:35], v[160:163], v[216:219], v[32:35]
    ds_read_b64_tr_b16 v[146:147], v10 offset:8704
    v_mfma_f32_16x16x32_bf16 v[36:39], v[164:167], v[216:219], v[36:39]
    ds_read_b64_tr_b16 v[148:149], v11 offset:8192
    v_mfma_f32_16x16x32_bf16 v[40:43], v[168:171], v[216:219], v[40:43]
    ds_read_b64_tr_b16 v[150:151], v11 offset:8704
    v_mfma_f32_16x16x32_bf16 v[44:47], v[172:175], v[216:219], v[44:47]
    ds_read_b64_tr_b16 v[152:153], v12 offset:8192
    v_mfma_f32_16x16x32_bf16 v[48:51], v[160:163], v[220:223], v[48:51]
    ds_read_b64_tr_b16 v[154:155], v12 offset:8704
    v_mfma_f32_16x16x32_bf16 v[52:55], v[164:167], v[220:223], v[52:55]
    ds_read_b64_tr_b16 v[156:157], v13 offset:8192
    v_mfma_f32_16x16x32_bf16 v[56:59], v[168:171], v[220:223], v[56:59]
    ds_read_b64_tr_b16 v[158:159], v13 offset:8704
    v_mfma_f32_16x16x32_bf16 v[60:63], v[172:175], v[220:223], v[60:63]
    s_barrier
    s_waitcnt vmcnt(9)
    v_mfma_f32_16x16x32_bf16 v[16:19], v[64:67], v[224:227], v[16:19]
    buffer_load_dwordx4 v[212:215], v5, s[4:7], s56 offen offset:0 sc1
    v_mfma_f32_16x16x32_bf16 v[20:23], v[68:71], v[224:227], v[20:23]
    buffer_load_dwordx4 v[216:219], v6, s[4:7], s56 offen offset:0 sc1
    v_mfma_f32_16x16x32_bf16 v[24:27], v[72:75], v[224:227], v[24:27]
    buffer_load_dwordx4 v[220:223], v7, s[4:7], s56 offen offset:0 sc1
    v_mfma_f32_16x16x32_bf16 v[28:31], v[76:79], v[224:227], v[28:31]
    ds_read_b64_tr_b16 v[160:161], v10 offset:16384
    v_mfma_f32_16x16x32_bf16 v[32:35], v[64:67], v[228:231], v[32:35]
    ds_read_b64_tr_b16 v[162:163], v10 offset:16896
    v_mfma_f32_16x16x32_bf16 v[36:39], v[68:71], v[228:231], v[36:39]
    ds_read_b64_tr_b16 v[164:165], v11 offset:16384
    v_mfma_f32_16x16x32_bf16 v[40:43], v[72:75], v[228:231], v[40:43]
    ds_read_b64_tr_b16 v[166:167], v11 offset:16896
    v_mfma_f32_16x16x32_bf16 v[44:47], v[76:79], v[228:231], v[44:47]
    ds_read_b64_tr_b16 v[168:169], v12 offset:16384
    v_mfma_f32_16x16x32_bf16 v[48:51], v[64:67], v[232:235], v[48:51]
    ds_read_b64_tr_b16 v[170:171], v12 offset:16896
    v_mfma_f32_16x16x32_bf16 v[52:55], v[68:71], v[232:235], v[52:55]
    ds_read_b64_tr_b16 v[172:173], v13 offset:16384
    v_mfma_f32_16x16x32_bf16 v[56:59], v[72:75], v[232:235], v[56:59]
    ds_read_b64_tr_b16 v[174:175], v13 offset:16896
    v_mfma_f32_16x16x32_bf16 v[60:63], v[76:79], v[232:235], v[60:63]
    s_waitcnt vmcnt(9)
    s_waitcnt lgkmcnt(15)
    v_mfma_f32_16x16x32_bf16 v[16:19], v[80:83], v[176:179], v[16:19]
    buffer_load_dwordx4 v[224:227], v5, s[4:7], s56 offen offset:2048 sc1
    v_mfma_f32_16x16x32_bf16 v[20:23], v[84:87], v[176:179], v[20:23]
    buffer_load_dwordx4 v[228:231], v6, s[4:7], s56 offen offset:2048 sc1
    v_mfma_f32_16x16x32_bf16 v[24:27], v[88:91], v[176:179], v[24:27]
    buffer_load_dwordx4 v[232:235], v7, s[4:7], s56 offen offset:2048 sc1
    s_add_u32 s56, s56, 4096
    v_mfma_f32_16x16x32_bf16 v[28:31], v[92:95], v[176:179], v[28:31]
    ds_read_b64_tr_b16 v[64:65], v10 offset:24576
    v_mfma_f32_16x16x32_bf16 v[32:35], v[80:83], v[180:183], v[32:35]
    ds_read_b64_tr_b16 v[66:67], v10 offset:25088
    v_mfma_f32_16x16x32_bf16 v[36:39], v[84:87], v[180:183], v[36:39]
    ds_read_b64_tr_b16 v[68:69], v11 offset:24576
    v_mfma_f32_16x16x32_bf16 v[40:43], v[88:91], v[180:183], v[40:43]
    ds_read_b64_tr_b16 v[70:71], v11 offset:25088
    v_mfma_f32_16x16x32_bf16 v[44:47], v[92:95], v[180:183], v[44:47]
    ds_read_b64_tr_b16 v[72:73], v12 offset:24576
    v_mfma_f32_16x16x32_bf16 v[48:51], v[80:83], v[184:187], v[48:51]
    ds_read_b64_tr_b16 v[74:75], v12 offset:25088
    v_mfma_f32_16x16x32_bf16 v[52:55], v[84:87], v[184:187], v[52:55]
    ds_read_b64_tr_b16 v[76:77], v13 offset:24576
    v_mfma_f32_16x16x32_bf16 v[56:59], v[88:91], v[184:187], v[56:59]
    ds_read_b64_tr_b16 v[78:79], v13 offset:25088
    v_mfma_f32_16x16x32_bf16 v[60:63], v[92:95], v[184:187], v[60:63]
    s_waitcnt vmcnt(9)
    v_mfma_f32_16x16x32_bf16 v[16:19], v[96:99], v[188:191], v[16:19]
    buffer_load_dwordx4 v[176:179], v5, s[4:7], s56 offen offset:0 sc1
    v_mfma_f32_16x16x32_bf16 v[20:23], v[100:103], v[188:191], v[20:23]
    buffer_load_dwordx4 v[180:183], v6, s[4:7], s56 offen offset:0 sc1
    v_mfma_f32_16x16x32_bf16 v[24:27], v[104:107], v[188:191], v[24:27]
    buffer_load_dwordx4 v[184:187], v7, s[4:7], s56 offen offset:0 sc1
    v_mfma_f32_16x16x32_bf16 v[28:31], v[108:111], v[188:191], v[28:31]
    v_add_u32 v10, 4294885376, v10
    v_add_u32 v11, 4294885376, v11
    v_add_u32 v12, 4294885376, v12
    v_add_u32 v13, 4294885376, v13
    v_mfma_f32_16x16x32_bf16 v[32:35], v[96:99], v[192:195], v[32:35]
    ds_read_b64_tr_b16 v[80:81], v10 offset:0
    v_mfma_f32_16x16x32_bf16 v[36:39], v[100:103], v[192:195], v[36:39]
    ds_read_b64_tr_b16 v[82:83], v10 offset:512
    v_mfma_f32_16x16x32_bf16 v[40:43], v[104:107], v[192:195], v[40:43]
    ds_read_b64_tr_b16 v[84:85], v11 offset:0
    v_mfma_f32_16x16x32_bf16 v[44:47], v[108:111], v[192:195], v[44:47]
    ds_read_b64_tr_b16 v[86:87], v11 offset:512
    v_mfma_f32_16x16x32_bf16 v[48:51], v[96:99], v[196:199], v[48:51]
    ds_read_b64_tr_b16 v[88:89], v12 offset:0
    v_mfma_f32_16x16x32_bf16 v[52:55], v[100:103], v[196:199], v[52:55]
    ds_read_b64_tr_b16 v[90:91], v12 offset:512
    v_mfma_f32_16x16x32_bf16 v[56:59], v[104:107], v[196:199], v[56:59]
    ds_read_b64_tr_b16 v[92:93], v13 offset:0
    v_mfma_f32_16x16x32_bf16 v[60:63], v[108:111], v[196:199], v[60:63]
    ds_read_b64_tr_b16 v[94:95], v13 offset:512
    s_waitcnt vmcnt(9)
    v_mfma_f32_16x16x32_bf16 v[16:19], v[112:115], v[200:203], v[16:19]
    buffer_load_dwordx4 v[188:191], v5, s[4:7], s56 offen offset:2048 sc1
    v_mfma_f32_16x16x32_bf16 v[20:23], v[116:119], v[200:203], v[20:23]
    buffer_load_dwordx4 v[192:195], v6, s[4:7], s56 offen offset:2048 sc1
    v_mfma_f32_16x16x32_bf16 v[24:27], v[120:123], v[200:203], v[24:27]
    buffer_load_dwordx4 v[196:199], v7, s[4:7], s56 offen offset:2048 sc1
    s_add_u32 s56, s56, 4096
    v_mfma_f32_16x16x32_bf16 v[28:31], v[124:127], v[200:203], v[28:31]
    ds_read_b64_tr_b16 v[96:97], v10 offset:8192
    v_mfma_f32_16x16x32_bf16 v[32:35], v[112:115], v[204:207], v[32:35]
    ds_read_b64_tr_b16 v[98:99], v10 offset:8704
    v_mfma_f32_16x16x32_bf16 v[36:39], v[116:119], v[204:207], v[36:39]
    ds_read_b64_tr_b16 v[100:101], v11 offset:8192
    v_mfma_f32_16x16x32_bf16 v[40:43], v[120:123], v[204:207], v[40:43]
    ds_read_b64_tr_b16 v[102:103], v11 offset:8704
    v_mfma_f32_16x16x32_bf16 v[44:47], v[124:127], v[204:207], v[44:47]
    ds_read_b64_tr_b16 v[104:105], v12 offset:8192
    v_mfma_f32_16x16x32_bf16 v[48:51], v[112:115], v[208:211], v[48:51]
    ds_read_b64_tr_b16 v[106:107], v12 offset:8704
    v_mfma_f32_16x16x32_bf16 v[52:55], v[116:119], v[208:211], v[52:55]
    ds_read_b64_tr_b16 v[108:109], v13 offset:8192
    v_mfma_f32_16x16x32_bf16 v[56:59], v[120:123], v[208:211], v[56:59]
    ds_read_b64_tr_b16 v[110:111], v13 offset:8704
    v_mfma_f32_16x16x32_bf16 v[60:63], v[124:127], v[208:211], v[60:63]
    s_waitcnt vmcnt(9)
    v_mfma_f32_16x16x32_bf16 v[16:19], v[128:131], v[212:215], v[16:19]
    buffer_load_dwordx4 v[200:203], v5, s[4:7], s56 offen offset:0 sc1
    v_mfma_f32_16x16x32_bf16 v[20:23], v[132:135], v[212:215], v[20:23]
    buffer_load_dwordx4 v[204:207], v6, s[4:7], s56 offen offset:0 sc1
    v_mfma_f32_16x16x32_bf16 v[24:27], v[136:139], v[212:215], v[24:27]
    buffer_load_dwordx4 v[208:211], v7, s[4:7], s56 offen offset:0 sc1
    v_mfma_f32_16x16x32_bf16 v[28:31], v[140:143], v[212:215], v[28:31]
    ds_read_b64_tr_b16 v[112:113], v10 offset:16384
    v_mfma_f32_16x16x32_bf16 v[32:35], v[128:131], v[216:219], v[32:35]
    ds_read_b64_tr_b16 v[114:115], v10 offset:16896
    v_mfma_f32_16x16x32_bf16 v[36:39], v[132:135], v[216:219], v[36:39]
    ds_read_b64_tr_b16 v[116:117], v11 offset:16384
    v_mfma_f32_16x16x32_bf16 v[40:43], v[136:139], v[216:219], v[40:43]
    ds_read_b64_tr_b16 v[118:119], v11 offset:16896
    v_mfma_f32_16x16x32_bf16 v[44:47], v[140:143], v[216:219], v[44:47]
    ds_read_b64_tr_b16 v[120:121], v12 offset:16384
    v_mfma_f32_16x16x32_bf16 v[48:51], v[128:131], v[220:223], v[48:51]
    ds_read_b64_tr_b16 v[122:123], v12 offset:16896
    v_mfma_f32_16x16x32_bf16 v[52:55], v[132:135], v[220:223], v[52:55]
    ds_read_b64_tr_b16 v[124:125], v13 offset:16384
    v_mfma_f32_16x16x32_bf16 v[56:59], v[136:139], v[220:223], v[56:59]
    ds_read_b64_tr_b16 v[126:127], v13 offset:16896
    v_mfma_f32_16x16x32_bf16 v[60:63], v[140:143], v[220:223], v[60:63]
    s_waitcnt vmcnt(9)
    s_waitcnt lgkmcnt(15)
    v_mfma_f32_16x16x32_bf16 v[16:19], v[144:147], v[224:227], v[16:19]
    buffer_load_dwordx4 v[212:215], v5, s[4:7], s56 offen offset:2048 sc1
    v_mfma_f32_16x16x32_bf16 v[20:23], v[148:151], v[224:227], v[20:23]
    buffer_load_dwordx4 v[216:219], v6, s[4:7], s56 offen offset:2048 sc1
    v_mfma_f32_16x16x32_bf16 v[24:27], v[152:155], v[224:227], v[24:27]
    buffer_load_dwordx4 v[220:223], v7, s[4:7], s56 offen offset:2048 sc1
    s_add_u32 s56, s56, 4096
    v_mfma_f32_16x16x32_bf16 v[28:31], v[156:159], v[224:227], v[28:31]
    ds_read_b64_tr_b16 v[128:129], v10 offset:24576
    v_mfma_f32_16x16x32_bf16 v[32:35], v[144:147], v[228:231], v[32:35]
    ds_read_b64_tr_b16 v[130:131], v10 offset:25088
    v_mfma_f32_16x16x32_bf16 v[36:39], v[148:151], v[228:231], v[36:39]
    ds_read_b64_tr_b16 v[132:133], v11 offset:24576
    v_mfma_f32_16x16x32_bf16 v[40:43], v[152:155], v[228:231], v[40:43]
    ds_read_b64_tr_b16 v[134:135], v11 offset:25088
    v_mfma_f32_16x16x32_bf16 v[44:47], v[156:159], v[228:231], v[44:47]
    ds_read_b64_tr_b16 v[136:137], v12 offset:24576
    v_mfma_f32_16x16x32_bf16 v[48:51], v[144:147], v[232:235], v[48:51]
    ds_read_b64_tr_b16 v[138:139], v12 offset:25088
    v_mfma_f32_16x16x32_bf16 v[52:55], v[148:151], v[232:235], v[52:55]
    ds_read_b64_tr_b16 v[140:141], v13 offset:24576
    v_mfma_f32_16x16x32_bf16 v[56:59], v[152:155], v[232:235], v[56:59]
    ds_read_b64_tr_b16 v[142:143], v13 offset:25088
    v_mfma_f32_16x16x32_bf16 v[60:63], v[156:159], v[232:235], v[60:63]
    s_waitcnt vmcnt(9)
    v_mfma_f32_16x16x32_bf16 v[16:19], v[160:163], v[176:179], v[16:19]
    buffer_load_dwordx4 v[224:227], v5, s[4:7], s56 offen offset:0 sc1
    v_mfma_f32_16x16x32_bf16 v[20:23], v[164:167], v[176:179], v[20:23]
    buffer_load_dwordx4 v[228:231], v6, s[4:7], s56 offen offset:0 sc1
    v_mfma_f32_16x16x32_bf16 v[24:27], v[168:171], v[176:179], v[24:27]
    buffer_load_dwordx4 v[232:235], v7, s[4:7], s56 offen offset:0 sc1
    v_mfma_f32_16x16x32_bf16 v[28:31], v[172:175], v[176:179], v[28:31]
    ds_read_b64_tr_b16 v[144:145], v10 offset:32768
    v_mfma_f32_16x16x32_bf16 v[32:35], v[160:163], v[180:183], v[32:35]
    ds_read_b64_tr_b16 v[146:147], v10 offset:33280
    v_mfma_f32_16x16x32_bf16 v[36:39], v[164:167], v[180:183], v[36:39]
    ds_read_b64_tr_b16 v[148:149], v11 offset:32768
    v_mfma_f32_16x16x32_bf16 v[40:43], v[168:171], v[180:183], v[40:43]
    ds_read_b64_tr_b16 v[150:151], v11 offset:33280
    v_mfma_f32_16x16x32_bf16 v[44:47], v[172:175], v[180:183], v[44:47]
    ds_read_b64_tr_b16 v[152:153], v12 offset:32768
    v_mfma_f32_16x16x32_bf16 v[48:51], v[160:163], v[184:187], v[48:51]
    ds_read_b64_tr_b16 v[154:155], v12 offset:33280
    v_mfma_f32_16x16x32_bf16 v[52:55], v[164:167], v[184:187], v[52:55]
    ds_read_b64_tr_b16 v[156:157], v13 offset:32768
    v_mfma_f32_16x16x32_bf16 v[56:59], v[168:171], v[184:187], v[56:59]
    ds_read_b64_tr_b16 v[158:159], v13 offset:33280
    v_mfma_f32_16x16x32_bf16 v[60:63], v[172:175], v[184:187], v[60:63]
    s_waitcnt vmcnt(9)
    v_mfma_f32_16x16x32_bf16 v[16:19], v[64:67], v[188:191], v[16:19]
    buffer_load_dwordx4 v[176:179], v5, s[4:7], s56 offen offset:2048 sc1
    v_mfma_f32_16x16x32_bf16 v[20:23], v[68:71], v[188:191], v[20:23]
    buffer_load_dwordx4 v[180:183], v6, s[4:7], s56 offen offset:2048 sc1
    v_mfma_f32_16x16x32_bf16 v[24:27], v[72:75], v[188:191], v[24:27]
    buffer_load_dwordx4 v[184:187], v7, s[4:7], s56 offen offset:2048 sc1
    s_add_u32 s56, s56, 4096
    v_mfma_f32_16x16x32_bf16 v[28:31], v[76:79], v[188:191], v[28:31]
    v_mfma_f32_16x16x32_bf16 v[32:35], v[64:67], v[192:195], v[32:35]
    v_mfma_f32_16x16x32_bf16 v[36:39], v[68:71], v[192:195], v[36:39]
    v_mfma_f32_16x16x32_bf16 v[40:43], v[72:75], v[192:195], v[40:43]
    v_mfma_f32_16x16x32_bf16 v[44:47], v[76:79], v[192:195], v[44:47]
    v_mfma_f32_16x16x32_bf16 v[48:51], v[64:67], v[196:199], v[48:51]
    v_mfma_f32_16x16x32_bf16 v[52:55], v[68:71], v[196:199], v[52:55]
    v_mfma_f32_16x16x32_bf16 v[56:59], v[72:75], v[196:199], v[56:59]
    v_mfma_f32_16x16x32_bf16 v[60:63], v[76:79], v[196:199], v[60:63]
    s_waitcnt vmcnt(9)
    v_mfma_f32_16x16x32_bf16 v[16:19], v[80:83], v[200:203], v[16:19]
    buffer_load_dwordx4 v[188:191], v5, s[4:7], s56 offen offset:0 sc1
    v_mfma_f32_16x16x32_bf16 v[20:23], v[84:87], v[200:203], v[20:23]
    buffer_load_dwordx4 v[192:195], v6, s[4:7], s56 offen offset:0 sc1
    v_mfma_f32_16x16x32_bf16 v[24:27], v[88:91], v[200:203], v[24:27]
    buffer_load_dwordx4 v[196:199], v7, s[4:7], s56 offen offset:0 sc1
    v_mfma_f32_16x16x32_bf16 v[28:31], v[92:95], v[200:203], v[28:31]
    v_mfma_f32_16x16x32_bf16 v[32:35], v[80:83], v[204:207], v[32:35]
    v_mfma_f32_16x16x32_bf16 v[36:39], v[84:87], v[204:207], v[36:39]
    v_mfma_f32_16x16x32_bf16 v[40:43], v[88:91], v[204:207], v[40:43]
    v_mfma_f32_16x16x32_bf16 v[44:47], v[92:95], v[204:207], v[44:47]
    v_mfma_f32_16x16x32_bf16 v[48:51], v[80:83], v[208:211], v[48:51]
    v_mfma_f32_16x16x32_bf16 v[52:55], v[84:87], v[208:211], v[52:55]
    v_mfma_f32_16x16x32_bf16 v[56:59], v[88:91], v[208:211], v[56:59]
    v_mfma_f32_16x16x32_bf16 v[60:63], v[92:95], v[208:211], v[60:63]
    s_waitcnt vmcnt(9)
    s_waitcnt lgkmcnt(15)
    v_mfma_f32_16x16x32_bf16 v[16:19], v[96:99], v[212:215], v[16:19]
    v_mfma_f32_16x16x32_bf16 v[20:23], v[100:103], v[212:215], v[20:23]
    v_mfma_f32_16x16x32_bf16 v[24:27], v[104:107], v[212:215], v[24:27]
    v_mfma_f32_16x16x32_bf16 v[28:31], v[108:111], v[212:215], v[28:31]
    v_mfma_f32_16x16x32_bf16 v[32:35], v[96:99], v[216:219], v[32:35]
    v_mfma_f32_16x16x32_bf16 v[36:39], v[100:103], v[216:219], v[36:39]
    v_mfma_f32_16x16x32_bf16 v[40:43], v[104:107], v[216:219], v[40:43]
    v_mfma_f32_16x16x32_bf16 v[44:47], v[108:111], v[216:219], v[44:47]
    v_mfma_f32_16x16x32_bf16 v[48:51], v[96:99], v[220:223], v[48:51]
    v_mfma_f32_16x16x32_bf16 v[52:55], v[100:103], v[220:223], v[52:55]
    v_mfma_f32_16x16x32_bf16 v[56:59], v[104:107], v[220:223], v[56:59]
    v_mfma_f32_16x16x32_bf16 v[60:63], v[108:111], v[220:223], v[60:63]
    s_waitcnt vmcnt(6)
    v_mfma_f32_16x16x32_bf16 v[16:19], v[112:115], v[224:227], v[16:19]
    v_lshlrev_b32 v64, 16, v236
    v_and_b32 v65, 0xffff0000, v236
    v_mfma_f32_16x16x32_bf16 v[20:23], v[116:119], v[224:227], v[20:23]
    v_lshlrev_b32 v66, 16, v237
    v_and_b32 v67, 0xffff0000, v237
    v_mfma_f32_16x16x32_bf16 v[24:27], v[120:123], v[224:227], v[24:27]
    v_lshlrev_b32 v68, 16, v238
    v_and_b32 v69, 0xffff0000, v238
    v_mfma_f32_16x16x32_bf16 v[28:31], v[124:127], v[224:227], v[28:31]
    v_lshlrev_b32 v70, 16, v239
    v_and_b32 v71, 0xffff0000, v239
    v_mfma_f32_16x16x32_bf16 v[32:35], v[112:115], v[228:231], v[32:35]
    v_lshlrev_b32 v72, 16, v240
    v_and_b32 v73, 0xffff0000, v240
    v_mfma_f32_16x16x32_bf16 v[36:39], v[116:119], v[228:231], v[36:39]
    v_lshlrev_b32 v74, 16, v241
    v_and_b32 v75, 0xffff0000, v241
    v_mfma_f32_16x16x32_bf16 v[40:43], v[120:123], v[228:231], v[40:43]
    v_lshlrev_b32 v76, 16, v242
    v_and_b32 v77, 0xffff0000, v242
    v_mfma_f32_16x16x32_bf16 v[44:47], v[124:127], v[228:231], v[44:47]
    v_lshlrev_b32 v78, 16, v243
    v_and_b32 v79, 0xffff0000, v243
    v_mfma_f32_16x16x32_bf16 v[48:51], v[112:115], v[232:235], v[48:51]
    v_lshlrev_b32 v80, 16, v244
    v_and_b32 v81, 0xffff0000, v244
    v_mfma_f32_16x16x32_bf16 v[52:55], v[116:119], v[232:235], v[52:55]
    v_lshlrev_b32 v82, 16, v245
    v_and_b32 v83, 0xffff0000, v245
    v_mfma_f32_16x16x32_bf16 v[56:59], v[120:123], v[232:235], v[56:59]
    v_lshlrev_b32 v84, 16, v246
    v_and_b32 v85, 0xffff0000, v246
    v_mfma_f32_16x16x32_bf16 v[60:63], v[124:127], v[232:235], v[60:63]
    v_lshlrev_b32 v86, 16, v247
    v_and_b32 v87, 0xffff0000, v247
    s_waitcnt vmcnt(3)
    s_waitcnt lgkmcnt(8)
    v_mfma_f32_16x16x32_bf16 v[16:19], v[128:131], v[176:179], v[16:19]
    v_mfma_f32_16x16x32_bf16 v[20:23], v[132:135], v[176:179], v[20:23]
    v_mfma_f32_16x16x32_bf16 v[24:27], v[136:139], v[176:179], v[24:27]
    v_mfma_f32_16x16x32_bf16 v[28:31], v[140:143], v[176:179], v[28:31]
    v_mfma_f32_16x16x32_bf16 v[32:35], v[128:131], v[180:183], v[32:35]
    v_mfma_f32_16x16x32_bf16 v[36:39], v[132:135], v[180:183], v[36:39]
    v_mfma_f32_16x16x32_bf16 v[40:43], v[136:139], v[180:183], v[40:43]
    v_mfma_f32_16x16x32_bf16 v[44:47], v[140:143], v[180:183], v[44:47]
    v_mfma_f32_16x16x32_bf16 v[48:51], v[128:131], v[184:187], v[48:51]
    v_mfma_f32_16x16x32_bf16 v[52:55], v[132:135], v[184:187], v[52:55]
    v_mfma_f32_16x16x32_bf16 v[56:59], v[136:139], v[184:187], v[56:59]
    v_mfma_f32_16x16x32_bf16 v[60:63], v[140:143], v[184:187], v[60:63]
    s_waitcnt vmcnt(0)
    s_waitcnt lgkmcnt(0)
    v_mfma_f32_16x16x32_bf16 v[24:27], v[152:155], v[188:191], v[24:27]
    v_mfma_f32_16x16x32_bf16 v[28:31], v[156:159], v[188:191], v[28:31]
    v_mfma_f32_16x16x32_bf16 v[40:43], v[152:155], v[192:195], v[40:43]
    v_mfma_f32_16x16x32_bf16 v[44:47], v[156:159], v[192:195], v[44:47]
    v_mfma_f32_16x16x32_bf16 v[56:59], v[152:155], v[196:199], v[56:59]
    v_mfma_f32_16x16x32_bf16 v[60:63], v[156:159], v[196:199], v[60:63]
    v_mfma_f32_16x16x32_bf16 v[16:19], v[144:147], v[188:191], v[16:19]
    s_nop 1
    ds_write_b128 v8, v[24:27] offset:0
    v_mfma_f32_16x16x32_bf16 v[20:23], v[148:151], v[188:191], v[20:23]
    ds_write_b128 v8, v[28:31] offset:1024
    v_mfma_f32_16x16x32_bf16 v[32:35], v[144:147], v[192:195], v[32:35]
    ds_write_b128 v8, v[40:43] offset:2048
    v_mfma_f32_16x16x32_bf16 v[36:39], v[148:151], v[192:195], v[36:39]
    ds_write_b128 v8, v[44:47] offset:3072
    v_mfma_f32_16x16x32_bf16 v[48:51], v[144:147], v[196:199], v[48:51]
    ds_write_b128 v8, v[56:59] offset:4096
    v_mfma_f32_16x16x32_bf16 v[52:55], v[148:151], v[196:199], v[52:55]
    ds_write_b128 v8, v[60:63] offset:5120
    s_waitcnt lgkmcnt(0)
    s_barrier
    ds_read_b128 v[96:99], v15 offset:0
    ds_read_b128 v[100:103], v15 offset:1024
    ds_read_b128 v[104:107], v15 offset:2048
    ds_read_b128 v[108:111], v15 offset:3072
    ds_read_b128 v[112:115], v15 offset:4096
    ds_read_b128 v[116:119], v15 offset:5120
    v_pk_add_f32 v[64:65], v[64:65], v[16:17]
    v_pk_add_f32 v[66:67], v[66:67], v[18:19]
    v_pk_add_f32 v[68:69], v[68:69], v[20:21]
    v_pk_add_f32 v[70:71], v[70:71], v[22:23]
    v_pk_add_f32 v[72:73], v[72:73], v[32:33]
    v_pk_add_f32 v[74:75], v[74:75], v[34:35]
    v_pk_add_f32 v[76:77], v[76:77], v[36:37]
    v_pk_add_f32 v[78:79], v[78:79], v[38:39]
    v_pk_add_f32 v[80:81], v[80:81], v[48:49]
    v_pk_add_f32 v[82:83], v[82:83], v[50:51]
    v_pk_add_f32 v[84:85], v[84:85], v[52:53]
    v_pk_add_f32 v[86:87], v[86:87], v[54:55]
    s_waitcnt lgkmcnt(4)
    v_pk_add_f32 v[64:65], v[64:65], v[96:97]
    v_pk_add_f32 v[66:67], v[66:67], v[98:99]
    v_pk_add_f32 v[68:69], v[68:69], v[100:101]
    v_pk_add_f32 v[70:71], v[70:71], v[102:103]
    v_cvt_pk_bf16_f32 v128, v64, v65
    v_cvt_pk_bf16_f32 v130, v68, v69
    v_cvt_pk_bf16_f32 v129, v66, v67
    v_cvt_pk_bf16_f32 v131, v70, v71
    v_permlane16_swap_b32 v128, v130
    s_nop 0
    v_permlane16_swap_b32 v129, v131
    buffer_store_dwordx4 v[128:131], v9, s[32:35], 0 offen sc1
    v_add_u32 v9, 20480, v9
    s_waitcnt lgkmcnt(2)
    v_pk_add_f32 v[72:73], v[72:73], v[104:105]
    v_pk_add_f32 v[74:75], v[74:75], v[106:107]
    v_pk_add_f32 v[76:77], v[76:77], v[108:109]
    v_pk_add_f32 v[78:79], v[78:79], v[110:111]
    v_cvt_pk_bf16_f32 v132, v72, v73
    v_cvt_pk_bf16_f32 v134, v76, v77
    v_cvt_pk_bf16_f32 v133, v74, v75
    v_cvt_pk_bf16_f32 v135, v78, v79
    v_permlane16_swap_b32 v132, v134
    s_nop 0
    v_permlane16_swap_b32 v133, v135
    buffer_store_dwordx4 v[132:135], v9, s[32:35], 0 offen sc1
    v_add_u32 v9, 20480, v9
    s_waitcnt lgkmcnt(0)
    v_pk_add_f32 v[80:81], v[80:81], v[112:113]
    v_pk_add_f32 v[82:83], v[82:83], v[114:115]
    v_pk_add_f32 v[84:85], v[84:85], v[116:117]
    v_pk_add_f32 v[86:87], v[86:87], v[118:119]
    v_cvt_pk_bf16_f32 v136, v80, v81
    v_cvt_pk_bf16_f32 v138, v84, v85
    v_cvt_pk_bf16_f32 v137, v82, v83
    v_cvt_pk_bf16_f32 v139, v86, v87
    v_permlane16_swap_b32 v136, v138
    s_nop 0
    v_permlane16_swap_b32 v137, v139
    buffer_store_dwordx4 v[136:139], v9, s[32:35], 0 offen sc1
    s_endpgm
L_h345:
    s_bfe_u32 s64, s2, 0x20001
    s_add_u32 s67, s64, 108
    s_mul_i32 s64, s64, 27
    s_lshr_b32 s65, s2, 3
    s_add_u32 s66, s64, s65
    s_cmp_ge_u32 s2, 216
    s_cselect_b32 s66, s67, s66
    s_mul_i32 s64, s66, 13108
    s_lshr_b32 s64, s64, 16
    s_mul_i32 s65, s64, 5
    s_sub_u32 s67, s66, s65
    s_and_b32 s65, s2, 1
    s_mul_i32 s65, s65, 5
    s_add_u32 s65, s65, s67
    s_mul_i32 s46, s64, 10
    s_add_u32 s46, s46, s65
    s_lshl_b32 s46, s46, 7
    s_add_u32 s46, s46, 28
    s_mul_i32 s47, s64, 3
    s_add_u32 s48, s47, 2
    s_min_u32 s48, s48, 63
    s_lshr_b32 s47, s47, 2
    s_lshr_b32 s48, s48, 2
    s_cmp_eq_u32 s47, s48
    s_cselect_b32 s47, 16, 32
    s_cmp_ge_i32 s1, 0
    s_cbranch_scc1 L_p3_hskip
    s_cmp_lg_u32 s3, 5
    s_cbranch_scc1 L_p3_hskip
    v_mov_b32 v8, 0
    s_mov_b64 exec, 1
    v_mov_b32 v248, 0
    buffer_atomic_add v248, v8, s[4:7], s46 offen sc0 sc1
    s_sleep 3
    v_mov_b32 v249, 0
    buffer_atomic_add v249, v8, s[4:7], s46 offen sc0 sc1
    s_sleep 3
Lpoll_15:
    v_mov_b32 v250, 0
    buffer_atomic_add v250, v8, s[4:7], s46 offen sc0 sc1
    s_waitcnt vmcnt(2)
    v_cmp_ne_u32 vcc, s47, v248
    s_cbranch_vccz Lpoll_15d
    v_mov_b32 v248, 0
    buffer_atomic_add v248, v8, s[4:7], s46 offen sc0 sc1
    s_waitcnt vmcnt(2)
    v_cmp_ne_u32 vcc, s47, v249
    s_cbranch_vccz Lpoll_15d
    v_mov_b32 v249, 0
    buffer_atomic_add v249, v8, s[4:7], s46 offen sc0 sc1
    s_waitcnt vmcnt(2)
    v_cmp_ne_u32 vcc, s47, v250
    s_cbranch_vccz Lpoll_15d
    s_sub_u32 s96, s96, 1
    s_cbranch_scc0 Lpoll_15
    s_mov_b32 s96, 0
Lpoll_15d:
    s_mov_b64 exec, -1
L_p3_hskip:
    s_barrier
    s_bfe_u32 s64, s2, 0x20001
    s_add_u32 s67, s64, 108
    s_mul_i32 s64, s64, 27
    s_lshr_b32 s65, s2, 3
    s_add_u32 s66, s64, s65
    s_cmp_ge_u32 s2, 216
    s_cselect_b32 s66, s67, s66
    s_mul_i32 s64, s66, 13108
    s_lshr_b32 s64, s64, 16
    s_mul_i32 s65, s64, 5
    s_sub_u32 s67, s66, s65
    s_and_b32 s65, s2, 1
    s_mul_i32 s65, s65, 5
    s_add_u32 s65, s65, s67
    v_lshrrev_b32 v10, 3, v1
    v_mul_u32_u24 v103, 1280, v10
    v_and_b32 v10, 2, v10
    v_and_b32 v11, 7, v1
    v_xor_b32 v10, v10, v11
    v_lshl_add_u32 v103, v10, 4, v103
    v_xor_b32 v104, 64, v103
    v_add_u32 v104, 9216, v104
    s_mul_i32 s68, s64, 331776
    s_add_u32 s68, s68, 16773120
    s_mul_i32 s69, s97, 20480
    s_lshl_b32 s70, s65, 7
    s_add_u32 s69, s69, s70
    s_mul_i32 s70, s97, 3072
    s_lshl_b32 s71, s97, 11
    s_mul_i32 s72, s64, 10
    s_add_u32 s72, s72, s65
    s_lshl_b32 s72, s72, 7
    s_add_u32 s72, s72, 16
    s_cmp_ge_i32 s1, 0
    s_cselect_b32 s69, 1073741816, s69
    s_mul_i32 s73, s64, 28089
    s_add_u32 s74, s73, 18726
    s_lshr_b32 s73, s73, 16
    s_lshr_b32 s74, s74, 16
    s_cmp_eq_u32 s73, s74
    s_cselect_b32 s73, 27, 54
    s_cmp_ge_i32 s1, 0
    s_cbranch_scc1 L_idle
    s_mul_i32 s50, s64, 28089
    s_lshr_b32 s50, s50, 16
    s_mul_i32 s50, s50, 27
    v_add_u32 v247, s50, v1
    s_cmp_eq_u32 s64, 21
    s_cselect_b32 s50, 13, s73
    v_cmp_gt_u32 vcc, s50, v1
    s_lshl_b32 s60, 0x11111111, s97
    s_mov_b32 s61, s60
    s_and_b64 s[60:61], s[60:61], vcc
    v_lshlrev_b32 v247, 7, v247
    s_cmp_eq_u32 s3, 4
    s_cselect_b64 s[62:63], vcc, 0
    s_lshl_b32 s50, s97, 8
    v_lshl_add_u32 v12, v1, 2, s50
    v_add_u32 v13, 155648, v12
    s_lshl_b32 s54, s65, 15
    s_mul_i32 s55, s64, 768
    s_add_u32 s54, s54, s55
    s_add_u32 s54, s54, 196608
    s_cmp_eq_u32 s97, 3
    s_cselect_b32 s54, 1073741816, s54
    s_and_b32 s40, s2, 7
    s_min_u32 s41, s40, 3
    s_mul_i32 s40, s40, 30
    s_add_u32 s40, s40, s41
    s_lshr_b32 s41, s2, 3
    s_add_u32 s40, s40, s41
    s_mul_i32 s41, s40, 1041
    s_lshr_b32 s41, s41, 16
    s_mul_i32 s42, s41, 63
    s_sub_u32 s40, s40, s42
    s_cmp_eq_u32 s41, 3
    s_cselect_b32 s42, 6, 7
    s_mov_b32 s43, 9363
    s_cselect_b32 s43, 10923, s43
    s_mul_i32 s41, s41, 7
    s_add_u32 s41, s41, s40
    s_mul_i32 s40, s40, s43
    s_lshr_b32 s40, s40, 16
    s_mul_i32 s42, s42, s40
    s_sub_u32 s41, s41, s42
    v_lshrrev_b32 v10, 3, v1
    v_mul_u32_u24 v3, 3456, v10
    v_and_b32 v10, 2, v10
    v_and_b32 v11, 7, v1
    v_xor_b32 v10, v10, v11
    v_lshl_add_u32 v3, v10, 4, v3
    v_xor_b32 v4, 64, v3
    v_add_u32 v4, 26624, v4
    v_lshlrev_b32 v2, 4, v1
    v_add_u32 v5, 18432, v2
    s_lshr_b32 s42, s97, 1
    s_and_b32 s43, s97, 1
    s_lshl_b32 s43, s43, 10
    s_lshl_b32 s44, s40, 1
    s_add_u32 s44, s44, s42
    s_mul_i32 s44, s44, 143360
    s_add_u32 s44, s44, s43
    s_add_u32 s44, s44, 12582912
    s_mul_i32 s47, s42, 14336
    s_add_u32 s47, s47, s43
    s_mul_i32 s45, s97, 55296
    s_lshl_b32 s46, s41, 7
    s_add_u32 s45, s45, s46
    s_lshl_b32 s46, s97, 11
    s_lshl_b32 s43, s97, 10
    s_mul_i32 s50, s40, 27
    s_add_u32 s50, s50, s41
    s_lshl_b32 s50, s50, 7
    s_add_u32 s51, s50, 12
    s_add_u32 s50, s50, 20
    s_mov_b32 s56, 30
    s_barrier
    s_waitcnt vmcnt(0)
    s_barrier
    s_cmp_eq_u64 s[62:63], 0
    s_cbranch_scc1 Lfin_16
    v_mov_b32 v246, 1
    s_mov_b64 exec, s[62:63]
    buffer_atomic_add v246, v247, s[4:7], 0 offen offset:12 sc1
    s_mov_b64 exec, -1
Lfin_16:
L_p4_h_in:
    s_add_u32 s58, s45, 0
    s_add_u32 m0, s46, 28672
    s_nop 0
    buffer_load_dwordx4 v3, s[20:23], s58 offen offset:0 lds
    buffer_load_dwordx4 v4, s[20:23], s58 offen offset:1024 lds
    s_add_u32 m0, s46, 36864
    s_nop 0
    buffer_load_dwordx4 v3, s[24:27], s58 offen offset:0 lds
    buffer_load_dwordx4 v4, s[24:27], s58 offen offset:1024 lds
    s_add_u32 s58, s45, 221184
    s_add_u32 m0, s46, 73728
    s_nop 0
    buffer_load_dwordx4 v3, s[20:23], s58 offen offset:0 lds
    buffer_load_dwordx4 v4, s[20:23], s58 offen offset:1024 lds
    s_add_u32 m0, s46, 81920
    s_nop 0
    buffer_load_dwordx4 v3, s[24:27], s58 offen offset:0 lds
    buffer_load_dwordx4 v4, s[24:27], s58 offen offset:1024 lds
    s_add_u32 s58, s45, 442368
    s_add_u32 m0, s46, 118784
    s_nop 0
    buffer_load_dwordx4 v3, s[20:23], s58 offen offset:0 lds
    buffer_load_dwordx4 v4, s[20:23], s58 offen offset:1024 lds
    s_add_u32 m0, s46, 126976
    s_nop 0
    buffer_load_dwordx4 v3, s[24:27], s58 offen offset:0 lds
    buffer_load_dwordx4 v4, s[24:27], s58 offen offset:1024 lds
    s_cmp_lg_u32 s3, 5
    s_cbranch_scc1 Lp1_17
    v_mov_b32 v8, 0
    s_mov_b64 exec, 1
    v_mov_b32 v248, 0
    buffer_atomic_add v248, v8, s[4:7], s51 offen sc0 sc1
    s_sleep 3
    v_mov_b32 v249, 0
    buffer_atomic_add v249, v8, s[4:7], s51 offen sc0 sc1
    s_sleep 3
Lpoll_18:
    v_mov_b32 v250, 0
    buffer_atomic_add v250, v8, s[4:7], s51 offen sc0 sc1
    s_waitcnt vmcnt(2)
    v_cmp_ne_u32 vcc, s56, v248
    s_cbranch_vccz Lpoll_18d
    v_mov_b32 v248, 0
    buffer_atomic_add v248, v8, s[4:7], s51 offen sc0 sc1
    s_waitcnt vmcnt(2)
    v_cmp_ne_u32 vcc, s56, v249
    s_cbranch_vccz Lpoll_18d
    v_mov_b32 v249, 0
    buffer_atomic_add v249, v8, s[4:7], s51 offen sc0 sc1
    s_waitcnt vmcnt(2)
    v_cmp_ne_u32 vcc, s56, v250
    s_cbranch_vccz Lpoll_18d
    s_sub_u32 s96, s96, 1
    s_cbranch_scc0 Lpoll_18
    s_mov_b32 s96, 0
Lpoll_18d:
    s_mov_b64 exec, -1
Lp1_17:
    s_barrier
    v_mov_b32 v8, 0
    s_add_u32 m0, s47, 0
    s_add_u32 s59, s44, 0
    buffer_load_dwordx4 v2, s[4:7], s59 offen offset:0 sc1 lds
    buffer_load_dwordx4 v5, s[4:7], s59 offen offset:2048 sc1 lds
    s_add_u32 m0, s47, 4096
    s_add_u32 s59, s44, 40960
    buffer_load_dwordx4 v2, s[4:7], s59 offen offset:0 sc1 lds
    buffer_load_dwordx4 v5, s[4:7], s59 offen offset:2048 sc1 lds
    s_add_u32 m0, s47, 8192
    s_add_u32 s59, s44, 81920
    buffer_load_dwordx4 v2, s[4:7], s59 offen offset:0 sc1 lds
    buffer_load_dwordx4 v5, s[4:7], s59 offen offset:2048 sc1 lds
    s_add_u32 m0, s47, 12288
    s_add_u32 s59, s44, 122880
    buffer_load_dwordx4 v2, s[4:7], s59 offen offset:0 sc1 lds
    s_add_u32 m0, s47, 45056
    s_add_u32 s59, s44, 2048
    buffer_load_dwordx4 v2, s[4:7], s59 offen offset:0 sc1 lds
    buffer_load_dwordx4 v5, s[4:7], s59 offen offset:2048 sc1 lds
    s_add_u32 m0, s47, 49152
    s_add_u32 s59, s44, 43008
    buffer_load_dwordx4 v2, s[4:7], s59 offen offset:0 sc1 lds
    buffer_load_dwordx4 v5, s[4:7], s59 offen offset:2048 sc1 lds
    s_add_u32 m0, s47, 53248
    s_add_u32 s59, s44, 83968
    buffer_load_dwordx4 v2, s[4:7], s59 offen offset:0 sc1 lds
    buffer_load_dwordx4 v5, s[4:7], s59 offen offset:2048 sc1 lds
    s_add_u32 m0, s47, 57344
    s_add_u32 s59, s44, 124928
    buffer_load_dwordx4 v2, s[4:7], s59 offen offset:0 sc1 lds
    v_lshlrev_b32 v9, 2, v1
    s_mul_i32 s48, s40, 1792
    s_lshl_b32 s49, s97, 9
    s_add_u32 s48, s48, s49
    s_add_u32 s48, s48, 196608
    v_lshrrev_b32 v16, 5, v1
    v_and_b32 v17, 31, v1
    v_lshlrev_b32 v7, 15, v16
    v_lshl_add_u32 v7, v17, 4, v7
    v_lshl_add_u32 v18, v17, 1, v16
    v_lshrrev_b32 v16, 4, v1
    v_mul_u32_u24 v9, 13824, v16
    v_and_b32 v19, 15, v1
    v_lshl_add_u32 v9, v19, 4, v9
    s_and_b32 s52, s97, 1
    s_mul_i32 s49, s52, 6912
    s_lshl_b32 s53, s41, 8
    s_add_u32 s49, s49, s53
    s_add_u32 s49, s49, 114688
    s_add_u32 s56, s56, 8
    s_waitcnt vmcnt(11)
    s_barrier
    s_waitcnt vmcnt(7)
    s_barrier
    ds_read_b32 v14, v13
    ds_read_b32 v15, v13 offset:768
    s_waitcnt lgkmcnt(0)
    v_add_f32 v14, v14, v15
    buffer_store_dword v14, v12, s[4:7], s54 offen sc1
    s_add_u32 m0, s47, 90112
    s_add_u32 s59, s44, 4096
    buffer_load_dwordx4 v2, s[4:7], s59 offen offset:0 sc1 lds
    buffer_load_dwordx4 v5, s[4:7], s59 offen offset:2048 sc1 lds
    s_add_u32 m0, s47, 94208
    s_add_u32 s59, s44, 45056
    buffer_load_dwordx4 v2, s[4:7], s59 offen offset:0 sc1 lds
    buffer_load_dwordx4 v5, s[4:7], s59 offen offset:2048 sc1 lds
    s_add_u32 m0, s47, 98304
    s_add_u32 s59, s44, 86016
    buffer_load_dwordx4 v2, s[4:7], s59 offen offset:0 sc1 lds
    buffer_load_dwordx4 v5, s[4:7], s59 offen offset:2048 sc1 lds
    s_add_u32 m0, s47, 102400
    s_add_u32 s59, s44, 126976
    buffer_load_dwordx4 v2, s[4:7], s59 offen offset:0 sc1 lds
    s_waitcnt vmcnt(8)
    s_barrier
    s_add_u32 m0, s47, 0
    s_add_u32 s59, s44, 6144
    buffer_load_dwordx4 v2, s[4:7], s59 offen offset:0 sc1 lds
    buffer_load_dwordx4 v5, s[4:7], s59 offen offset:2048 sc1 lds
    s_add_u32 m0, s47, 4096
    s_add_u32 s59, s44, 47104
    buffer_load_dwordx4 v2, s[4:7], s59 offen offset:0 sc1 lds
    buffer_load_dwordx4 v5, s[4:7], s59 offen offset:2048 sc1 lds
    s_add_u32 m0, s47, 8192
    s_add_u32 s59, s44, 88064
    buffer_load_dwordx4 v2, s[4:7], s59 offen offset:0 sc1 lds
    buffer_load_dwordx4 v5, s[4:7], s59 offen offset:2048 sc1 lds
    s_add_u32 m0, s47, 12288
    s_add_u32 s59, s44, 129024
    buffer_load_dwordx4 v2, s[4:7], s59 offen offset:0 sc1 lds
    s_add_u32 s58, s45, 663552
    s_add_u32 m0, s46, 28672
    s_nop 0
    buffer_load_dwordx4 v3, s[20:23], s58 offen offset:0 lds
    buffer_load_dwordx4 v4, s[20:23], s58 offen offset:1024 lds
    s_add_u32 m0, s46, 36864
    s_nop 0
    buffer_load_dwordx4 v3, s[24:27], s58 offen offset:0 lds
    buffer_load_dwordx4 v4, s[24:27], s58 offen offset:1024 lds
    s_waitcnt vmcnt(11)
    s_barrier
    s_add_u32 m0, s47, 45056
    s_add_u32 s59, s44, 8192
    buffer_load_dwordx4 v2, s[4:7], s59 offen offset:0 sc1 lds
    buffer_load_dwordx4 v5, s[4:7], s59 offen offset:2048 sc1 lds
    s_add_u32 m0, s47, 49152
    s_add_u32 s59, s44, 49152
    buffer_load_dwordx4 v2, s[4:7], s59 offen offset:0 sc1 lds
    buffer_load_dwordx4 v5, s[4:7], s59 offen offset:2048 sc1 lds
    s_add_u32 m0, s47, 53248
    s_add_u32 s59, s44, 90112
    buffer_load_dwordx4 v2, s[4:7], s59 offen offset:0 sc1 lds
    buffer_load_dwordx4 v5, s[4:7], s59 offen offset:2048 sc1 lds
    s_add_u32 m0, s47, 57344
    s_add_u32 s59, s44, 131072
    buffer_load_dwordx4 v2, s[4:7], s59 offen offset:0 sc1 lds
    s_add_u32 s58, s45, 884736
    s_add_u32 m0, s46, 73728
    s_nop 0
    buffer_load_dwordx4 v3, s[20:23], s58 offen offset:0 lds
    buffer_load_dwordx4 v4, s[20:23], s58 offen offset:1024 lds
    s_add_u32 m0, s46, 81920
    s_nop 0
    buffer_load_dwordx4 v3, s[24:27], s58 offen offset:0 lds
    buffer_load_dwordx4 v4, s[24:27], s58 offen offset:1024 lds
    v_mov_b32 v246, 1
    s_mov_b64 exec, s[60:61]
    buffer_atomic_add v246, v247, s[4:7], 0 offen offset:20 sc1
    s_mov_b64 exec, -1
    s_waitcnt vmcnt(12)
    s_barrier
    s_add_u32 m0, s47, 90112
    s_add_u32 s59, s44, 10240
    buffer_load_dwordx4 v2, s[4:7], s59 offen offset:0 sc1 lds
    buffer_load_dwordx4 v5, s[4:7], s59 offen offset:2048 sc1 lds
    s_add_u32 m0, s47, 94208
    s_add_u32 s59, s44, 51200
    buffer_load_dwordx4 v2, s[4:7], s59 offen offset:0 sc1 lds
    buffer_load_dwordx4 v5, s[4:7], s59 offen offset:2048 sc1 lds
    s_add_u32 m0, s47, 98304
    s_add_u32 s59, s44, 92160
    buffer_load_dwordx4 v2, s[4:7], s59 offen offset:0 sc1 lds
    buffer_load_dwordx4 v5, s[4:7], s59 offen offset:2048 sc1 lds
    s_add_u32 m0, s47, 102400
    s_add_u32 s59, s44, 133120
    buffer_load_dwordx4 v2, s[4:7], s59 offen offset:0 sc1 lds
    s_add_u32 s58, s45, 1105920
    s_add_u32 m0, s46, 118784
    s_nop 0
    buffer_load_dwordx4 v3, s[20:23], s58 offen offset:0 lds
    buffer_load_dwordx4 v4, s[20:23], s58 offen offset:1024 lds
    s_add_u32 m0, s46, 126976
    s_nop 0
    buffer_load_dwordx4 v3, s[24:27], s58 offen offset:0 lds
    buffer_load_dwordx4 v4, s[24:27], s58 offen offset:1024 lds
    s_waitcnt vmcnt(12)
    s_barrier
    s_add_u32 m0, s47, 0
    s_add_u32 s59, s44, 12288
    buffer_load_dwordx4 v2, s[4:7], s59 offen offset:0 sc1 lds
    buffer_load_dwordx4 v5, s[4:7], s59 offen offset:2048 sc1 lds
    s_add_u32 m0, s47, 4096
    s_add_u32 s59, s44, 53248
    buffer_load_dwordx4 v2, s[4:7], s59 offen offset:0 sc1 lds
    buffer_load_dwordx4 v5, s[4:7], s59 offen offset:2048 sc1 lds
    s_add_u32 m0, s47, 8192
    s_add_u32 s59, s44, 94208
    buffer_load_dwordx4 v2, s[4:7], s59 offen offset:0 sc1 lds
    buffer_load_dwordx4 v5, s[4:7], s59 offen offset:2048 sc1 lds
    s_add_u32 m0, s47, 12288
    s_add_u32 s59, s44, 135168
    buffer_load_dwordx4 v2, s[4:7], s59 offen offset:0 sc1 lds
    s_add_u32 s58, s45, 1327104
    s_add_u32 m0, s46, 28672
    s_nop 0
    buffer_load_dwordx4 v3, s[20:23], s58 offen offset:0 lds
    buffer_load_dwordx4 v4, s[20:23], s58 offen offset:1024 lds
    s_add_u32 m0, s46, 36864
    s_nop 0
    buffer_load_dwordx4 v3, s[24:27], s58 offen offset:0 lds
    buffer_load_dwordx4 v4, s[24:27], s58 offen offset:1024 lds
    buffer_load_dword v36, v8, s[4:7], s50 offen sc1
    s_waitcnt vmcnt(12)
    s_barrier
    s_add_u32 m0, s47, 45056
    s_add_u32 s59, s44, 14336
    buffer_load_dwordx4 v2, s[4:7], s59 offen offset:0 sc1 lds
    buffer_load_dwordx4 v5, s[4:7], s59 offen offset:2048 sc1 lds
    s_add_u32 m0, s47, 49152
    s_add_u32 s59, s44, 55296
    buffer_load_dwordx4 v2, s[4:7], s59 offen offset:0 sc1 lds
    buffer_load_dwordx4 v5, s[4:7], s59 offen offset:2048 sc1 lds
    s_add_u32 m0, s47, 53248
    s_add_u32 s59, s44, 96256
    buffer_load_dwordx4 v2, s[4:7], s59 offen offset:0 sc1 lds
    buffer_load_dwordx4 v5, s[4:7], s59 offen offset:2048 sc1 lds
    s_add_u32 m0, s47, 57344
    s_add_u32 s59, s44, 137216
    buffer_load_dwordx4 v2, s[4:7], s59 offen offset:0 sc1 lds
    s_add_u32 s58, s45, 1548288
    s_add_u32 m0, s46, 73728
    s_nop 0
    buffer_load_dwordx4 v3, s[20:23], s58 offen offset:0 lds
    buffer_load_dwordx4 v4, s[20:23], s58 offen offset:1024 lds
    s_add_u32 m0, s46, 81920
    s_nop 0
    buffer_load_dwordx4 v3, s[24:27], s58 offen offset:0 lds
    buffer_load_dwordx4 v4, s[24:27], s58 offen offset:1024 lds
    s_waitcnt vmcnt(11)
    v_cmp_ne_u32 vcc, s56, v36
    s_cbranch_vccz L_p4_csok
    v_mov_b32 v8, 0
Lpoll_19:
    buffer_load_dword v36, v8, s[4:7], s50 offen sc1
    s_waitcnt vmcnt(0)
    v_cmp_ne_u32 vcc, s56, v36
    s_cbranch_vccz Lpoll_19d
    s_sleep 1
    s_sub_u32 s96, s96, 1
    s_cbranch_scc0 Lpoll_19
    s_mov_b32 s96, 0
Lpoll_19d:
L_p4_csok:
    buffer_load_dwordx4 v[40:43], v7, s[4:7], s48 offen sc1
    s_add_u32 s48, s48, 65536
    buffer_load_dwordx4 v[44:47], v7, s[4:7], s48 offen sc1
    s_add_u32 s48, s48, 65536
    buffer_load_dwordx4 v[48:51], v7, s[4:7], s48 offen sc1
    s_add_u32 s48, s48, 65536
    s_waitcnt vmcnt(15)
    s_barrier
    s_add_u32 m0, s47, 90112
    s_add_u32 s59, s44, 16384
    buffer_load_dwordx4 v2, s[4:7], s59 offen offset:0 sc1 lds
    buffer_load_dwordx4 v5, s[4:7], s59 offen offset:2048 sc1 lds
    s_add_u32 m0, s47, 94208
    s_add_u32 s59, s44, 57344
    buffer_load_dwordx4 v2, s[4:7], s59 offen offset:0 sc1 lds
    buffer_load_dwordx4 v5, s[4:7], s59 offen offset:2048 sc1 lds
    s_add_u32 m0, s47, 98304
    s_add_u32 s59, s44, 98304
    buffer_load_dwordx4 v2, s[4:7], s59 offen offset:0 sc1 lds
    buffer_load_dwordx4 v5, s[4:7], s59 offen offset:2048 sc1 lds
    s_add_u32 m0, s47, 102400
    s_add_u32 s59, s44, 139264
    buffer_load_dwordx4 v2, s[4:7], s59 offen offset:0 sc1 lds
    s_add_u32 s58, s45, 1769472
    s_add_u32 m0, s46, 118784
    s_nop 0
    buffer_load_dwordx4 v3, s[20:23], s58 offen offset:0 lds
    buffer_load_dwordx4 v4, s[20:23], s58 offen offset:1024 lds
    s_add_u32 m0, s46, 126976
    s_nop 0
    buffer_load_dwordx4 v3, s[24:27], s58 offen offset:0 lds
    buffer_load_dwordx4 v4, s[24:27], s58 offen offset:1024 lds
    buffer_load_dwordx4 v[52:55], v7, s[4:7], s48 offen sc1
    s_add_u32 s48, s48, 65536
    buffer_load_dwordx4 v[56:59], v7, s[4:7], s48 offen sc1
    s_add_u32 s48, s48, 65536
    buffer_load_dwordx4 v[32:35], v9, s[4:7], s49 offen sc1
    s_waitcnt vmcnt(17)
    s_barrier
    s_add_u32 m0, s47, 0
    s_add_u32 s59, s44, 18432
    buffer_load_dwordx4 v2, s[4:7], s59 offen offset:0 sc1 lds
    buffer_load_dwordx4 v5, s[4:7], s59 offen offset:2048 sc1 lds
    s_add_u32 m0, s47, 4096
    s_add_u32 s59, s44, 59392
    buffer_load_dwordx4 v2, s[4:7], s59 offen offset:0 sc1 lds
    buffer_load_dwordx4 v5, s[4:7], s59 offen offset:2048 sc1 lds
    s_add_u32 m0, s47, 8192
    s_add_u32 s59, s44, 100352
    buffer_load_dwordx4 v2, s[4:7], s59 offen offset:0 sc1 lds
    buffer_load_dwordx4 v5, s[4:7], s59 offen offset:2048 sc1 lds
    s_add_u32 m0, s47, 12288
    s_add_u32 s59, s44, 141312
    buffer_load_dwordx4 v2, s[4:7], s59 offen offset:0 sc1 lds
    s_add_u32 s58, s45, 1990656
    s_add_u32 m0, s46, 28672
    s_nop 0
    buffer_load_dwordx4 v3, s[20:23], s58 offen offset:0 lds
    buffer_load_dwordx4 v4, s[20:23], s58 offen offset:1024 lds
    s_add_u32 m0, s46, 36864
    s_nop 0
    buffer_load_dwordx4 v3, s[24:27], s58 offen offset:0 lds
    buffer_load_dwordx4 v4, s[24:27], s58 offen offset:1024 lds
    s_add_u32 s76, s69, 0
    s_add_u32 m0, s71, 147456
    s_nop 0
    buffer_load_dwordx4 v103, s[28:31], s76 offen offset:0 lds
    buffer_load_dwordx4 v104, s[28:31], s76 offen offset:1024 lds
    s_add_u32 s76, s69, 81920
    s_add_u32 m0, s71, 155648
    s_nop 0
    buffer_load_dwordx4 v103, s[28:31], s76 offen offset:0 lds
    buffer_load_dwordx4 v104, s[28:31], s76 offen offset:1024 lds
    s_waitcnt vmcnt(18)
    s_barrier
    s_waitcnt vmcnt(15)
    v_add_f32 v40, v40, v44
    v_add_f32 v41, v41, v45
    v_add_f32 v42, v42, v46
    v_add_f32 v43, v43, v47
    v_add_f32 v40, v40, v48
    v_add_f32 v41, v41, v49
    v_add_f32 v42, v42, v50
    v_add_f32 v43, v43, v51
    v_add_f32 v40, v40, v52
    v_add_f32 v41, v41, v53
    v_add_f32 v42, v42, v54
    v_add_f32 v43, v43, v55
    v_add_f32 v40, v40, v56
    v_add_f32 v41, v41, v57
    v_add_f32 v42, v42, v58
    v_add_f32 v43, v43, v59
    s_nop 0
    v_permlane32_swap_b32 v40, v42
    v_permlane32_swap_b32 v41, v43
    v_permlane32_swap_b32 v32, v34
    v_permlane32_swap_b32 v33, v35
    v_add_f32 v16, v40, v42
    v_add_f32 v17, v41, v43
    v_add_f32 v32, v32, v34
    v_add_f32 v33, v33, v35
    v_mov_b32 v20, 0x3acccccd
    v_mul_f32 v12, v16, v20
    v_permlane16_swap_b32 v32, v33
    v_mul_f32 v17, v17, v20
    v_fma_f32 v17, -v12, v12, v17
    v_max_f32 v17, 0, v17
    v_add_f32 v17, 0x3727c5ac, v17
    v_rsq_f32 v13, v17
    v_sqrt_f32 v14, v17
    v_add_f32 v32, v32, v33
    v_mov_b32 v15, 0
    v_mul_f32 v13, 0xbfb8aa3b, v13
    s_lshl_b32 s52, s52, 8
    s_add_u32 s52, s52, 139264
    v_lshrrev_b32 v16, 4, v1
    v_lshl_add_u32 v10, v19, 2, v16
    v_lshl_add_u32 v10, v10, 2, s52
    s_add_u32 s52, s43, 135168
    v_lshl_add_u32 v11, v18, 4, s52
    s_add_u32 s76, s69, 163840
    s_add_u32 m0, s71, 49152
    s_nop 0
    buffer_load_dwordx4 v103, s[28:31], s76 offen offset:0 lds
    buffer_load_dwordx4 v104, s[28:31], s76 offen offset:1024 lds
    s_add_u32 s76, s69, 245760
    s_add_u32 m0, s71, 57344
    s_nop 0
    buffer_load_dwordx4 v103, s[28:31], s76 offen offset:0 lds
    buffer_load_dwordx4 v104, s[28:31], s76 offen offset:1024 lds
    s_add_u32 s76, s69, 327680
    s_add_u32 m0, s71, 65536
    s_nop 0
    buffer_load_dwordx4 v103, s[28:31], s76 offen offset:0 lds
    buffer_load_dwordx4 v104, s[28:31], s76 offen offset:1024 lds
    s_add_u32 s76, s69, 409600
    s_add_u32 m0, s71, 73728
    s_nop 0
    buffer_load_dwordx4 v103, s[28:31], s76 offen offset:0 lds
    buffer_load_dwordx4 v104, s[28:31], s76 offen offset:1024 lds
    s_add_u32 s76, s69, 491520
    s_add_u32 m0, s71, 81920
    s_nop 0
    buffer_load_dwordx4 v103, s[28:31], s76 offen offset:0 lds
    buffer_load_dwordx4 v104, s[28:31], s76 offen offset:1024 lds
    s_waitcnt vmcnt(14)
    s_barrier
    ds_write_b32 v10, v32
    ds_write_b128 v11, v[12:15]
    s_add_u32 s76, s69, 573440
    s_add_u32 m0, s71, 90112
    s_nop 0
    buffer_load_dwordx4 v103, s[28:31], s76 offen offset:0 lds
    buffer_load_dwordx4 v104, s[28:31], s76 offen offset:1024 lds
    s_add_u32 s76, s69, 655360
    s_add_u32 m0, s71, 98304
    s_nop 0
    buffer_load_dwordx4 v103, s[28:31], s76 offen offset:0 lds
    buffer_load_dwordx4 v104, s[28:31], s76 offen offset:1024 lds
    s_add_u32 s76, s69, 737280
    s_add_u32 m0, s71, 106496
    s_nop 0
    buffer_load_dwordx4 v103, s[28:31], s76 offen offset:0 lds
    buffer_load_dwordx4 v104, s[28:31], s76 offen offset:1024 lds
    s_add_u32 s76, s69, 819200
    s_add_u32 m0, s71, 114688
    s_nop 0
    buffer_load_dwordx4 v103, s[28:31], s76 offen offset:0 lds
    buffer_load_dwordx4 v104, s[28:31], s76 offen offset:1024 lds
    s_waitcnt lgkmcnt(0)
    s_barrier
L_p5_h_pre:
    s_add_u32 s76, s69, 901120
    s_add_u32 m0, s71, 122880
    s_nop 0
    buffer_load_dwordx4 v103, s[28:31], s76 offen offset:0 lds
    buffer_load_dwordx4 v104, s[28:31], s76 offen offset:1024 lds
    s_add_u32 s76, s69, 983040
    s_add_u32 m0, s71, 0
    s_nop 0
    buffer_load_dwordx4 v103, s[28:31], s76 offen offset:0 lds
    buffer_load_dwordx4 v104, s[28:31], s76 offen offset:1024 lds
    s_add_u32 s76, s69, 1064960
    s_add_u32 m0, s71, 8192
    s_nop 0
    buffer_load_dwordx4 v103, s[28:31], s76 offen offset:0 lds
    buffer_load_dwordx4 v104, s[28:31], s76 offen offset:1024 lds
    s_add_u32 s76, s69, 1146880
    s_add_u32 m0, s71, 16384
    s_nop 0
    buffer_load_dwordx4 v103, s[28:31], s76 offen offset:0 lds
    buffer_load_dwordx4 v104, s[28:31], s76 offen offset:1024 lds
    s_add_u32 s76, s69, 1228800
    s_add_u32 m0, s71, 24576
    s_nop 0
    buffer_load_dwordx4 v103, s[28:31], s76 offen offset:0 lds
    buffer_load_dwordx4 v104, s[28:31], s76 offen offset:1024 lds
    s_add_u32 s76, s69, 1310720
    s_add_u32 m0, s71, 32768
    s_nop 0
    buffer_load_dwordx4 v103, s[28:31], s76 offen offset:0 lds
    buffer_load_dwordx4 v104, s[28:31], s76 offen offset:1024 lds
    s_add_u32 s76, s69, 1392640
    s_add_u32 m0, s71, 40960
    s_nop 0
    buffer_load_dwordx4 v103, s[28:31], s76 offen offset:0 lds
    buffer_load_dwordx4 v104, s[28:31], s76 offen offset:1024 lds
    s_waitcnt vmcnt(10)
    s_barrier
    s_cmp_ge_i32 s1, 0
    s_cbranch_scc1 L_end
    s_add_u32 s76, s69, 1474560
    s_add_u32 m0, s71, 131072
    s_nop 0
    buffer_load_dwordx4 v103, s[28:31], s76 offen offset:0 lds
    buffer_load_dwordx4 v104, s[28:31], s76 offen offset:1024 lds
    s_add_u32 s76, s69, 1556480
    s_add_u32 m0, s71, 139264
    s_nop 0
    buffer_load_dwordx4 v103, s[28:31], s76 offen offset:0 lds
    buffer_load_dwordx4 v104, s[28:31], s76 offen offset:1024 lds
    s_barrier
    s_add_u32 s76, s69, 1638400
    s_add_u32 m0, s71, 147456
    s_nop 0
    buffer_load_dwordx4 v103, s[28:31], s76 offen offset:0 lds
    buffer_load_dwordx4 v104, s[28:31], s76 offen offset:1024 lds
    s_add_u32 s76, s69, 1720320
    s_add_u32 m0, s71, 155648
    s_nop 0
    buffer_load_dwordx4 v103, s[28:31], s76 offen offset:0 lds
    buffer_load_dwordx4 v104, s[28:31], s76 offen offset:1024 lds
    s_add_u32 s76, s69, 1802240
    s_add_u32 m0, s71, 49152
    s_nop 0
    buffer_load_dwordx4 v103, s[28:31], s76 offen offset:0 lds
    buffer_load_dwordx4 v104, s[28:31], s76 offen offset:1024 lds
    s_add_u32 s76, s69, 1884160
    s_add_u32 m0, s71, 57344
    s_nop 0
    buffer_load_dwordx4 v103, s[28:31], s76 offen offset:0 lds
    buffer_load_dwordx4 v104, s[28:31], s76 offen offset:1024 lds
    s_add_u32 s76, s69, 1966080
    s_add_u32 m0, s71, 65536
    s_nop 0
    buffer_load_dwordx4 v103, s[28:31], s76 offen offset:0 lds
    buffer_load_dwordx4 v104, s[28:31], s76 offen offset:1024 lds
    s_add_u32 s76, s69, 2048000
    s_add_u32 m0, s71, 73728
    s_nop 0
    buffer_load_dwordx4 v103, s[28:31], s76 offen offset:0 lds
    buffer_load_dwordx4 v104, s[28:31], s76 offen offset:1024 lds
    s_add_u32 s76, s69, 2129920
    s_add_u32 m0, s71, 81920
    s_nop 0
    buffer_load_dwordx4 v103, s[28:31], s76 offen offset:0 lds
    buffer_load_dwordx4 v104, s[28:31], s76 offen offset:1024 lds
    s_barrier
    s_waitcnt vmcnt(14)
    s_barrier
    s_waitcnt vmcnt(0)
    s_barrier
L_end:
    s_endpgm
L_spare:
    v_lshlrev_b32 v2, 7, v1
    s_lshl_b32 s50, s3, 4
    s_add_u32 s50, s50, s2
    s_lshl_b32 s50, s50, 13
    s_add_u32 s51, s50, 983040
    s_mov_b32 s4, s82
    s_mov_b32 s5, s83
    s_mov_b32 s6, 24117248
    s_mov_b32 s7, 0x20000
    s_mov_b32 s36, s80
    s_mov_b32 s37, s81
    s_mov_b32 s38, 256
    s_mov_b32 s39, 0x20000
    s_mov_b32 s16, s68
    s_mov_b32 s17, s69
    s_mov_b32 s18, 819200
    s_mov_b32 s19, 0x20000
    s_mov_b32 s20, s72
    s_mov_b32 s21, s73
    s_mov_b32 s22, 2211840
    s_mov_b32 s23, 0x20000
    s_mov_b32 s24, s74
    s_mov_b32 s25, s75
    s_mov_b32 s26, 2211840
    s_mov_b32 s27, 0x20000
    s_mov_b32 s28, s76
    s_mov_b32 s29, s77
    s_mov_b32 s30, 2211840
    s_mov_b32 s31, 0x20000
    s_mov_b32 s32, s78
    s_mov_b32 s33, s79
    s_mov_b32 s34, 2621440
    s_mov_b32 s35, 0x20000
    s_mov_b32 s0, 0
    s_sub_u32 s1, s2, 220
    buffer_load_dword v248, v2, s[12:15], s51 offen
    s_add_u32 s51, s51, 1048576
    buffer_load_dword v249, v2, s[12:15], s51 offen
    s_cmp_ge_u32 s3, 4
    s_cbranch_scc1 L_spare3
    s_waitcnt vmcnt(2)
    v_lshlrev_b32 v32, 16, v12
    v_and_b32 v33, 0xffff0000, v12
    v_lshlrev_b32 v34, 16, v13
    v_and_b32 v35, 0xffff0000, v13
    v_lshlrev_b32 v36, 16, v14
    v_and_b32 v37, 0xffff0000, v14
    v_lshlrev_b32 v38, 16, v15
    v_and_b32 v39, 0xffff0000, v15
    v_lshlrev_b32 v40, 16, v16
    v_and_b32 v41, 0xffff0000, v16
    v_lshlrev_b32 v44, 16, v20
    v_and_b32 v45, 0xffff0000, v20
    v_lshlrev_b32 v46, 16, v21
    v_and_b32 v47, 0xffff0000, v21
    v_lshlrev_b32 v48, 16, v22
    v_and_b32 v49, 0xffff0000, v22
    v_lshlrev_b32 v50, 16, v23
    v_and_b32 v51, 0xffff0000, v23
    v_lshlrev_b32 v52, 16, v24
    v_and_b32 v53, 0xffff0000, v24
    v_add_f32 v12, v32, v33
    v_add_f32 v20, v44, v45
    v_add_f32 v12, v12, v34
    v_add_f32 v20, v20, v46
    v_add_f32 v12, v12, v35
    v_add_f32 v20, v20, v47
    v_add_f32 v12, v12, v36
    v_add_f32 v20, v20, v48
    v_add_f32 v12, v12, v37
    v_add_f32 v20, v20, v49
    v_add_f32 v12, v12, v38
    v_add_f32 v20, v20, v50
    v_add_f32 v12, v12, v39
    v_add_f32 v20, v20, v51
    v_add_f32 v12, v12, v40
    v_add_f32 v20, v20, v52
    v_add_f32 v12, v12, v41
    v_add_f32 v20, v20, v53
    s_nop 0
    v_add_f32_dpp v12, v12, v12 quad_perm:[1,0,3,2] row_mask:0xf bank_mask:0xf
    v_add_f32_dpp v20, v20, v20 quad_perm:[1,0,3,2] row_mask:0xf bank_mask:0xf
    s_nop 0
    v_add_f32_dpp v12, v12, v12 quad_perm:[2,3,0,1] row_mask:0xf bank_mask:0xf
    v_add_f32_dpp v20, v20, v20 quad_perm:[2,3,0,1] row_mask:0xf bank_mask:0xf
    s_nop 0
    v_add_f32_dpp v12, v12, v12 row_half_mirror row_mask:0xf bank_mask:0xf
    v_add_f32_dpp v20, v20, v20 row_half_mirror row_mask:0xf bank_mask:0xf
    s_nop 0
    v_add_f32_dpp v12, v12, v12 row_mirror row_mask:0xf bank_mask:0xf
    v_add_f32_dpp v20, v20, v20 row_mirror row_mask:0xf bank_mask:0xf
    s_nop 0
    v_add_f32_dpp v12, v12, v12 row_bcast:15 row_mask:0xa bank_mask:0xf
    v_add_f32_dpp v20, v20, v20 row_bcast:15 row_mask:0xa bank_mask:0xf
    s_nop 0
    v_add_f32_dpp v12, v12, v12 row_bcast:31 row_mask:0xc bank_mask:0xf
    v_add_f32_dpp v20, v20, v20 row_bcast:31 row_mask:0xc bank_mask:0xf
    v_readlane_b32 s46, v12, 63
    v_readlane_b32 s47, v20, 63
    v_mov_b32 v10, 0x3acccccd
    v_mul_f32 v13, s46, v10
    v_mul_f32 v21, s47, v10
    v_sub_f32 v32, v32, v13
    v_sub_f32 v44, v44, v21
    v_sub_f32 v33, v33, v13
    v_sub_f32 v45, v45, v21
    v_sub_f32 v34, v34, v13
    v_sub_f32 v46, v46, v21
    v_sub_f32 v35, v35, v13
    v_sub_f32 v47, v47, v21
    v_sub_f32 v36, v36, v13
    v_sub_f32 v48, v48, v21
    v_sub_f32 v37, v37, v13
    v_sub_f32 v49, v49, v21
    v_sub_f32 v38, v38, v13
    v_sub_f32 v50, v50, v21
    v_sub_f32 v39, v39, v13
    v_sub_f32 v51, v51, v21
    v_sub_f32 v40, v40, v13
    v_sub_f32 v52, v52, v21
    v_sub_f32 v41, v41, v13
    v_sub_f32 v53, v53, v21
    v_mul_f32 v12, v32, v32
    v_mul_f32 v20, v44, v44
    v_fmac_f32 v12, v33, v33
    v_fmac_f32 v20, v45, v45
    v_fmac_f32 v12, v34, v34
    v_fmac_f32 v20, v46, v46
    v_fmac_f32 v12, v35, v35
    v_fmac_f32 v20, v47, v47
    v_fmac_f32 v12, v36, v36
    v_fmac_f32 v20, v48, v48
    v_fmac_f32 v12, v37, v37
    v_fmac_f32 v20, v49, v49
    v_fmac_f32 v12, v38, v38
    v_fmac_f32 v20, v50, v50
    v_fmac_f32 v12, v39, v39
    v_fmac_f32 v20, v51, v51
    v_fmac_f32 v12, v40, v40
    v_fmac_f32 v20, v52, v52
    v_fmac_f32 v12, v41, v41
    v_fmac_f32 v20, v53, v53
    s_nop 0
    v_add_f32_dpp v12, v12, v12 quad_perm:[1,0,3,2] row_mask:0xf bank_mask:0xf
    v_add_f32_dpp v20, v20, v20 quad_perm:[1,0,3,2] row_mask:0xf bank_mask:0xf
    s_nop 0
    v_add_f32_dpp v12, v12, v12 quad_perm:[2,3,0,1] row_mask:0xf bank_mask:0xf
    v_add_f32_dpp v20, v20, v20 quad_perm:[2,3,0,1] row_mask:0xf bank_mask:0xf
    s_nop 0
    v_add_f32_dpp v12, v12, v12 row_half_mirror row_mask:0xf bank_mask:0xf
    v_add_f32_dpp v20, v20, v20 row_half_mirror row_mask:0xf bank_mask:0xf
    s_nop 0
    v_add_f32_dpp v12, v12, v12 row_mirror row_mask:0xf bank_mask:0xf
    v_add_f32_dpp v20, v20, v20 row_mirror row_mask:0xf bank_mask:0xf
    s_nop 0
    v_add_f32_dpp v12, v12, v12 row_bcast:15 row_mask:0xa bank_mask:0xf
    v_add_f32_dpp v20, v20, v20 row_bcast:15 row_mask:0xa bank_mask:0xf
    s_nop 0
    v_add_f32_dpp v12, v12, v12 row_bcast:31 row_mask:0xc bank_mask:0xf
    v_add_f32_dpp v20, v20, v20 row_bcast:31 row_mask:0xc bank_mask:0xf
    v_readlane_b32 s46, v12, 63
    v_readlane_b32 s47, v20, 63
    v_mov_b32 v14, 0x3727c5ac
    v_fmac_f32 v14, s46, v10
    v_rsq_f32 v14, v14
    v_mov_b32 v22, 0x3727c5ac
    v_fmac_f32 v22, s47, v10
    v_rsq_f32 v22, v22
    s_lshl_b32 s45, s44, 2
    s_add_u32 s45, s45, 65536
    s_add_u32 s46, s45, 8192
    v_mov_b32 v10, 0
    s_mov_b64 exec, 1
    buffer_store_dword v13, v10, s[4:7], s45 offen offset:0 sc1
    buffer_store_dword v14, v10, s[4:7], s46 offen offset:0 sc1
    buffer_store_dword v21, v10, s[4:7], s45 offen offset:4 sc1
    buffer_store_dword v22, v10, s[4:7], s46 offen offset:4 sc1
    s_mov_b64 exec, -1
L_spare3:
    v_mov_b32 v10, 0
Lpoll_20:
    buffer_load_dword v11, v10, s[36:39], 0 offen sc1
    s_waitcnt vmcnt(0)
    v_cmp_ne_u32 vcc, 1, v11
    s_cbranch_vccz Lpoll_20d
    s_sleep 1
    s_sub_u32 s96, s96, 1
    s_cbranch_scc0 Lpoll_20
    s_mov_b32 s96, 0
Lpoll_20d:
    s_barrier
    s_cmp_lg_u32 s3, 0
    s_cbranch_scc1 L_spare4
    s_lshr_b32 s53, s55, 4
    s_mul_i32 s53, s53, 15
    v_add_u32 v10, s53, v1
    v_cmp_gt_u32 vcc, 15, v1
    v_lshlrev_b32 v10, 7, v10
    v_mov_b32 v11, 1
    s_mov_b64 exec, vcc
    buffer_atomic_add v11, v10, s[4:7], 0 offen offset:0 sc1
    s_mov_b64 exec, -1
L_spare4:
    s_and_b32 s51, s50, 524287
    s_cmp_ge_u32 s3, 4
    s_cbranch_scc1 L_spare5
    buffer_load_dword v249, v2, s[20:23], s51 offen
    s_branch L_spare6
L_spare5:
    buffer_load_dword v249, v2, s[24:27], s51 offen
L_spare6:
    s_mov_b64 s[62:63], 0
    s_branch L_p1_join
L_init:
    s_mov_b32 s4, s82
    s_mov_b32 s5, s83
    s_mov_b32 s6, 24117248
    s_mov_b32 s7, 0x20000
    s_mov_b32 s36, s80
    s_mov_b32 s37, s81
    s_mov_b32 s38, 256
    s_mov_b32 s39, 0x20000
    v_mov_b32 v4, 0
    v_mov_b32 v5, 0
    v_mov_b32 v6, 0
    v_mov_b32 v7, 0
    v_lshlrev_b32 v8, 4, v1
    s_lshl_b32 s40, s3, 12
    buffer_store_dwordx4 v[4:7], v8, s[4:7], s40 offen offset:0 sc1
    buffer_store_dwordx4 v[4:7], v8, s[4:7], s40 offen offset:1024 sc1
    buffer_store_dwordx4 v[4:7], v8, s[4:7], s40 offen offset:2048 sc1
    buffer_store_dwordx4 v[4:7], v8, s[4:7], s40 offen offset:3072 sc1
    s_waitcnt vmcnt(0)
    s_barrier
    s_cmp_lg_u32 s3, 0
    s_cbranch_scc1 L_init_back
    v_mov_b32 v5, 1
    s_mov_b64 exec, 1
    buffer_store_dword v5, v4, s[36:39], 0 offen sc1
    s_mov_b64 exec, -1
    s_branch L_init_back
L_p2_slow:
    s_nop 12
    ds_read_b128 v[24:27], v12 offset:512
    ds_read_b128 v[28:31], v13 offset:512
    s_waitcnt lgkmcnt(1)
    v_mfma_f32_32x32x16_bf16 v[80:95], v[24:27], v[16:19], 0
    s_waitcnt lgkmcnt(0)
    v_mfma_f32_32x32x16_bf16 v[80:95], v[28:31], v[20:23], v[80:95]
    ds_read_b128 v[32:35], v12 offset:4096
    ds_read_b128 v[36:39], v13 offset:4096
    s_waitcnt lgkmcnt(1)
    v_mfma_f32_32x32x16_bf16 v[192:207], v[32:35], v[16:19], 0
    s_waitcnt lgkmcnt(0)
    v_mfma_f32_32x32x16_bf16 v[192:207], v[36:39], v[20:23], v[192:207]
    ds_read_b128 v[40:43], v12 offset:0
    ds_read_b128 v[44:47], v13 offset:0
    s_waitcnt lgkmcnt(1)
    v_mfma_f32_32x32x16_bf16 v[64:79], v[40:43], v[16:19], 0
    s_waitcnt lgkmcnt(0)
    v_mfma_f32_32x32x16_bf16 v[64:79], v[44:47], v[20:23], v[64:79]
    ds_read_b128 v[24:27], v12 offset:1024
    ds_read_b128 v[28:31], v13 offset:1024
    s_waitcnt lgkmcnt(1)
    v_mfma_f32_32x32x16_bf16 v[96:111], v[24:27], v[16:19], 0
    s_waitcnt lgkmcnt(0)
    v_mfma_f32_32x32x16_bf16 v[96:111], v[28:31], v[20:23], v[96:111]
    ds_read_b128 v[32:35], v12 offset:1536
    ds_read_b128 v[36:39], v13 offset:1536
    s_waitcnt lgkmcnt(1)
    v_mfma_f32_32x32x16_bf16 v[112:127], v[32:35], v[16:19], 0
    s_waitcnt lgkmcnt(0)
    v_mfma_f32_32x32x16_bf16 v[112:127], v[36:39], v[20:23], v[112:127]
    ds_read_b128 v[40:43], v12 offset:2048
    ds_read_b128 v[44:47], v13 offset:2048
    s_waitcnt lgkmcnt(1)
    v_mfma_f32_32x32x16_bf16 v[128:143], v[40:43], v[16:19], 0
    s_waitcnt lgkmcnt(0)
    v_mfma_f32_32x32x16_bf16 v[128:143], v[44:47], v[20:23], v[128:143]
    ds_read_b128 v[24:27], v12 offset:2560
    ds_read_b128 v[28:31], v13 offset:2560
    s_waitcnt lgkmcnt(1)
    v_mfma_f32_32x32x16_bf16 v[144:159], v[24:27], v[16:19], 0
    s_waitcnt lgkmcnt(0)
    v_mfma_f32_32x32x16_bf16 v[144:159], v[28:31], v[20:23], v[144:159]
    ds_read_b128 v[32:35], v12 offset:3072
    ds_read_b128 v[36:39], v13 offset:3072
    s_waitcnt lgkmcnt(1)
    v_mfma_f32_32x32x16_bf16 v[160:175], v[32:35], v[16:19], 0
    s_waitcnt lgkmcnt(0)
    v_mfma_f32_32x32x16_bf16 v[160:175], v[36:39], v[20:23], v[160:175]
    ds_read_b128 v[40:43], v12 offset:3584
    ds_read_b128 v[44:47], v13 offset:3584
    s_waitcnt lgkmcnt(1)
    v_mfma_f32_32x32x16_bf16 v[176:191], v[40:43], v[16:19], 0
    s_waitcnt lgkmcnt(0)
    v_mfma_f32_32x32x16_bf16 v[176:191], v[44:47], v[20:23], v[176:191]
    v_cndmask_b32 v192, v64, v192, s[64:65]
    v_cndmask_b32 v193, v65, v193, s[66:67]
    v_cndmask_b32 v194, v66, v194, s[68:69]
    v_cndmask_b32 v195, v67, v195, s[70:71]
    v_cndmask_b32 v196, v68, v196, s[72:73]
    v_cndmask_b32 v197, v69, v197, s[74:75]
    v_cndmask_b32 v198, v70, v198, s[76:77]
    v_cndmask_b32 v199, v71, v199, s[78:79]
    v_cndmask_b32 v200, v72, v200, s[80:81]
    v_cndmask_b32 v201, v73, v201, s[82:83]
    v_cndmask_b32 v202, v74, v202, s[84:85]
    v_cndmask_b32 v203, v75, v203, s[86:87]
    v_cndmask_b32 v204, v76, v204, s[88:89]
    v_cndmask_b32 v205, v77, v205, s[90:91]
    v_cndmask_b32 v206, v78, v206, s[92:93]
    v_cndmask_b32 v207, v79, v207, s[94:95]
    v_max_f32 v60, v80, v81
    v_max_f32 v61, v82, v83
    v_max3_f32 v60, v60, v84, v85
    v_max3_f32 v61, v61, v86, v87
    v_max3_f32 v60, v60, v88, v89
    v_max3_f32 v61, v61, v90, v91
    v_max3_f32 v60, v60, v92, v93
    v_max3_f32 v61, v61, v94, v95
    v_max3_f32 v60, v60, v96, v97
    v_max3_f32 v61, v61, v98, v99
    v_max3_f32 v60, v60, v100, v101
    v_max3_f32 v61, v61, v102, v103
    v_max3_f32 v60, v60, v104, v105
    v_max3_f32 v61, v61, v106, v107
    v_max3_f32 v60, v60, v108, v109
    v_max3_f32 v61, v61, v110, v111
    v_max3_f32 v60, v60, v112, v113
    v_max3_f32 v61, v61, v114, v115
    v_max3_f32 v60, v60, v116, v117
    v_max3_f32 v61, v61, v118, v119
    v_max3_f32 v60, v60, v120, v121
    v_max3_f32 v61, v61, v122, v123
    v_max3_f32 v60, v60, v124, v125
    v_max3_f32 v61, v61, v126, v127
    v_max3_f32 v60, v60, v128, v129
    v_max3_f32 v61, v61, v130, v131
    v_max3_f32 v60, v60, v132, v133
    v_max3_f32 v61, v61, v134, v135
    v_max3_f32 v60, v60, v136, v137
    v_max3_f32 v61, v61, v138, v139
    v_max3_f32 v60, v60, v140, v141
    v_max3_f32 v61, v61, v142, v143
    v_max3_f32 v60, v60, v144, v145
    v_max3_f32 v61, v61, v146, v147
    v_max3_f32 v60, v60, v148, v149
    v_max3_f32 v61, v61, v150, v151
    v_max3_f32 v60, v60, v152, v153
    v_max3_f32 v61, v61, v154, v155
    v_max3_f32 v60, v60, v156, v157
    v_max3_f32 v61, v61, v158, v159
    v_max3_f32 v60, v60, v160, v161
    v_max3_f32 v61, v61, v162, v163
    v_max3_f32 v60, v60, v164, v165
    v_max3_f32 v61, v61, v166, v167
    v_max3_f32 v60, v60, v168, v169
    v_max3_f32 v61, v61, v170, v171
    v_max3_f32 v60, v60, v172, v173
    v_max3_f32 v61, v61, v174, v175
    v_max3_f32 v60, v60, v176, v177
    v_max3_f32 v61, v61, v178, v179
    v_max3_f32 v60, v60, v180, v181
    v_max3_f32 v61, v61, v182, v183
    v_max3_f32 v60, v60, v184, v185
    v_max3_f32 v61, v61, v186, v187
    v_max3_f32 v60, v60, v188, v189
    v_max3_f32 v61, v61, v190, v191
    v_max3_f32 v60, v60, v192, v193
    v_max3_f32 v61, v61, v194, v195
    v_max3_f32 v60, v60, v196, v197
    v_max3_f32 v61, v61, v198, v199
    v_max3_f32 v60, v60, v200, v201
    v_max3_f32 v61, v61, v202, v203
    v_max3_f32 v60, v60, v204, v205
    v_max3_f32 v61, v61, v206, v207
    v_max_f32 v60, v60, v61
    v_mov_b32 v61, v60
    s_nop 1
    v_permlane32_swap_b32 v60, v61
    v_max_f32 v60, v60, v61
    v_sub_f32 v192, v192, v60
    v_sub_f32 v193, v193, v60
    v_sub_f32 v194, v194, v60
    v_sub_f32 v195, v195, v60
    v_sub_f32 v196, v196, v60
    v_sub_f32 v197, v197, v60
    v_sub_f32 v198, v198, v60
    v_sub_f32 v199, v199, v60
    v_sub_f32 v200, v200, v60
    v_sub_f32 v201, v201, v60
    v_sub_f32 v202, v202, v60
    v_sub_f32 v203, v203, v60
    v_sub_f32 v204, v204, v60
    v_sub_f32 v205, v205, v60
    v_sub_f32 v206, v206, v60
    v_sub_f32 v207, v207, v60
    v_exp_f32 v192, v192
    v_exp_f32 v193, v193
    v_exp_f32 v194, v194
    v_exp_f32 v195, v195
    v_exp_f32 v196, v196
    v_exp_f32 v197, v197
    v_exp_f32 v198, v198
    v_exp_f32 v199, v199
    v_exp_f32 v200, v200
    v_exp_f32 v201, v201
    v_exp_f32 v202, v202
    v_exp_f32 v203, v203
    v_exp_f32 v204, v204
    v_exp_f32 v205, v205
    v_exp_f32 v206, v206
    v_exp_f32 v207, v207
    .p2align 3
    v_cvt_pk_bf16_f32 v192, v192, v193
    v_cvt_pk_bf16_f32 v193, v194, v195
    v_cvt_pk_bf16_f32 v194, v196, v197
    v_cvt_pk_bf16_f32 v195, v198, v199
    v_cvt_pk_bf16_f32 v196, v200, v201
    v_cvt_pk_bf16_f32 v197, v202, v203
    v_cvt_pk_bf16_f32 v198, v204, v205
    v_cvt_pk_bf16_f32 v199, v206, v207
    v_and_b32_e64 v200, v192, v52
    v_bfi_b32 v64, v52, 0, v192
    v_and_b32_e64 v201, v193, v53
    v_bfi_b32 v65, v53, 0, v193
    v_and_b32_e64 v202, v194, v54
    v_bfi_b32 v66, v54, 0, v194
    v_and_b32_e64 v203, v195, v55
    v_bfi_b32 v67, v55, 0, v195
    v_and_b32_e64 v204, v196, v56
    v_bfi_b32 v68, v56, 0, v196
    v_and_b32_e64 v205, v197, v57
    v_bfi_b32 v69, v57, 0, v197
    v_and_b32_e64 v206, v198, v58
    v_bfi_b32 v70, v58, 0, v198
    v_and_b32_e64 v207, v199, v59
    v_bfi_b32 v71, v59, 0, v199
    ds_read_b64_tr_b16 v[192:193], v14 offset:4096
    ds_read_b64_tr_b16 v[194:195], v14 offset:4224
    ds_read_b64_tr_b16 v[196:197], v14 offset:4352
    ds_read_b64_tr_b16 v[198:199], v14 offset:4480
    s_waitcnt lgkmcnt(2)
    v_mfma_f32_32x32x16_bf16 v[208:223], v[192:195], v[200:203], 0
    s_waitcnt lgkmcnt(0)
    v_mfma_f32_32x32x16_bf16 v[208:223], v[196:199], v[204:207], v[208:223]
    ds_read_b64_tr_b16 v[72:73], v14 offset:0
    ds_read_b64_tr_b16 v[74:75], v14 offset:128
    ds_read_b64_tr_b16 v[76:77], v14 offset:256
    ds_read_b64_tr_b16 v[78:79], v14 offset:384
    s_waitcnt lgkmcnt(2)
    v_mfma_f32_32x32x16_bf16 v[208:223], v[72:75], v[64:67], v[208:223]
    s_waitcnt lgkmcnt(0)
    v_mfma_f32_32x32x16_bf16 v[208:223], v[76:79], v[68:71], v[208:223]
    v_sub_f32 v80, v80, v60
    v_sub_f32 v81, v81, v60
    v_sub_f32 v82, v82, v60
    v_sub_f32 v83, v83, v60
    v_sub_f32 v84, v84, v60
    v_sub_f32 v85, v85, v60
    v_sub_f32 v86, v86, v60
    v_sub_f32 v87, v87, v60
    v_sub_f32 v88, v88, v60
    v_sub_f32 v89, v89, v60
    v_sub_f32 v90, v90, v60
    v_sub_f32 v91, v91, v60
    v_sub_f32 v92, v92, v60
    v_sub_f32 v93, v93, v60
    v_sub_f32 v94, v94, v60
    v_sub_f32 v95, v95, v60
    v_exp_f32 v80, v80
    v_exp_f32 v81, v81
    v_exp_f32 v82, v82
    v_exp_f32 v83, v83
    v_exp_f32 v84, v84
    v_exp_f32 v85, v85
    v_exp_f32 v86, v86
    v_exp_f32 v87, v87
    v_exp_f32 v88, v88
    v_exp_f32 v89, v89
    v_exp_f32 v90, v90
    v_exp_f32 v91, v91
    v_exp_f32 v92, v92
    v_exp_f32 v93, v93
    v_exp_f32 v94, v94
    v_exp_f32 v95, v95
    .p2align 3
    v_cvt_pk_bf16_f32 v80, v80, v81
    v_cvt_pk_bf16_f32 v81, v82, v83
    v_cvt_pk_bf16_f32 v82, v84, v85
    v_cvt_pk_bf16_f32 v83, v86, v87
    v_cvt_pk_bf16_f32 v84, v88, v89
    v_cvt_pk_bf16_f32 v85, v90, v91
    v_cvt_pk_bf16_f32 v86, v92, v93
    v_cvt_pk_bf16_f32 v87, v94, v95
    ds_read_b64_tr_b16 v[88:89], v14 offset:512
    ds_read_b64_tr_b16 v[90:91], v14 offset:640
    ds_read_b64_tr_b16 v[92:93], v14 offset:768
    ds_read_b64_tr_b16 v[94:95], v14 offset:896
    s_waitcnt lgkmcnt(2)
    v_mfma_f32_32x32x16_bf16 v[208:223], v[88:91], v[80:83], v[208:223]
    s_waitcnt lgkmcnt(0)
    v_mfma_f32_32x32x16_bf16 v[208:223], v[92:95], v[84:87], v[208:223]
    v_sub_f32 v96, v96, v60
    v_sub_f32 v97, v97, v60
    v_sub_f32 v98, v98, v60
    v_sub_f32 v99, v99, v60
    v_sub_f32 v100, v100, v60
    v_sub_f32 v101, v101, v60
    v_sub_f32 v102, v102, v60
    v_sub_f32 v103, v103, v60
    v_sub_f32 v104, v104, v60
    v_sub_f32 v105, v105, v60
    v_sub_f32 v106, v106, v60
    v_sub_f32 v107, v107, v60
    v_sub_f32 v108, v108, v60
    v_sub_f32 v109, v109, v60
    v_sub_f32 v110, v110, v60
    v_sub_f32 v111, v111, v60
    v_exp_f32 v96, v96
    v_exp_f32 v97, v97
    v_exp_f32 v98, v98
    v_exp_f32 v99, v99
    v_exp_f32 v100, v100
    v_exp_f32 v101, v101
    v_exp_f32 v102, v102
    v_exp_f32 v103, v103
    v_exp_f32 v104, v104
    v_exp_f32 v105, v105
    v_exp_f32 v106, v106
    v_exp_f32 v107, v107
    v_exp_f32 v108, v108
    v_exp_f32 v109, v109
    v_exp_f32 v110, v110
    v_exp_f32 v111, v111
    .p2align 3
    v_cvt_pk_bf16_f32 v96, v96, v97
    v_cvt_pk_bf16_f32 v97, v98, v99
    v_cvt_pk_bf16_f32 v98, v100, v101
    v_cvt_pk_bf16_f32 v99, v102, v103
    v_cvt_pk_bf16_f32 v100, v104, v105
    v_cvt_pk_bf16_f32 v101, v106, v107
    v_cvt_pk_bf16_f32 v102, v108, v109
    v_cvt_pk_bf16_f32 v103, v110, v111
    ds_read_b64_tr_b16 v[104:105], v14 offset:1024
    ds_read_b64_tr_b16 v[106:107], v14 offset:1152
    ds_read_b64_tr_b16 v[108:109], v14 offset:1280
    ds_read_b64_tr_b16 v[110:111], v14 offset:1408
    s_waitcnt lgkmcnt(2)
    v_mfma_f32_32x32x16_bf16 v[208:223], v[104:107], v[96:99], v[208:223]
    s_waitcnt lgkmcnt(0)
    v_mfma_f32_32x32x16_bf16 v[208:223], v[108:111], v[100:103], v[208:223]
    v_sub_f32 v112, v112, v60
    v_sub_f32 v113, v113, v60
    v_sub_f32 v114, v114, v60
    v_sub_f32 v115, v115, v60
    v_sub_f32 v116, v116, v60
    v_sub_f32 v117, v117, v60
    v_sub_f32 v118, v118, v60
    v_sub_f32 v119, v119, v60
    v_sub_f32 v120, v120, v60
    v_sub_f32 v121, v121, v60
    v_sub_f32 v122, v122, v60
    v_sub_f32 v123, v123, v60
    v_sub_f32 v124, v124, v60
    v_sub_f32 v125, v125, v60
    v_sub_f32 v126, v126, v60
    v_sub_f32 v127, v127, v60
    v_exp_f32 v112, v112
    v_exp_f32 v113, v113
    v_exp_f32 v114, v114
    v_exp_f32 v115, v115
    v_exp_f32 v116, v116
    v_exp_f32 v117, v117
    v_exp_f32 v118, v118
    v_exp_f32 v119, v119
    v_exp_f32 v120, v120
    v_exp_f32 v121, v121
    v_exp_f32 v122, v122
    v_exp_f32 v123, v123
    v_exp_f32 v124, v124
    v_exp_f32 v125, v125
    v_exp_f32 v126, v126
    v_exp_f32 v127, v127
    .p2align 3
    v_cvt_pk_bf16_f32 v112, v112, v113
    v_cvt_pk_bf16_f32 v113, v114, v115
    v_cvt_pk_bf16_f32 v114, v116, v117
    v_cvt_pk_bf16_f32 v115, v118, v119
    v_cvt_pk_bf16_f32 v116, v120, v121
    v_cvt_pk_bf16_f32 v117, v122, v123
    v_cvt_pk_bf16_f32 v118, v124, v125
    v_cvt_pk_bf16_f32 v119, v126, v127
    ds_read_b64_tr_b16 v[120:121], v14 offset:1536
    ds_read_b64_tr_b16 v[122:123], v14 offset:1664
    ds_read_b64_tr_b16 v[124:125], v14 offset:1792
    ds_read_b64_tr_b16 v[126:127], v14 offset:1920
    s_waitcnt lgkmcnt(2)
    v_mfma_f32_32x32x16_bf16 v[208:223], v[120:123], v[112:115], v[208:223]
    s_waitcnt lgkmcnt(0)
    v_mfma_f32_32x32x16_bf16 v[208:223], v[124:127], v[116:119], v[208:223]
    v_sub_f32 v128, v128, v60
    v_sub_f32 v129, v129, v60
    v_sub_f32 v130, v130, v60
    v_sub_f32 v131, v131, v60
    v_sub_f32 v132, v132, v60
    v_sub_f32 v133, v133, v60
    v_sub_f32 v134, v134, v60
    v_sub_f32 v135, v135, v60
    v_sub_f32 v136, v136, v60
    v_sub_f32 v137, v137, v60
    v_sub_f32 v138, v138, v60
    v_sub_f32 v139, v139, v60
    v_sub_f32 v140, v140, v60
    v_sub_f32 v141, v141, v60
    v_sub_f32 v142, v142, v60
    v_sub_f32 v143, v143, v60
    v_exp_f32 v128, v128
    v_exp_f32 v129, v129
    v_exp_f32 v130, v130
    v_exp_f32 v131, v131
    v_exp_f32 v132, v132
    v_exp_f32 v133, v133
    v_exp_f32 v134, v134
    v_exp_f32 v135, v135
    v_exp_f32 v136, v136
    v_exp_f32 v137, v137
    v_exp_f32 v138, v138
    v_exp_f32 v139, v139
    v_exp_f32 v140, v140
    v_exp_f32 v141, v141
    v_exp_f32 v142, v142
    v_exp_f32 v143, v143
    .p2align 3
    v_cvt_pk_bf16_f32 v128, v128, v129
    v_cvt_pk_bf16_f32 v129, v130, v131
    v_cvt_pk_bf16_f32 v130, v132, v133
    v_cvt_pk_bf16_f32 v131, v134, v135
    v_cvt_pk_bf16_f32 v132, v136, v137
    v_cvt_pk_bf16_f32 v133, v138, v139
    v_cvt_pk_bf16_f32 v134, v140, v141
    v_cvt_pk_bf16_f32 v135, v142, v143
    ds_read_b64_tr_b16 v[136:137], v14 offset:2048
    ds_read_b64_tr_b16 v[138:139], v14 offset:2176
    ds_read_b64_tr_b16 v[140:141], v14 offset:2304
    ds_read_b64_tr_b16 v[142:143], v14 offset:2432
    s_waitcnt lgkmcnt(2)
    v_mfma_f32_32x32x16_bf16 v[208:223], v[136:139], v[128:131], v[208:223]
    s_waitcnt lgkmcnt(0)
    v_mfma_f32_32x32x16_bf16 v[208:223], v[140:143], v[132:135], v[208:223]
    v_sub_f32 v144, v144, v60
    v_sub_f32 v145, v145, v60
    v_sub_f32 v146, v146, v60
    v_sub_f32 v147, v147, v60
    v_sub_f32 v148, v148, v60
    v_sub_f32 v149, v149, v60
    v_sub_f32 v150, v150, v60
    v_sub_f32 v151, v151, v60
    v_sub_f32 v152, v152, v60
    v_sub_f32 v153, v153, v60
    v_sub_f32 v154, v154, v60
    v_sub_f32 v155, v155, v60
    v_sub_f32 v156, v156, v60
    v_sub_f32 v157, v157, v60
    v_sub_f32 v158, v158, v60
    v_sub_f32 v159, v159, v60
    v_exp_f32 v144, v144
    v_exp_f32 v145, v145
    v_exp_f32 v146, v146
    v_exp_f32 v147, v147
    v_exp_f32 v148, v148
    v_exp_f32 v149, v149
    v_exp_f32 v150, v150
    v_exp_f32 v151, v151
    v_exp_f32 v152, v152
    v_exp_f32 v153, v153
    v_exp_f32 v154, v154
    v_exp_f32 v155, v155
    v_exp_f32 v156, v156
    v_exp_f32 v157, v157
    v_exp_f32 v158, v158
    v_exp_f32 v159, v159
    .p2align 3
    v_cvt_pk_bf16_f32 v144, v144, v145
    v_cvt_pk_bf16_f32 v145, v146, v147
    v_cvt_pk_bf16_f32 v146, v148, v149
    v_cvt_pk_bf16_f32 v147, v150, v151
    v_cvt_pk_bf16_f32 v148, v152, v153
    v_cvt_pk_bf16_f32 v149, v154, v155
    v_cvt_pk_bf16_f32 v150, v156, v157
    v_cvt_pk_bf16_f32 v151, v158, v159
    ds_read_b64_tr_b16 v[152:153], v14 offset:2560
    ds_read_b64_tr_b16 v[154:155], v14 offset:2688
    ds_read_b64_tr_b16 v[156:157], v14 offset:2816
    ds_read_b64_tr_b16 v[158:159], v14 offset:2944
    s_waitcnt lgkmcnt(2)
    v_mfma_f32_32x32x16_bf16 v[208:223], v[152:155], v[144:147], v[208:223]
    s_waitcnt lgkmcnt(0)
    v_mfma_f32_32x32x16_bf16 v[208:223], v[156:159], v[148:151], v[208:223]
    v_sub_f32 v160, v160, v60
    v_sub_f32 v161, v161, v60
    v_sub_f32 v162, v162, v60
    v_sub_f32 v163, v163, v60
    v_sub_f32 v164, v164, v60
    v_sub_f32 v165, v165, v60
    v_sub_f32 v166, v166, v60
    v_sub_f32 v167, v167, v60
    v_sub_f32 v168, v168, v60
    v_sub_f32 v169, v169, v60
    v_sub_f32 v170, v170, v60
    v_sub_f32 v171, v171, v60
    v_sub_f32 v172, v172, v60
    v_sub_f32 v173, v173, v60
    v_sub_f32 v174, v174, v60
    v_sub_f32 v175, v175, v60
    v_exp_f32 v160, v160
    v_exp_f32 v161, v161
    v_exp_f32 v162, v162
    v_exp_f32 v163, v163
    v_exp_f32 v164, v164
    v_exp_f32 v165, v165
    v_exp_f32 v166, v166
    v_exp_f32 v167, v167
    v_exp_f32 v168, v168
    v_exp_f32 v169, v169
    v_exp_f32 v170, v170
    v_exp_f32 v171, v171
    v_exp_f32 v172, v172
    v_exp_f32 v173, v173
    v_exp_f32 v174, v174
    v_exp_f32 v175, v175
    .p2align 3
    v_cvt_pk_bf16_f32 v160, v160, v161
    v_cvt_pk_bf16_f32 v161, v162, v163
    v_cvt_pk_bf16_f32 v162, v164, v165
    v_cvt_pk_bf16_f32 v163, v166, v167
    v_cvt_pk_bf16_f32 v164, v168, v169
    v_cvt_pk_bf16_f32 v165, v170, v171
    v_cvt_pk_bf16_f32 v166, v172, v173
    v_cvt_pk_bf16_f32 v167, v174, v175
    ds_read_b64_tr_b16 v[168:169], v14 offset:3072
    ds_read_b64_tr_b16 v[170:171], v14 offset:3200
    ds_read_b64_tr_b16 v[172:173], v14 offset:3328
    ds_read_b64_tr_b16 v[174:175], v14 offset:3456
    s_waitcnt lgkmcnt(2)
    v_mfma_f32_32x32x16_bf16 v[208:223], v[168:171], v[160:163], v[208:223]
    s_waitcnt lgkmcnt(0)
    v_mfma_f32_32x32x16_bf16 v[208:223], v[172:175], v[164:167], v[208:223]
    v_sub_f32 v176, v176, v60
    v_sub_f32 v177, v177, v60
    v_sub_f32 v178, v178, v60
    v_sub_f32 v179, v179, v60
    v_sub_f32 v180, v180, v60
    v_sub_f32 v181, v181, v60
    v_sub_f32 v182, v182, v60
    v_sub_f32 v183, v183, v60
    v_sub_f32 v184, v184, v60
    v_sub_f32 v185, v185, v60
    v_sub_f32 v186, v186, v60
    v_sub_f32 v187, v187, v60
    v_sub_f32 v188, v188, v60
    v_sub_f32 v189, v189, v60
    v_sub_f32 v190, v190, v60
    v_sub_f32 v191, v191, v60
    v_exp_f32 v176, v176
    v_exp_f32 v177, v177
    v_exp_f32 v178, v178
    v_exp_f32 v179, v179
    v_exp_f32 v180, v180
    v_exp_f32 v181, v181
    v_exp_f32 v182, v182
    v_exp_f32 v183, v183
    v_exp_f32 v184, v184
    v_exp_f32 v185, v185
    v_exp_f32 v186, v186
    v_exp_f32 v187, v187
    v_exp_f32 v188, v188
    v_exp_f32 v189, v189
    v_exp_f32 v190, v190
    v_exp_f32 v191, v191
    .p2align 3
    v_cvt_pk_bf16_f32 v176, v176, v177
    v_cvt_pk_bf16_f32 v177, v178, v179
    v_cvt_pk_bf16_f32 v178, v180, v181
    v_cvt_pk_bf16_f32 v179, v182, v183
    v_cvt_pk_bf16_f32 v180, v184, v185
    v_cvt_pk_bf16_f32 v181, v186, v187
    v_cvt_pk_bf16_f32 v182, v188, v189
    v_cvt_pk_bf16_f32 v183, v190, v191
    ds_read_b64_tr_b16 v[184:185], v14 offset:3584
    ds_read_b64_tr_b16 v[186:187], v14 offset:3712
    ds_read_b64_tr_b16 v[188:189], v14 offset:3840
    ds_read_b64_tr_b16 v[190:191], v14 offset:3968
    s_waitcnt lgkmcnt(2)
    v_mfma_f32_32x32x16_bf16 v[208:223], v[184:187], v[176:179], v[208:223]
    s_waitcnt lgkmcnt(0)
    v_mfma_f32_32x32x16_bf16 v[208:223], v[188:191], v[180:183], v[208:223]
    s_nop 12
    s_branch L_p2_norm
L_idle:
    s_mul_i32 s40, s3, 36
    s_add_u32 s40, s40, s1
    s_cmp_ge_u32 s40, 216
    s_cbranch_scc1 L_ct2
    s_mul_i32 s46, s40, 1214
    s_lshr_b32 s46, s46, 16
    s_mul_i32 s41, s46, 54
    s_sub_u32 s40, s40, s41
    s_cmp_ge_u32 s40, 27
    s_cselect_b32 s44, 27, 0
    s_cselect_b32 s56, s24, s20
    s_cselect_b32 s57, s25, s21
    s_mov_b32 s58, 2211840
    s_mov_b32 s59, 0x20000
    s_sub_u32 s45, s40, s44
    s_lshl_b32 s47, s45, 7
    s_mul_i32 s41, s46, 552960
    s_add_u32 s47, s47, s41
    s_mul_i32 s50, s3, 20480
    v_lshrrev_b32 v18, 3, v1
    v_mul_u32_u24 v16, 3456, v18
    v_and_b32 v18, 2, v18
    v_and_b32 v17, 7, v1
    v_xor_b32 v18, v18, v17
    v_lshl_add_u32 v16, v18, 4, v16
    v_xor_b32 v17, 64, v16
    s_add_u32 m0, s50, 0
    s_nop 0
    buffer_load_dwordx4 v16, s[56:59], s47 offen lds
    s_add_u32 s47, s47, 27648
    s_add_u32 m0, s50, 1024
    s_nop 0
    buffer_load_dwordx4 v17, s[56:59], s47 offen lds
    s_add_u32 s47, s47, 27648
    s_add_u32 m0, s50, 2048
    s_nop 0
    buffer_load_dwordx4 v16, s[56:59], s47 offen lds
    s_add_u32 s47, s47, 27648
    s_add_u32 m0, s50, 3072
    s_nop 0
    buffer_load_dwordx4 v17, s[56:59], s47 offen lds
    s_add_u32 s47, s47, 27648
    s_add_u32 m0, s50, 4096
    s_nop 0
    buffer_load_dwordx4 v16, s[56:59], s47 offen lds
    s_add_u32 s47, s47, 27648
    s_add_u32 m0, s50, 5120
    s_nop 0
    buffer_load_dwordx4 v17, s[56:59], s47 offen lds
    s_add_u32 s47, s47, 27648
    s_add_u32 m0, s50, 6144
    s_nop 0
    buffer_load_dwordx4 v16, s[56:59], s47 offen lds
    s_add_u32 s47, s47, 27648
    s_add_u32 m0, s50, 7168
    s_nop 0
    buffer_load_dwordx4 v17, s[56:59], s47 offen lds
    s_add_u32 s47, s47, 27648
    s_add_u32 m0, s50, 8192
    s_nop 0
    buffer_load_dwordx4 v16, s[56:59], s47 offen lds
    s_add_u32 s47, s47, 27648
    s_add_u32 m0, s50, 9216
    s_nop 0
    buffer_load_dwordx4 v17, s[56:59], s47 offen lds
    s_add_u32 s47, s47, 27648
    s_add_u32 m0, s50, 10240
    s_nop 0
    buffer_load_dwordx4 v16, s[56:59], s47 offen lds
    s_add_u32 s47, s47, 27648
    s_add_u32 m0, s50, 11264
    s_nop 0
    buffer_load_dwordx4 v17, s[56:59], s47 offen lds
    s_add_u32 s47, s47, 27648
    s_add_u32 m0, s50, 12288
    s_nop 0
    buffer_load_dwordx4 v16, s[56:59], s47 offen lds
    s_add_u32 s47, s47, 27648
    s_add_u32 m0, s50, 13312
    s_nop 0
    buffer_load_dwordx4 v17, s[56:59], s47 offen lds
    s_add_u32 s47, s47, 27648
    s_add_u32 m0, s50, 14336
    s_nop 0
    buffer_load_dwordx4 v16, s[56:59], s47 offen lds
    s_add_u32 s47, s47, 27648
    s_add_u32 m0, s50, 15360
    s_nop 0
    buffer_load_dwordx4 v17, s[56:59], s47 offen lds
    s_add_u32 s47, s47, 27648
    s_add_u32 m0, s50, 16384
    s_nop 0
    buffer_load_dwordx4 v16, s[56:59], s47 offen lds
    s_add_u32 s47, s47, 27648
    s_add_u32 m0, s50, 17408
    s_nop 0
    buffer_load_dwordx4 v17, s[56:59], s47 offen lds
    s_add_u32 s47, s47, 27648
    s_add_u32 m0, s50, 18432
    s_nop 0
    buffer_load_dwordx4 v16, s[56:59], s47 offen lds
    s_add_u32 s47, s47, 27648
    s_add_u32 m0, s50, 19456
    s_nop 0
    buffer_load_dwordx4 v17, s[56:59], s47 offen lds
    s_mul_i32 s47, s46, 13824
    s_lshl_b32 s41, s40, 8
    s_add_u32 s47, s47, s41
    s_add_u32 s47, s47, 114688
    s_waitcnt vmcnt(0)
    v_lshrrev_b32 v20, 4, v1
    v_lshlrev_b32 v16, 10, v20
    v_bfe_u32 v20, v1, 2, 2
    v_lshl_add_u32 v16, v20, 7, v16
    v_and_b32 v20, 3, v1
    v_lshl_add_u32 v16, v20, 3, v16
    v_bfe_u32 v20, v1, 3, 2
    v_lshl_add_u32 v16, v20, 5, v16
    v_add_u32 v16, s50, v16
    v_xor_b32 v17, 32, v16
    v_xor_b32 v18, 64, v16
    v_xor_b32 v19, 96, v16
    v_mov_b32 v20, 0x3f803f80
    v_mov_b32 v21, 0x3f803f80
    v_mov_b32 v22, 0x3f803f80
    v_mov_b32 v23, 0x3f803f80
    ds_read_b64_tr_b16 v[40:41], v16 offset:0
    ds_read_b64_tr_b16 v[42:43], v16 offset:512
    ds_read_b64_tr_b16 v[44:45], v17 offset:0
    ds_read_b64_tr_b16 v[46:47], v17 offset:512
    ds_read_b64_tr_b16 v[48:49], v18 offset:0
    ds_read_b64_tr_b16 v[50:51], v18 offset:512
    ds_read_b64_tr_b16 v[52:53], v19 offset:0
    ds_read_b64_tr_b16 v[54:55], v19 offset:512
    s_waitcnt lgkmcnt(0)
    v_mfma_f32_16x16x32_bf16 v[24:27], v[20:23], v[40:43], 0
    v_mfma_f32_16x16x32_bf16 v[28:31], v[20:23], v[44:47], 0
    v_mfma_f32_16x16x32_bf16 v[32:35], v[20:23], v[48:51], 0
    v_mfma_f32_16x16x32_bf16 v[36:39], v[20:23], v[52:55], 0
    ds_read_b64_tr_b16 v[56:57], v16 offset:4096
    ds_read_b64_tr_b16 v[58:59], v16 offset:4608
    ds_read_b64_tr_b16 v[60:61], v17 offset:4096
    ds_read_b64_tr_b16 v[62:63], v17 offset:4608
    ds_read_b64_tr_b16 v[64:65], v18 offset:4096
    ds_read_b64_tr_b16 v[66:67], v18 offset:4608
    ds_read_b64_tr_b16 v[68:69], v19 offset:4096
    ds_read_b64_tr_b16 v[70:71], v19 offset:4608
    s_waitcnt lgkmcnt(0)
    v_mfma_f32_16x16x32_bf16 v[24:27], v[20:23], v[56:59], v[24:27]
    v_mfma_f32_16x16x32_bf16 v[28:31], v[20:23], v[60:63], v[28:31]
    v_mfma_f32_16x16x32_bf16 v[32:35], v[20:23], v[64:67], v[32:35]
    v_mfma_f32_16x16x32_bf16 v[36:39], v[20:23], v[68:71], v[36:39]
    ds_read_b64_tr_b16 v[40:41], v16 offset:8192
    ds_read_b64_tr_b16 v[42:43], v16 offset:8704
    ds_read_b64_tr_b16 v[44:45], v17 offset:8192
    ds_read_b64_tr_b16 v[46:47], v17 offset:8704
    ds_read_b64_tr_b16 v[48:49], v18 offset:8192
    ds_read_b64_tr_b16 v[50:51], v18 offset:8704
    ds_read_b64_tr_b16 v[52:53], v19 offset:8192
    ds_read_b64_tr_b16 v[54:55], v19 offset:8704
    s_waitcnt lgkmcnt(0)
    v_mfma_f32_16x16x32_bf16 v[24:27], v[20:23], v[40:43], v[24:27]
    v_mfma_f32_16x16x32_bf16 v[28:31], v[20:23], v[44:47], v[28:31]
    v_mfma_f32_16x16x32_bf16 v[32:35], v[20:23], v[48:51], v[32:35]
    v_mfma_f32_16x16x32_bf16 v[36:39], v[20:23], v[52:55], v[36:39]
    ds_read_b64_tr_b16 v[56:57], v16 offset:12288
    ds_read_b64_tr_b16 v[58:59], v16 offset:12800
    ds_read_b64_tr_b16 v[60:61], v17 offset:12288
    ds_read_b64_tr_b16 v[62:63], v17 offset:12800
    ds_read_b64_tr_b16 v[64:65], v18 offset:12288
    ds_read_b64_tr_b16 v[66:67], v18 offset:12800
    ds_read_b64_tr_b16 v[68:69], v19 offset:12288
    ds_read_b64_tr_b16 v[70:71], v19 offset:12800
    s_waitcnt lgkmcnt(0)
    v_mfma_f32_16x16x32_bf16 v[24:27], v[20:23], v[56:59], v[24:27]
    v_mfma_f32_16x16x32_bf16 v[28:31], v[20:23], v[60:63], v[28:31]
    v_mfma_f32_16x16x32_bf16 v[32:35], v[20:23], v[64:67], v[32:35]
    v_mfma_f32_16x16x32_bf16 v[36:39], v[20:23], v[68:71], v[36:39]
    ds_read_b64_tr_b16 v[40:41], v16 offset:16384
    ds_read_b64_tr_b16 v[42:43], v16 offset:16896
    ds_read_b64_tr_b16 v[44:45], v17 offset:16384
    ds_read_b64_tr_b16 v[46:47], v17 offset:16896
    ds_read_b64_tr_b16 v[48:49], v18 offset:16384
    ds_read_b64_tr_b16 v[50:51], v18 offset:16896
    ds_read_b64_tr_b16 v[52:53], v19 offset:16384
    ds_read_b64_tr_b16 v[54:55], v19 offset:16896
    s_waitcnt lgkmcnt(0)
    v_mfma_f32_16x16x32_bf16 v[24:27], v[20:23], v[40:43], v[24:27]
    v_mfma_f32_16x16x32_bf16 v[28:31], v[20:23], v[44:47], v[28:31]
    v_mfma_f32_16x16x32_bf16 v[32:35], v[20:23], v[48:51], v[32:35]
    v_mfma_f32_16x16x32_bf16 v[36:39], v[20:23], v[52:55], v[36:39]
    v_cmp_lt_u32 vcc, 15, v1
    s_nop 4
    v_cndmask_b32 v24, v24, v28, vcc
    v_cmp_lt_u32 vcc, 31, v1
    s_nop 1
    v_cndmask_b32 v24, v24, v32, vcc
    v_cmp_lt_u32 vcc, 47, v1
    s_nop 1
    v_cndmask_b32 v24, v24, v36, vcc
    v_lshlrev_b32 v16, 2, v1
    buffer_store_dword v24, v16, s[4:7], s47 offen sc1
    v_mul_u32_u24 v16, 27, v1
    v_add_u32 v16, s45, v16
    v_cmp_gt_u32 vcc, 9, v1
    s_waitcnt vmcnt(0)
    v_lshlrev_b32 v16, 7, v16
    v_mov_b32 v17, 1
    s_mov_b64 exec, vcc
    buffer_atomic_add v17, v16, s[4:7], 0 offen offset:20 sc1
    s_mov_b64 exec, -1
    s_branch L_cs4_done
L_ct2:
    s_sub_u32 s41, s3, 6
    s_mul_i32 s41, s41, 3
    s_getpc_b64 s[42:43]
L_pcb:
    s_sub_u32 s42, s42, L_pcb-sequential_preLN__sliding_block__glu_gated_glu__prompt_kernel
    s_subb_u32 s43, s43, 0
    s_lshl_b32 s41, s41, 13
    v_lshl_add_u32 v16, v1, 7, s41
    v_min_u32 v17, L_code_end-sequential_preLN__sliding_block__glu_gated_glu__prompt_kernel-4, v16
    global_load_dword v251, v17, s[42:43]
    v_add_u32 v16, 8192, v16
    v_min_u32 v17, L_code_end-sequential_preLN__sliding_block__glu_gated_glu__prompt_kernel-4, v16
    global_load_dword v251, v17, s[42:43]
    v_add_u32 v16, 8192, v16
    v_min_u32 v17, L_code_end-sequential_preLN__sliding_block__glu_gated_glu__prompt_kernel-4, v16
    global_load_dword v251, v17, s[42:43]
    v_add_u32 v16, 8192, v16
    s_waitcnt vmcnt(0)
L_cs4_done:
    s_nop 12
    s_barrier
    s_sub_u32 s40, s2, 243
    s_cmp_ge_i32 s40, 0
    s_cbranch_scc1 L_rem
    s_cmp_lt_u32 s3, 4
    s_cbranch_scc1 L_p4_c_in
    s_and_b32 s40, s2, 7
    s_min_u32 s41, s40, 3
    s_mul_i32 s40, s40, 30
    s_add_u32 s40, s40, s41
    s_lshr_b32 s41, s2, 3
    s_add_u32 s40, s40, s41
    s_mul_i32 s41, s40, 1041
    s_lshr_b32 s41, s41, 16
    s_mul_i32 s42, s41, 63
    s_sub_u32 s40, s40, s42
    s_cmp_eq_u32 s41, 3
    s_cselect_b32 s42, 6, 7
    s_mov_b32 s43, 9363
    s_cselect_b32 s43, 10923, s43
    s_mul_i32 s41, s41, 7
    s_add_u32 s41, s41, s40
    s_mul_i32 s40, s40, s43
    s_lshr_b32 s40, s40, 16
    s_mul_i32 s42, s42, s40
    s_sub_u32 s41, s41, s42
    v_lshrrev_b32 v10, 3, v1
    v_mul_u32_u24 v3, 3456, v10
    v_and_b32 v10, 2, v10
    v_and_b32 v11, 7, v1
    v_xor_b32 v10, v10, v11
    v_lshl_add_u32 v3, v10, 4, v3
    v_xor_b32 v4, 64, v3
    v_add_u32 v4, 26624, v4
    v_lshlrev_b32 v2, 4, v1
    v_add_u32 v5, 18432, v2
    s_lshr_b32 s42, s97, 1
    s_and_b32 s43, s97, 1
    s_lshl_b32 s43, s43, 10
    s_lshl_b32 s44, s40, 1
    s_add_u32 s44, s44, s42
    s_mul_i32 s44, s44, 143360
    s_add_u32 s44, s44, s43
    s_add_u32 s44, s44, 12582912
    s_mul_i32 s47, s42, 14336
    s_add_u32 s47, s47, s43
    s_mul_i32 s45, s97, 55296
    s_lshl_b32 s46, s41, 7
    s_add_u32 s45, s45, s46
    s_lshl_b32 s46, s97, 11
    s_lshl_b32 s43, s97, 10
    s_mul_i32 s50, s40, 27
    s_add_u32 s50, s50, s41
    s_lshl_b32 s50, s50, 7
    s_add_u32 s51, s50, 12
    s_add_u32 s50, s50, 20
    s_mov_b32 s56, 30
    s_mov_b32 s54, 1073741816
    v_mov_b32 v12, 0
    v_mov_b32 v13, 0
    v_mov_b32 v247, 1073741816
    s_mov_b64 s[60:61], 1
    s_branch L_p4_h_in
L_rem:
    s_lshl_b32 s41, s40, 2
    s_mov_b32 s44, 1091283059
    s_mov_b32 s45, 181909
    s_lshr_b64 s[44:45], s[44:45], s41
    s_and_b32 s41, s44, 15
    s_cmp_eq_u32 s41, 0
    s_cselect_b32 s44, 3, 2
    s_cmp_ge_u32 s3, s44
    s_cbranch_scc1 L_end
    s_lshl_b32 s41, s41, 1
    s_add_u32 s41, s41, 2
    s_sub_u32 s41, s41, s3
    v_lshrrev_b32 v10, 3, v1
    v_mul_u32_u24 v4, 3456, v10
    v_and_b32 v10, 2, v10
    v_and_b32 v11, 7, v1
    v_xor_b32 v10, v10, v11
    v_lshl_add_u32 v4, v10, 4, v4
    v_lshrrev_b32 v2, 4, v1
    v_lshlrev_b32 v10, 10, v2
    v_bfe_u32 v2, v1, 2, 2
    v_lshl_add_u32 v10, v2, 7, v10
    v_and_b32 v2, 3, v1
    v_lshl_add_u32 v10, v2, 3, v10
    v_bfe_u32 v2, v1, 3, 2
    v_lshl_add_u32 v10, v2, 5, v10
    v_xor_b32 v5, 64, v4
    v_add_u32 v5, 26624, v5
    v_add_u32 v6, 53248, v4
    v_add_u32 v7, 53248, v5
    v_lshlrev_b32 v8, 4, v1
    v_add_u32 v9, 19456, v8
    s_mul_i32 s42, s3, 51200
    v_add_u32 v10, s42, v10
    v_xor_b32 v11, 32, v10
    v_xor_b32 v12, 64, v10
    v_xor_b32 v13, 96, v10
    v_add_u32 v14, s42, v8
    v_and_b32 v2, 15, v1
    v_lshrrev_b32 v3, 4, v1
    s_lshl_b32 s44, s41, 7
    s_mov_b32 s45, 15163392
    s_lshl_b32 s46, s40, 7
    s_add_u32 s46, s46, 31116
    v_mov_b32 v64, 0
    v_mov_b32 v65, 0
    v_mov_b32 v66, 0
    v_mov_b32 v67, 0
    v_mov_b32 v68, 0
    v_mov_b32 v69, 0
    v_mov_b32 v70, 0
    v_mov_b32 v71, 0
    v_mov_b32 v72, 0
    v_mov_b32 v73, 0
    v_mov_b32 v74, 0
    v_mov_b32 v75, 0
    v_mov_b32 v76, 0
    v_mov_b32 v77, 0
    v_mov_b32 v78, 0
    v_mov_b32 v79, 0
    v_mov_b32 v80, 0
    v_mov_b32 v81, 0
    v_mov_b32 v82, 0
    v_mov_b32 v83, 0
    v_mov_b32 v84, 0
    v_mov_b32 v85, 0
    v_mov_b32 v86, 0
    v_mov_b32 v87, 0
    v_mov_b32 v88, 0
    v_mov_b32 v89, 0
    v_mov_b32 v90, 0
    v_mov_b32 v91, 0
    v_mov_b32 v92, 0
    v_mov_b32 v93, 0
    v_mov_b32 v94, 0
    v_mov_b32 v95, 0
    v_mov_b32 v96, 0
    v_mov_b32 v97, 0
    v_mov_b32 v98, 0
    v_mov_b32 v99, 0
    v_mov_b32 v100, 0
    v_mov_b32 v101, 0
    v_mov_b32 v102, 0
    v_mov_b32 v103, 0
    v_mov_b32 v104, 0
    v_mov_b32 v105, 0
    v_mov_b32 v106, 0
    v_mov_b32 v107, 0
    v_mov_b32 v108, 0
    v_mov_b32 v109, 0
    v_mov_b32 v110, 0
    v_mov_b32 v111, 0
    v_mov_b32 v112, 0
    v_mov_b32 v113, 0
    v_mov_b32 v114, 0
    v_mov_b32 v115, 0
    v_mov_b32 v116, 0
    v_mov_b32 v117, 0
    v_mov_b32 v118, 0
    v_mov_b32 v119, 0
    v_mov_b32 v120, 0
    v_mov_b32 v121, 0
    v_mov_b32 v122, 0
    v_mov_b32 v123, 0
    v_mov_b32 v124, 0
    v_mov_b32 v125, 0
    v_mov_b32 v126, 0
    v_mov_b32 v127, 0
    v_mov_b32 v128, 0
    v_mov_b32 v129, 0
    v_mov_b32 v130, 0
    v_mov_b32 v131, 0
    v_mov_b32 v132, 0
    v_mov_b32 v133, 0
    v_mov_b32 v134, 0
    v_mov_b32 v135, 0
    v_mov_b32 v136, 0
    v_mov_b32 v137, 0
    v_mov_b32 v138, 0
    v_mov_b32 v139, 0
    v_mov_b32 v140, 0
    v_mov_b32 v141, 0
    v_mov_b32 v142, 0
    v_mov_b32 v143, 0
    v_mov_b32 v144, 0
    v_mov_b32 v145, 0
    v_mov_b32 v146, 0
    v_mov_b32 v147, 0
    v_mov_b32 v148, 0
    v_mov_b32 v149, 0
    v_mov_b32 v150, 0
    v_mov_b32 v151, 0
    v_mov_b32 v152, 0
    v_mov_b32 v153, 0
    v_mov_b32 v154, 0
    v_mov_b32 v155, 0
    v_mov_b32 v156, 0
    v_mov_b32 v157, 0
    v_mov_b32 v158, 0
    v_mov_b32 v159, 0
    v_mov_b32 v160, 0
    v_mov_b32 v161, 0
    v_mov_b32 v162, 0
    v_mov_b32 v163, 0
    v_mov_b32 v164, 0
    v_mov_b32 v165, 0
    v_mov_b32 v166, 0
    v_mov_b32 v167, 0
    v_mov_b32 v168, 0
    v_mov_b32 v169, 0
    v_mov_b32 v170, 0
    v_mov_b32 v171, 0
    v_mov_b32 v172, 0
    v_mov_b32 v173, 0
    v_mov_b32 v174, 0
    v_mov_b32 v175, 0
    v_mov_b32 v176, 0x3f803f80
    v_mov_b32 v177, 0x3f803f80
    v_mov_b32 v178, 0x3f803f80
    v_mov_b32 v179, 0x3f803f80
    s_add_u32 s47, s42, 0
    s_add_u32 m0, s47, 0
    s_nop 0
    buffer_load_dwordx4 v4, s[20:23], s44 offen offset:0 lds
    buffer_load_dwordx4 v5, s[20:23], s44 offen offset:1024 lds
    buffer_load_dwordx4 v6, s[20:23], s44 offen offset:2048 lds
    buffer_load_dwordx4 v7, s[20:23], s44 offen offset:3072 lds
    s_add_u32 m0, s47, 4096
    s_nop 0
    buffer_load_dwordx4 v4, s[24:27], s44 offen offset:0 lds
    buffer_load_dwordx4 v5, s[24:27], s44 offen offset:1024 lds
    buffer_load_dwordx4 v6, s[24:27], s44 offen offset:2048 lds
    buffer_load_dwordx4 v7, s[24:27], s44 offen offset:3072 lds
    s_add_u32 s44, s44, 110592
    s_add_u32 s47, s42, 10240
    s_add_u32 m0, s47, 0
    s_nop 0
    buffer_load_dwordx4 v4, s[20:23], s44 offen offset:0 lds
    buffer_load_dwordx4 v5, s[20:23], s44 offen offset:1024 lds
    buffer_load_dwordx4 v6, s[20:23], s44 offen offset:2048 lds
    buffer_load_dwordx4 v7, s[20:23], s44 offen offset:3072 lds
    s_add_u32 m0, s47, 4096
    s_nop 0
    buffer_load_dwordx4 v4, s[24:27], s44 offen offset:0 lds
    buffer_load_dwordx4 v5, s[24:27], s44 offen offset:1024 lds
    buffer_load_dwordx4 v6, s[24:27], s44 offen offset:2048 lds
    buffer_load_dwordx4 v7, s[24:27], s44 offen offset:3072 lds
    s_add_u32 s44, s44, 110592
    s_add_u32 s47, s42, 20480
    s_add_u32 m0, s47, 0
    s_nop 0
    buffer_load_dwordx4 v4, s[20:23], s44 offen offset:0 lds
    buffer_load_dwordx4 v5, s[20:23], s44 offen offset:1024 lds
    buffer_load_dwordx4 v6, s[20:23], s44 offen offset:2048 lds
    buffer_load_dwordx4 v7, s[20:23], s44 offen offset:3072 lds
    s_add_u32 m0, s47, 4096
    s_nop 0
    buffer_load_dwordx4 v4, s[24:27], s44 offen offset:0 lds
    buffer_load_dwordx4 v5, s[24:27], s44 offen offset:1024 lds
    buffer_load_dwordx4 v6, s[24:27], s44 offen offset:2048 lds
    buffer_load_dwordx4 v7, s[24:27], s44 offen offset:3072 lds
    s_add_u32 s44, s44, 110592
    s_add_u32 s47, s42, 30720
    s_add_u32 m0, s47, 0
    s_nop 0
    buffer_load_dwordx4 v4, s[20:23], s44 offen offset:0 lds
    buffer_load_dwordx4 v5, s[20:23], s44 offen offset:1024 lds
    buffer_load_dwordx4 v6, s[20:23], s44 offen offset:2048 lds
    buffer_load_dwordx4 v7, s[20:23], s44 offen offset:3072 lds
    s_add_u32 m0, s47, 4096
    s_nop 0
    buffer_load_dwordx4 v4, s[24:27], s44 offen offset:0 lds
    buffer_load_dwordx4 v5, s[24:27], s44 offen offset:1024 lds
    buffer_load_dwordx4 v6, s[24:27], s44 offen offset:2048 lds
    buffer_load_dwordx4 v7, s[24:27], s44 offen offset:3072 lds
    s_add_u32 s44, s44, 110592
    s_add_u32 s47, s42, 40960
    s_add_u32 m0, s47, 0
    s_nop 0
    buffer_load_dwordx4 v4, s[20:23], s44 offen offset:0 lds
    buffer_load_dwordx4 v5, s[20:23], s44 offen offset:1024 lds
    buffer_load_dwordx4 v6, s[20:23], s44 offen offset:2048 lds
    buffer_load_dwordx4 v7, s[20:23], s44 offen offset:3072 lds
    s_add_u32 m0, s47, 4096
    s_nop 0
    buffer_load_dwordx4 v4, s[24:27], s44 offen offset:0 lds
    buffer_load_dwordx4 v5, s[24:27], s44 offen offset:1024 lds
    buffer_load_dwordx4 v6, s[24:27], s44 offen offset:2048 lds
    buffer_load_dwordx4 v7, s[24:27], s44 offen offset:3072 lds
    s_add_u32 s44, s44, 110592
    v_mov_b32 v15, 0
    s_mov_b64 exec, 1
Lpoll_21:
    v_mov_b32 v248, 0
    buffer_atomic_add v248, v15, s[4:7], s46 offen sc0 sc1
    s_waitcnt vmcnt(0)
    v_cmp_ne_u32 vcc, 10, v248
    s_cbranch_vccz Lpoll_21d
    s_sub_u32 s96, s96, 1
    s_cbranch_scc0 Lpoll_21
    s_mov_b32 s96, 0
Lpoll_21d:
    s_mov_b64 exec, -1
    s_add_u32 s47, s42, 0
    s_add_u32 m0, s47, 8192
    s_nop 0
    buffer_load_dwordx4 v8, s[4:7], s45 offen offset:0 sc1 lds
    buffer_load_dwordx4 v9, s[4:7], s45 offen offset:1024 sc1 lds
    s_add_u32 s45, s45, 1024
    s_add_u32 s47, s42, 10240
    s_add_u32 m0, s47, 8192
    s_nop 0
    buffer_load_dwordx4 v8, s[4:7], s45 offen offset:0 sc1 lds
    buffer_load_dwordx4 v9, s[4:7], s45 offen offset:1024 sc1 lds
    s_add_u32 s45, s45, 1024
    s_add_u32 s47, s42, 20480
    s_add_u32 m0, s47, 8192
    s_nop 0
    buffer_load_dwordx4 v8, s[4:7], s45 offen offset:0 sc1 lds
    buffer_load_dwordx4 v9, s[4:7], s45 offen offset:1024 sc1 lds
    s_add_u32 s45, s45, 1024
    s_add_u32 s47, s42, 30720
    s_add_u32 m0, s47, 8192
    s_nop 0
    buffer_load_dwordx4 v8, s[4:7], s45 offen offset:0 sc1 lds
    buffer_load_dwordx4 v9, s[4:7], s45 offen offset:1024 sc1 lds
    s_add_u32 s45, s45, 1024
    s_add_u32 s47, s42, 40960
    s_add_u32 m0, s47, 8192
    s_nop 0
    buffer_load_dwordx4 v8, s[4:7], s45 offen offset:0 sc1 lds
    buffer_load_dwordx4 v9, s[4:7], s45 offen offset:1024 sc1 lds
    s_add_u32 s45, s45, 1024
    s_mov_b32 s47, s42
    s_mov_b32 s48, 0
    s_mov_b32 s49, 0
    s_waitcnt vmcnt(0)
    ds_read_b128 v[16:19], v14 offset:8192
    ds_read_b128 v[20:23], v14 offset:9216
    ds_read_b64_tr_b16 v[24:25], v10 offset:0
    ds_read_b64_tr_b16 v[26:27], v10 offset:512
    ds_read_b64_tr_b16 v[28:29], v11 offset:0
    ds_read_b64_tr_b16 v[30:31], v11 offset:512
    ds_read_b64_tr_b16 v[32:33], v12 offset:0
    ds_read_b64_tr_b16 v[34:35], v12 offset:512
    ds_read_b64_tr_b16 v[36:37], v13 offset:0
    ds_read_b64_tr_b16 v[38:39], v13 offset:512
    ds_read_b64_tr_b16 v[40:41], v10 offset:4096
    ds_read_b64_tr_b16 v[42:43], v10 offset:4608
    ds_read_b64_tr_b16 v[44:45], v11 offset:4096
    ds_read_b64_tr_b16 v[46:47], v11 offset:4608
    ds_read_b64_tr_b16 v[48:49], v12 offset:4096
    ds_read_b64_tr_b16 v[50:51], v12 offset:4608
    ds_read_b64_tr_b16 v[52:53], v13 offset:4096
    ds_read_b64_tr_b16 v[54:55], v13 offset:4608
L_rem_l:
    s_cmp_ge_u32 s48, 15
    s_cselect_b32 s45, 1073741816, s45
    s_add_u32 s48, s48, 1
    s_add_u32 s49, s49, 1
    s_cmp_eq_u32 s49, 5
    s_cselect_b32 s49, 0, s49
    s_mov_b32 s50, 10240
    s_cselect_b32 s50, 4294926336, s50
    v_add_u32 v10, s50, v10
    v_add_u32 v11, s50, v11
    v_add_u32 v12, s50, v12
    v_add_u32 v13, s50, v13
    v_add_u32 v14, s50, v14
    s_waitcnt vmcnt(30) lgkmcnt(0)
    v_mfma_f32_16x16x32_bf16 v[160:163], v[176:179], v[16:19], v[160:163]
    ds_read_b128 v[200:203], v14 offset:8192
    v_mfma_f32_16x16x32_bf16 v[168:171], v[16:19], v[16:19], v[168:171]
    ds_read_b128 v[204:207], v14 offset:9216
    v_mfma_f32_16x16x32_bf16 v[164:167], v[176:179], v[20:23], v[164:167]
    ds_read_b64_tr_b16 v[208:209], v10 offset:0
    v_mfma_f32_16x16x32_bf16 v[172:175], v[20:23], v[20:23], v[172:175]
    ds_read_b64_tr_b16 v[210:211], v10 offset:512
    v_mfma_f32_16x16x32_bf16 v[64:67], v[24:27], v[16:19], v[64:67]
    ds_read_b64_tr_b16 v[212:213], v11 offset:0
    v_mfma_f32_16x16x32_bf16 v[96:99], v[24:27], v[20:23], v[96:99]
    ds_read_b64_tr_b16 v[214:215], v11 offset:512
    v_mfma_f32_16x16x32_bf16 v[128:131], v[24:27], v[176:179], v[128:131]
    ds_read_b64_tr_b16 v[216:217], v12 offset:0
    v_mfma_f32_16x16x32_bf16 v[68:71], v[28:31], v[16:19], v[68:71]
    ds_read_b64_tr_b16 v[218:219], v12 offset:512
    v_mfma_f32_16x16x32_bf16 v[100:103], v[28:31], v[20:23], v[100:103]
    ds_read_b64_tr_b16 v[220:221], v13 offset:0
    v_mfma_f32_16x16x32_bf16 v[132:135], v[28:31], v[176:179], v[132:135]
    ds_read_b64_tr_b16 v[222:223], v13 offset:512
    v_mfma_f32_16x16x32_bf16 v[80:83], v[32:35], v[16:19], v[80:83]
    ds_read_b64_tr_b16 v[224:225], v10 offset:4096
    v_mfma_f32_16x16x32_bf16 v[112:115], v[32:35], v[20:23], v[112:115]
    ds_read_b64_tr_b16 v[226:227], v10 offset:4608
    v_mfma_f32_16x16x32_bf16 v[144:147], v[32:35], v[176:179], v[144:147]
    ds_read_b64_tr_b16 v[228:229], v11 offset:4096
    s_add_u32 m0, s47, 0
    v_mfma_f32_16x16x32_bf16 v[84:87], v[36:39], v[16:19], v[84:87]
    ds_read_b64_tr_b16 v[230:231], v11 offset:4608
    buffer_load_dwordx4 v4, s[20:23], s44 offen offset:0 lds
    v_mfma_f32_16x16x32_bf16 v[116:119], v[36:39], v[20:23], v[116:119]
    ds_read_b64_tr_b16 v[232:233], v12 offset:4096
    buffer_load_dwordx4 v5, s[20:23], s44 offen offset:1024 lds
    v_mfma_f32_16x16x32_bf16 v[148:151], v[36:39], v[176:179], v[148:151]
    ds_read_b64_tr_b16 v[234:235], v12 offset:4608
    buffer_load_dwordx4 v6, s[20:23], s44 offen offset:2048 lds
    v_mfma_f32_16x16x32_bf16 v[72:75], v[40:43], v[16:19], v[72:75]
    ds_read_b64_tr_b16 v[236:237], v13 offset:4096
    buffer_load_dwordx4 v7, s[20:23], s44 offen offset:3072 lds
    v_mfma_f32_16x16x32_bf16 v[104:107], v[40:43], v[20:23], v[104:107]
    ds_read_b64_tr_b16 v[238:239], v13 offset:4608
    s_add_u32 m0, s47, 4096
    v_mfma_f32_16x16x32_bf16 v[136:139], v[40:43], v[176:179], v[136:139]
    buffer_load_dwordx4 v4, s[24:27], s44 offen offset:0 lds
    v_mfma_f32_16x16x32_bf16 v[76:79], v[44:47], v[16:19], v[76:79]
    buffer_load_dwordx4 v5, s[24:27], s44 offen offset:1024 lds
    v_mfma_f32_16x16x32_bf16 v[108:111], v[44:47], v[20:23], v[108:111]
    buffer_load_dwordx4 v6, s[24:27], s44 offen offset:2048 lds
    v_mfma_f32_16x16x32_bf16 v[140:143], v[44:47], v[176:179], v[140:143]
    buffer_load_dwordx4 v7, s[24:27], s44 offen offset:3072 lds
    v_mfma_f32_16x16x32_bf16 v[88:91], v[48:51], v[16:19], v[88:91]
    s_add_u32 s44, s44, 110592
    v_mfma_f32_16x16x32_bf16 v[120:123], v[48:51], v[20:23], v[120:123]
    s_add_u32 m0, s47, 8192
    v_mfma_f32_16x16x32_bf16 v[152:155], v[48:51], v[176:179], v[152:155]
    buffer_load_dwordx4 v8, s[4:7], s45 offen offset:0 sc1 lds
    v_mfma_f32_16x16x32_bf16 v[92:95], v[52:55], v[16:19], v[92:95]
    buffer_load_dwordx4 v9, s[4:7], s45 offen offset:1024 sc1 lds
    v_mfma_f32_16x16x32_bf16 v[124:127], v[52:55], v[20:23], v[124:127]
    s_add_u32 s45, s45, 1024
    v_mfma_f32_16x16x32_bf16 v[156:159], v[52:55], v[176:179], v[156:159]
    s_add_u32 s47, s47, s50
    s_cmp_ge_u32 s48, 15
    s_cselect_b32 s45, 1073741816, s45
    s_add_u32 s48, s48, 1
    s_add_u32 s49, s49, 1
    s_cmp_eq_u32 s49, 5
    s_cselect_b32 s49, 0, s49
    s_mov_b32 s50, 10240
    s_cselect_b32 s50, 4294926336, s50
    v_add_u32 v10, s50, v10
    v_add_u32 v11, s50, v11
    v_add_u32 v12, s50, v12
    v_add_u32 v13, s50, v13
    v_add_u32 v14, s50, v14
    s_waitcnt vmcnt(30) lgkmcnt(0)
    v_mfma_f32_16x16x32_bf16 v[160:163], v[176:179], v[200:203], v[160:163]
    ds_read_b128 v[16:19], v14 offset:8192
    v_mfma_f32_16x16x32_bf16 v[168:171], v[200:203], v[200:203], v[168:171]
    ds_read_b128 v[20:23], v14 offset:9216
    v_mfma_f32_16x16x32_bf16 v[164:167], v[176:179], v[204:207], v[164:167]
    ds_read_b64_tr_b16 v[24:25], v10 offset:0
    v_mfma_f32_16x16x32_bf16 v[172:175], v[204:207], v[204:207], v[172:175]
    ds_read_b64_tr_b16 v[26:27], v10 offset:512
    v_mfma_f32_16x16x32_bf16 v[64:67], v[208:211], v[200:203], v[64:67]
    ds_read_b64_tr_b16 v[28:29], v11 offset:0
    v_mfma_f32_16x16x32_bf16 v[96:99], v[208:211], v[204:207], v[96:99]
    ds_read_b64_tr_b16 v[30:31], v11 offset:512
    v_mfma_f32_16x16x32_bf16 v[128:131], v[208:211], v[176:179], v[128:131]
    ds_read_b64_tr_b16 v[32:33], v12 offset:0
    v_mfma_f32_16x16x32_bf16 v[68:71], v[212:215], v[200:203], v[68:71]
    ds_read_b64_tr_b16 v[34:35], v12 offset:512
    v_mfma_f32_16x16x32_bf16 v[100:103], v[212:215], v[204:207], v[100:103]
    ds_read_b64_tr_b16 v[36:37], v13 offset:0
    v_mfma_f32_16x16x32_bf16 v[132:135], v[212:215], v[176:179], v[132:135]
    ds_read_b64_tr_b16 v[38:39], v13 offset:512
    v_mfma_f32_16x16x32_bf16 v[80:83], v[216:219], v[200:203], v[80:83]
    ds_read_b64_tr_b16 v[40:41], v10 offset:4096
    v_mfma_f32_16x16x32_bf16 v[112:115], v[216:219], v[204:207], v[112:115]
    ds_read_b64_tr_b16 v[42:43], v10 offset:4608
    v_mfma_f32_16x16x32_bf16 v[144:147], v[216:219], v[176:179], v[144:147]
    ds_read_b64_tr_b16 v[44:45], v11 offset:4096
    s_add_u32 m0, s47, 0
    v_mfma_f32_16x16x32_bf16 v[84:87], v[220:223], v[200:203], v[84:87]
    ds_read_b64_tr_b16 v[46:47], v11 offset:4608
    buffer_load_dwordx4 v4, s[20:23], s44 offen offset:0 lds
    v_mfma_f32_16x16x32_bf16 v[116:119], v[220:223], v[204:207], v[116:119]
    ds_read_b64_tr_b16 v[48:49], v12 offset:4096
    buffer_load_dwordx4 v5, s[20:23], s44 offen offset:1024 lds
    v_mfma_f32_16x16x32_bf16 v[148:151], v[220:223], v[176:179], v[148:151]
    ds_read_b64_tr_b16 v[50:51], v12 offset:4608
    buffer_load_dwordx4 v6, s[20:23], s44 offen offset:2048 lds
    v_mfma_f32_16x16x32_bf16 v[72:75], v[224:227], v[200:203], v[72:75]
    ds_read_b64_tr_b16 v[52:53], v13 offset:4096
    buffer_load_dwordx4 v7, s[20:23], s44 offen offset:3072 lds
    v_mfma_f32_16x16x32_bf16 v[104:107], v[224:227], v[204:207], v[104:107]
    ds_read_b64_tr_b16 v[54:55], v13 offset:4608
    s_add_u32 m0, s47, 4096
    v_mfma_f32_16x16x32_bf16 v[136:139], v[224:227], v[176:179], v[136:139]
    buffer_load_dwordx4 v4, s[24:27], s44 offen offset:0 lds
    v_mfma_f32_16x16x32_bf16 v[76:79], v[228:231], v[200:203], v[76:79]
    buffer_load_dwordx4 v5, s[24:27], s44 offen offset:1024 lds
    v_mfma_f32_16x16x32_bf16 v[108:111], v[228:231], v[204:207], v[108:111]
    buffer_load_dwordx4 v6, s[24:27], s44 offen offset:2048 lds
    v_mfma_f32_16x16x32_bf16 v[140:143], v[228:231], v[176:179], v[140:143]
    buffer_load_dwordx4 v7, s[24:27], s44 offen offset:3072 lds
    v_mfma_f32_16x16x32_bf16 v[88:91], v[232:235], v[200:203], v[88:91]
    s_add_u32 s44, s44, 110592
    v_mfma_f32_16x16x32_bf16 v[120:123], v[232:235], v[204:207], v[120:123]
    s_add_u32 m0, s47, 8192
    v_mfma_f32_16x16x32_bf16 v[152:155], v[232:235], v[176:179], v[152:155]
    buffer_load_dwordx4 v8, s[4:7], s45 offen offset:0 sc1 lds
    v_mfma_f32_16x16x32_bf16 v[92:95], v[236:239], v[200:203], v[92:95]
    buffer_load_dwordx4 v9, s[4:7], s45 offen offset:1024 sc1 lds
    v_mfma_f32_16x16x32_bf16 v[124:127], v[236:239], v[204:207], v[124:127]
    s_add_u32 s45, s45, 1024
    v_mfma_f32_16x16x32_bf16 v[156:159], v[236:239], v[176:179], v[156:159]
    s_add_u32 s47, s47, s50
    s_cmp_lt_u32 s48, 20
    s_cbranch_scc1 L_rem_l
    s_waitcnt lgkmcnt(0)
    s_nop 9
    v_and_b32 v4, 3, v2
    v_lshrrev_b32 v5, 2, v2
    v_cmp_eq_u32 s[50:51], v5, v3
    v_cmp_eq_u32 vcc, 1, v4
    s_nop 1
    v_cndmask_b32 v168, v168, v169, vcc
    v_cmp_eq_u32 vcc, 2, v4
    s_nop 1
    v_cndmask_b32 v168, v168, v170, vcc
    v_cmp_eq_u32 vcc, 3, v4
    s_nop 1
    v_cndmask_b32 v168, v168, v171, vcc
    v_cndmask_b32 v168, 0, v168, s[50:51]
    v_mov_b32 v169, v168
    s_nop 1
    v_permlane16_swap_b32 v168, v169
    v_add_f32 v168, v168, v169
    v_mov_b32 v169, v168
    s_nop 1
    v_permlane32_swap_b32 v168, v169
    v_add_f32 v168, v168, v169
    v_mul_f32 v180, 0x3acccccd, v160
    v_mul_f32 v168, 0x3acccccd, v168
    v_fma_f32 v168, -v180, v180, v168
    v_max_f32 v168, 0, v168
    v_add_f32 v168, 0x3727c5ac, v168
    v_rsq_f32 v181, v168
    v_sqrt_f32 v182, v168
    v_mov_b32 v183, 0
    v_mul_f32 v181, 0xbfb8aa3b, v181
    v_cmp_eq_u32 vcc, 1, v4
    s_nop 1
    v_cndmask_b32 v172, v172, v173, vcc
    v_cmp_eq_u32 vcc, 2, v4
    s_nop 1
    v_cndmask_b32 v172, v172, v174, vcc
    v_cmp_eq_u32 vcc, 3, v4
    s_nop 1
    v_cndmask_b32 v172, v172, v175, vcc
    v_cndmask_b32 v172, 0, v172, s[50:51]
    v_mov_b32 v173, v172
    s_nop 1
    v_permlane16_swap_b32 v172, v173
    v_add_f32 v172, v172, v173
    v_mov_b32 v173, v172
    s_nop 1
    v_permlane32_swap_b32 v172, v173
    v_add_f32 v172, v172, v173
    v_mul_f32 v184, 0x3acccccd, v164
    v_mul_f32 v172, 0x3acccccd, v172
    v_fma_f32 v172, -v184, v184, v172
    v_max_f32 v172, 0, v172
    v_add_f32 v172, 0x3727c5ac, v172
    v_rsq_f32 v185, v172
    v_sqrt_f32 v186, v172
    v_mov_b32 v187, 0
    v_mul_f32 v185, 0xbfb8aa3b, v185
    v_and_b32 v6, 1, v3
    v_lshlrev_b32 v6, 9, v6
    v_lshrrev_b32 v7, 1, v3
    v_lshl_add_u32 v6, v7, 8, v6
    v_lshl_add_u32 v6, v2, 4, v6
    s_lshl_b32 s50, s41, 11
    s_add_u32 s50, s50, 23744512
    s_add_u32 s51, s50, 55296
    v_pk_fma_f32 v[64:65], v[128:129], v[180:181], v[64:65] op_sel_hi:[1,0,1] neg_lo:[0,1,0] neg_hi:[0,1,0]
    v_pk_fma_f32 v[66:67], v[130:131], v[180:181], v[66:67] op_sel_hi:[1,0,1] neg_lo:[0,1,0] neg_hi:[0,1,0]
    v_pk_fma_f32 v[68:69], v[132:133], v[180:181], v[68:69] op_sel_hi:[1,0,1] neg_lo:[0,1,0] neg_hi:[0,1,0]
    v_pk_fma_f32 v[70:71], v[134:135], v[180:181], v[70:71] op_sel_hi:[1,0,1] neg_lo:[0,1,0] neg_hi:[0,1,0]
    v_pk_mul_f32 v[64:65], v[64:65], v[180:181] op_sel:[0,1] op_sel_hi:[1,1]
    v_pk_mul_f32 v[66:67], v[66:67], v[180:181] op_sel:[0,1] op_sel_hi:[1,1]
    v_pk_mul_f32 v[68:69], v[68:69], v[180:181] op_sel:[0,1] op_sel_hi:[1,1]
    v_pk_mul_f32 v[70:71], v[70:71], v[180:181] op_sel:[0,1] op_sel_hi:[1,1]
    v_exp_f32 v64, v64
    v_exp_f32 v65, v65
    v_exp_f32 v66, v66
    v_exp_f32 v67, v67
    v_exp_f32 v68, v68
    v_exp_f32 v69, v69
    v_exp_f32 v70, v70
    v_exp_f32 v71, v71
    v_pk_fma_f32 v[72:73], v[136:137], v[180:181], v[72:73] op_sel_hi:[1,0,1] neg_lo:[0,1,0] neg_hi:[0,1,0]
    v_pk_fma_f32 v[74:75], v[138:139], v[180:181], v[74:75] op_sel_hi:[1,0,1] neg_lo:[0,1,0] neg_hi:[0,1,0]
    v_pk_fma_f32 v[76:77], v[140:141], v[180:181], v[76:77] op_sel_hi:[1,0,1] neg_lo:[0,1,0] neg_hi:[0,1,0]
    v_pk_fma_f32 v[78:79], v[142:143], v[180:181], v[78:79] op_sel_hi:[1,0,1] neg_lo:[0,1,0] neg_hi:[0,1,0]
    v_pk_fma_f32 v[64:65], v[64:65], v[182:183], v[182:183] op_sel_hi:[1,0,0]
    v_pk_fma_f32 v[66:67], v[66:67], v[182:183], v[182:183] op_sel_hi:[1,0,0]
    v_pk_fma_f32 v[68:69], v[68:69], v[182:183], v[182:183] op_sel_hi:[1,0,0]
    v_pk_fma_f32 v[70:71], v[70:71], v[182:183], v[182:183] op_sel_hi:[1,0,0]
    v_rcp_f32 v64, v64
    v_rcp_f32 v65, v65
    v_rcp_f32 v66, v66
    v_rcp_f32 v67, v67
    v_rcp_f32 v68, v68
    v_rcp_f32 v69, v69
    v_rcp_f32 v70, v70
    v_rcp_f32 v71, v71
    v_pk_fma_f32 v[80:81], v[144:145], v[180:181], v[80:81] op_sel_hi:[1,0,1] neg_lo:[0,1,0] neg_hi:[0,1,0]
    v_pk_fma_f32 v[82:83], v[146:147], v[180:181], v[82:83] op_sel_hi:[1,0,1] neg_lo:[0,1,0] neg_hi:[0,1,0]
    v_pk_fma_f32 v[84:85], v[148:149], v[180:181], v[84:85] op_sel_hi:[1,0,1] neg_lo:[0,1,0] neg_hi:[0,1,0]
    v_pk_fma_f32 v[86:87], v[150:151], v[180:181], v[86:87] op_sel_hi:[1,0,1] neg_lo:[0,1,0] neg_hi:[0,1,0]
    v_pk_mul_f32 v[64:65], v[64:65], v[72:73]
    v_pk_mul_f32 v[66:67], v[66:67], v[74:75]
    v_pk_mul_f32 v[68:69], v[68:69], v[76:77]
    v_pk_mul_f32 v[70:71], v[70:71], v[78:79]
    v_cvt_pk_bf16_f32 v16, v64, v65
    v_cvt_pk_bf16_f32 v18, v68, v69
    v_cvt_pk_bf16_f32 v17, v66, v67
    v_cvt_pk_bf16_f32 v19, v70, v71
    v_pk_mul_f32 v[80:81], v[80:81], v[180:181] op_sel:[0,1] op_sel_hi:[1,1]
    v_pk_mul_f32 v[82:83], v[82:83], v[180:181] op_sel:[0,1] op_sel_hi:[1,1]
    v_pk_mul_f32 v[84:85], v[84:85], v[180:181] op_sel:[0,1] op_sel_hi:[1,1]
    v_pk_mul_f32 v[86:87], v[86:87], v[180:181] op_sel:[0,1] op_sel_hi:[1,1]
    v_permlane16_swap_b32 v16, v18
    v_permlane16_swap_b32 v17, v19
    buffer_store_dwordx4 v[16:19], v6, s[4:7], s50 offen offset:0 sc1
    v_exp_f32 v80, v80
    v_exp_f32 v81, v81
    v_exp_f32 v82, v82
    v_exp_f32 v83, v83
    v_exp_f32 v84, v84
    v_exp_f32 v85, v85
    v_exp_f32 v86, v86
    v_exp_f32 v87, v87
    v_pk_fma_f32 v[88:89], v[152:153], v[180:181], v[88:89] op_sel_hi:[1,0,1] neg_lo:[0,1,0] neg_hi:[0,1,0]
    v_pk_fma_f32 v[90:91], v[154:155], v[180:181], v[90:91] op_sel_hi:[1,0,1] neg_lo:[0,1,0] neg_hi:[0,1,0]
    v_pk_fma_f32 v[92:93], v[156:157], v[180:181], v[92:93] op_sel_hi:[1,0,1] neg_lo:[0,1,0] neg_hi:[0,1,0]
    v_pk_fma_f32 v[94:95], v[158:159], v[180:181], v[94:95] op_sel_hi:[1,0,1] neg_lo:[0,1,0] neg_hi:[0,1,0]
    v_pk_fma_f32 v[80:81], v[80:81], v[182:183], v[182:183] op_sel_hi:[1,0,0]
    v_pk_fma_f32 v[82:83], v[82:83], v[182:183], v[182:183] op_sel_hi:[1,0,0]
    v_pk_fma_f32 v[84:85], v[84:85], v[182:183], v[182:183] op_sel_hi:[1,0,0]
    v_pk_fma_f32 v[86:87], v[86:87], v[182:183], v[182:183] op_sel_hi:[1,0,0]
    v_rcp_f32 v80, v80
    v_rcp_f32 v81, v81
    v_rcp_f32 v82, v82
    v_rcp_f32 v83, v83
    v_rcp_f32 v84, v84
    v_rcp_f32 v85, v85
    v_rcp_f32 v86, v86
    v_rcp_f32 v87, v87
    v_pk_fma_f32 v[96:97], v[128:129], v[184:185], v[96:97] op_sel_hi:[1,0,1] neg_lo:[0,1,0] neg_hi:[0,1,0]
    v_pk_fma_f32 v[98:99], v[130:131], v[184:185], v[98:99] op_sel_hi:[1,0,1] neg_lo:[0,1,0] neg_hi:[0,1,0]
    v_pk_fma_f32 v[100:101], v[132:133], v[184:185], v[100:101] op_sel_hi:[1,0,1] neg_lo:[0,1,0] neg_hi:[0,1,0]
    v_pk_fma_f32 v[102:103], v[134:135], v[184:185], v[102:103] op_sel_hi:[1,0,1] neg_lo:[0,1,0] neg_hi:[0,1,0]
    v_pk_mul_f32 v[80:81], v[80:81], v[88:89]
    v_pk_mul_f32 v[82:83], v[82:83], v[90:91]
    v_pk_mul_f32 v[84:85], v[84:85], v[92:93]
    v_pk_mul_f32 v[86:87], v[86:87], v[94:95]
    v_cvt_pk_bf16_f32 v20, v80, v81
    v_cvt_pk_bf16_f32 v22, v84, v85
    v_cvt_pk_bf16_f32 v21, v82, v83
    v_cvt_pk_bf16_f32 v23, v86, v87
    v_pk_mul_f32 v[96:97], v[96:97], v[184:185] op_sel:[0,1] op_sel_hi:[1,1]
    v_pk_mul_f32 v[98:99], v[98:99], v[184:185] op_sel:[0,1] op_sel_hi:[1,1]
    v_pk_mul_f32 v[100:101], v[100:101], v[184:185] op_sel:[0,1] op_sel_hi:[1,1]
    v_pk_mul_f32 v[102:103], v[102:103], v[184:185] op_sel:[0,1] op_sel_hi:[1,1]
    v_permlane16_swap_b32 v20, v22
    v_permlane16_swap_b32 v21, v23
    buffer_store_dwordx4 v[20:23], v6, s[4:7], s50 offen offset:1024 sc1
    v_exp_f32 v96, v96
    v_exp_f32 v97, v97
    v_exp_f32 v98, v98
    v_exp_f32 v99, v99
    v_exp_f32 v100, v100
    v_exp_f32 v101, v101
    v_exp_f32 v102, v102
    v_exp_f32 v103, v103
    v_pk_fma_f32 v[104:105], v[136:137], v[184:185], v[104:105] op_sel_hi:[1,0,1] neg_lo:[0,1,0] neg_hi:[0,1,0]
    v_pk_fma_f32 v[106:107], v[138:139], v[184:185], v[106:107] op_sel_hi:[1,0,1] neg_lo:[0,1,0] neg_hi:[0,1,0]
    v_pk_fma_f32 v[108:109], v[140:141], v[184:185], v[108:109] op_sel_hi:[1,0,1] neg_lo:[0,1,0] neg_hi:[0,1,0]
    v_pk_fma_f32 v[110:111], v[142:143], v[184:185], v[110:111] op_sel_hi:[1,0,1] neg_lo:[0,1,0] neg_hi:[0,1,0]
    v_pk_fma_f32 v[96:97], v[96:97], v[186:187], v[186:187] op_sel_hi:[1,0,0]
    v_pk_fma_f32 v[98:99], v[98:99], v[186:187], v[186:187] op_sel_hi:[1,0,0]
    v_pk_fma_f32 v[100:101], v[100:101], v[186:187], v[186:187] op_sel_hi:[1,0,0]
    v_pk_fma_f32 v[102:103], v[102:103], v[186:187], v[186:187] op_sel_hi:[1,0,0]
    v_rcp_f32 v96, v96
    v_rcp_f32 v97, v97
    v_rcp_f32 v98, v98
    v_rcp_f32 v99, v99
    v_rcp_f32 v100, v100
    v_rcp_f32 v101, v101
    v_rcp_f32 v102, v102
    v_rcp_f32 v103, v103
    v_pk_fma_f32 v[112:113], v[144:145], v[184:185], v[112:113] op_sel_hi:[1,0,1] neg_lo:[0,1,0] neg_hi:[0,1,0]
    v_pk_fma_f32 v[114:115], v[146:147], v[184:185], v[114:115] op_sel_hi:[1,0,1] neg_lo:[0,1,0] neg_hi:[0,1,0]
    v_pk_fma_f32 v[116:117], v[148:149], v[184:185], v[116:117] op_sel_hi:[1,0,1] neg_lo:[0,1,0] neg_hi:[0,1,0]
    v_pk_fma_f32 v[118:119], v[150:151], v[184:185], v[118:119] op_sel_hi:[1,0,1] neg_lo:[0,1,0] neg_hi:[0,1,0]
    v_pk_mul_f32 v[96:97], v[96:97], v[104:105]
    v_pk_mul_f32 v[98:99], v[98:99], v[106:107]
    v_pk_mul_f32 v[100:101], v[100:101], v[108:109]
    v_pk_mul_f32 v[102:103], v[102:103], v[110:111]
    v_cvt_pk_bf16_f32 v24, v96, v97
    v_cvt_pk_bf16_f32 v26, v100, v101
    v_cvt_pk_bf16_f32 v25, v98, v99
    v_cvt_pk_bf16_f32 v27, v102, v103
    v_pk_mul_f32 v[112:113], v[112:113], v[184:185] op_sel:[0,1] op_sel_hi:[1,1]
    v_pk_mul_f32 v[114:115], v[114:115], v[184:185] op_sel:[0,1] op_sel_hi:[1,1]
    v_pk_mul_f32 v[116:117], v[116:117], v[184:185] op_sel:[0,1] op_sel_hi:[1,1]
    v_pk_mul_f32 v[118:119], v[118:119], v[184:185] op_sel:[0,1] op_sel_hi:[1,1]
    v_permlane16_swap_b32 v24, v26
    v_permlane16_swap_b32 v25, v27
    buffer_store_dwordx4 v[24:27], v6, s[4:7], s51 offen offset:0 sc1
    v_exp_f32 v112, v112
    v_exp_f32 v113, v113
    v_exp_f32 v114, v114
    v_exp_f32 v115, v115
    v_exp_f32 v116, v116
    v_exp_f32 v117, v117
    v_exp_f32 v118, v118
    v_exp_f32 v119, v119
    v_pk_fma_f32 v[120:121], v[152:153], v[184:185], v[120:121] op_sel_hi:[1,0,1] neg_lo:[0,1,0] neg_hi:[0,1,0]
    v_pk_fma_f32 v[122:123], v[154:155], v[184:185], v[122:123] op_sel_hi:[1,0,1] neg_lo:[0,1,0] neg_hi:[0,1,0]
    v_pk_fma_f32 v[124:125], v[156:157], v[184:185], v[124:125] op_sel_hi:[1,0,1] neg_lo:[0,1,0] neg_hi:[0,1,0]
    v_pk_fma_f32 v[126:127], v[158:159], v[184:185], v[126:127] op_sel_hi:[1,0,1] neg_lo:[0,1,0] neg_hi:[0,1,0]
    v_pk_fma_f32 v[112:113], v[112:113], v[186:187], v[186:187] op_sel_hi:[1,0,0]
    v_pk_fma_f32 v[114:115], v[114:115], v[186:187], v[186:187] op_sel_hi:[1,0,0]
    v_pk_fma_f32 v[116:117], v[116:117], v[186:187], v[186:187] op_sel_hi:[1,0,0]
    v_pk_fma_f32 v[118:119], v[118:119], v[186:187], v[186:187] op_sel_hi:[1,0,0]
    v_rcp_f32 v112, v112
    v_rcp_f32 v113, v113
    v_rcp_f32 v114, v114
    v_rcp_f32 v115, v115
    v_rcp_f32 v116, v116
    v_rcp_f32 v117, v117
    v_rcp_f32 v118, v118
    v_rcp_f32 v119, v119
    v_pk_mul_f32 v[112:113], v[112:113], v[120:121]
    v_pk_mul_f32 v[114:115], v[114:115], v[122:123]
    v_pk_mul_f32 v[116:117], v[116:117], v[124:125]
    v_pk_mul_f32 v[118:119], v[118:119], v[126:127]
    v_cvt_pk_bf16_f32 v28, v112, v113
    v_cvt_pk_bf16_f32 v30, v116, v117
    v_cvt_pk_bf16_f32 v29, v114, v115
    v_cvt_pk_bf16_f32 v31, v118, v119
    v_permlane16_swap_b32 v28, v30
    s_nop 0
    v_permlane16_swap_b32 v29, v31
    buffer_store_dwordx4 v[28:31], v6, s[4:7], s51 offen offset:1024 sc1
    v_add_u32 v16, 210, v1
    s_waitcnt vmcnt(0)
    v_lshlrev_b32 v16, 7, v16
    v_mov_b32 v17, 1
    s_mov_b64 exec, 0x3ff
    buffer_atomic_add v17, v16, s[4:7], 0 offen offset:16 sc1
    s_mov_b64 exec, -1
    s_endpgm
L_p3_skip:
    s_barrier
    s_branch L_idle
L_code_end:
.section .rodata,"a"
.p2align 6
.amdhsa_kernel sequential_preLN__sliding_block__glu_gated_glu__prompt_kernel
  .amdhsa_next_free_vgpr 256
  .amdhsa_next_free_sgpr 102
  .amdhsa_accum_offset 256
  .amdhsa_group_segment_fixed_size 0
  .amdhsa_kernarg_size 80
  .amdhsa_user_sgpr_count 2
  .amdhsa_user_sgpr_kernarg_segment_ptr 1
  .amdhsa_system_sgpr_workgroup_id_x 1
.end_amdhsa_kernel
```
